```python
import torch

def _softmax(x, axis=-1):
    return torch.softmax(x, dim=axis)
def _gelu(x):
    return torch.nn.functional.gelu(x, approximate="tanh")
def _silu(x):
    return torch.nn.functional.silu(x)
def _sigmoid(x):
    return torch.sigmoid(x)
def _layernorm(x, axis=-1, eps=1e-5):
    m = x.mean(dim=axis, keepdim=True)
    v = x.var(dim=axis, keepdim=True, unbiased=False)
    return (x - m) / torch.sqrt(v + eps)
def _scatter_add(tgt, idx, src, axis=0):
    return tgt.clone().index_add_(axis, idx, src)
def _segment_sum(src, seg, n):
    out = torch.zeros((n,) + src.shape[1:], dtype=src.dtype)
    return out.index_add_(0, seg, src)
def _pad(x, pw):
    flat = tuple(v for pair in reversed(pw) for v in pair)
    return torch.nn.functional.pad(x, flat)

kernel_name = 'interleave_layers__sliding_local_dilated__linear_kernel_hedgehog__prompt'

def setup_inputs():

    _w = (lambda a: (lambda t: t.to(torch.bfloat16) if t.is_floating_point() else t)(torch.as_tensor(a)))
    def _A_setup():
        B, S, D = 1, 2048, 576
        return {
            "x": _w((lambda *s: torch.randn(*s, dtype=torch.bfloat16) * 0.05)(B, S, D)),
            "wqkv": _w((lambda *s: torch.randn(*s, dtype=torch.bfloat16) * 0.05)(D, 3 * D)),
            "wo": _w((lambda *s: torch.randn(*s, dtype=torch.bfloat16) * 0.05)(D, D)),
        }
    _A_in = _A_setup()

    def _B_setup():
        B, S, D, H = 1, 2048, 576, 32
        Dh = D // H
        return {
            "x": _w((lambda *s: torch.randn(*s, dtype=torch.bfloat16) * 0.05)(B, S, D)),
            "wqkv": _w((lambda *s: torch.randn(*s, dtype=torch.bfloat16) * 0.4)(D, 3 * D)),
            "w_phi": _w((lambda *s: torch.randn(*s, dtype=torch.bfloat16) * 0.4)(H, Dh, Dh) * (Dh ** -0.5)),
            "wo": _w((lambda *s: torch.randn(*s, dtype=torch.bfloat16) * 0.1)(D, D)),
        }
    _B_in = _B_setup()

    return {
        "A_x": _A_in["x"],
        "A_wqkv": _A_in["wqkv"],
        "A_wo": _A_in["wo"],
        "B_x": _B_in["x"],
        "B_wqkv": _B_in["wqkv"],
        "B_w_phi": _B_in["w_phi"],
        "B_wo": _B_in["wo"],
    }

def reference(A_x, A_wqkv, A_wo, B_x, B_wqkv, B_w_phi, B_wo):
    def _A_ref(x, wqkv, wo):
        B, S, D = x.shape
        H = 32; Dh = D // H
        W, dil = 8, 2
        qkv = (lambda x, *d: x.permute(*d))((x @ wqkv).reshape(B, S, 3, H, Dh), 2, 0, 3, 1, 4)
        q, k, v = qkv[0], qkv[1], qkv[2]
        scale = Dh ** -0.5
        pos = torch.arange(S)
        off = torch.arange(W) * dil
        idx = pos[:, None] - off[None, :]
        mask = idx >= 0
        idx_c = torch.where(mask, idx, 0).reshape(-1)
        kg = k[:, :, idx_c, :].reshape(B, H, S, W, Dh)
        vg = v[:, :, idx_c, :].reshape(B, H, S, W, Dh)
        logits = torch.einsum("bhsd,bhswd->bhsw", q, kg) * scale
        logits = torch.where(mask[None, None, :, :], logits, -1e9)
        attn = _softmax(logits, axis=-1)
        o = torch.einsum("bhsw,bhswd->bhsd", attn, vg)
        return (lambda x, *d: x.permute(*d))(o, 0, 2, 1, 3).reshape(B, S, D) @ wo

    def _B_ref(x, wqkv, w_phi, wo):
        B, S, D = x.shape
        H = 32; Dh = D // H
        qkv = (lambda x, *d: x.permute(*d))((x @ wqkv).reshape(B, S, 3, H, Dh), 2, 0, 3, 1, 4)
        q, k, v = qkv[0], qkv[1], qkv[2]
        pq = torch.einsum("bhsd,hdf->bhsf", q, w_phi)
        pk = torch.einsum("bhsd,hdf->bhsf", k, w_phi)
        phi_q = torch.concatenate([_softmax(pq, axis=-1), _softmax(-pq, axis=-1)], axis=-1)
        phi_k = torch.concatenate([_softmax(pk, axis=-1), _softmax(-pk, axis=-1)], axis=-1)
        kv = torch.einsum("bhsf,bhsd->bhfd", phi_k, v)
        z  = torch.einsum("bhsf->bhf", phi_k)
        num = torch.einsum("bhqf,bhfd->bhqd", phi_q, kv)
        den = torch.einsum("bhqf,bhf->bhq", phi_q, z)[..., None] + 1e-6
        o = num / den
        return (lambda x, *d: x.permute(*d))(o, 0, 2, 1, 3).reshape(B, S, D) @ wo

    x = A_x
    x = x + _A_ref(_layernorm(x, axis=-1), A_wqkv, A_wo)
    x = x + _B_ref(_layernorm(x, axis=-1), B_wqkv, B_w_phi, B_wo)
    x = x + _A_ref(_layernorm(x, axis=-1), A_wqkv, A_wo)
    x = x + _B_ref(_layernorm(x, axis=-1), B_wqkv, B_w_phi, B_wo)
    return x
```

```asm
; @launch grid=(256,1,1) block=(256,1,1) lds=163840
.amdgcn_target "amdgcn-amd-amdhsa--gfx950"
.text
.globl interleave_layers__sliding_local_dilated__linear_kernel_hedgehog__prompt_kernel
.p2align 8
.type interleave_layers__sliding_local_dilated__linear_kernel_hedgehog__prompt_kernel,@function
interleave_layers__sliding_local_dilated__linear_kernel_hedgehog__prompt_kernel:
    s_cmp_ge_u32 s2, 256
    s_cbranch_scc1 L_EXIT
    s_load_dwordx4 s[56:59], s[0:1], 0
    s_load_dwordx2 s[60:61], s[0:1], 16
    s_load_dwordx4 s[64:67], s[0:1], 32
    s_load_dwordx4 s[68:71], s[0:1], 48
    s_load_dwordx2 s[72:73], s[0:1], 72
    s_getreg_b32 s42, hwreg(HW_REG_XCC_ID)
    s_and_b32 s45, s2, 7
    s_lshl_b32 s45, s45, 1
    s_lshr_b32 s3, s2, 7
    s_add_u32 s45, s45, s3
    s_lshr_b32 s46, s2, 3
    s_and_b32 s46, s46, 15
    s_lshr_b32 s49, s46, 3
    s_and_b32 s50, s46, 7
    s_and_b32 s42, s42, 7
    v_lshrrev_b32 v1, 6, v0
    v_and_b32 v197, 63, v0
    v_readfirstlane_b32 s44, v1
    v_and_b32 v198, 15, v197
    v_lshrrev_b32 v199, 4, v197
    v_mov_b32 v255, 0
    v_lshlrev_b32 v254, 4, v197
    v_mov_b32 v13, 1073741824
    s_cmp_eq_u32 s44, 0
    s_cbranch_scc0 Lpf_1
    s_getpc_b64 s[84:85]
Lpf_1_pc:
    s_sub_u32 s84, s84, Lpf_1_pc-interleave_layers__sliding_local_dilated__linear_kernel_hedgehog__prompt_kernel
    s_subb_u32 s85, s85, 0
    s_lshr_b32 s86, s2, 3
    s_and_b32 s86, s86, 31
    s_lshl_b32 s86, s86, 10
    v_add_u32 v116, s86, v254
    v_min_u32 v116, L_PF1-(interleave_layers__sliding_local_dilated__linear_kernel_hedgehog__prompt_kernel)-16, v116
    v_add_u32 v116, interleave_layers__sliding_local_dilated__linear_kernel_hedgehog__prompt_kernel-interleave_layers__sliding_local_dilated__linear_kernel_hedgehog__prompt_kernel, v116
    v_mov_b32 v117, s85
    v_add_co_u32 v116, vcc, s84, v116
    s_nop 1
    v_addc_co_u32 v117, vcc, 0, v117, vcc
    global_load_dwordx4 a[252:255], v[116:117], off
Lpf_1:
    s_waitcnt lgkmcnt(0)
    s_mov_b32 s47, 0
    s_mov_b32 s20, s56
    s_mov_b32 s21, s57
    s_mov_b32 s22, 2359296
    s_mov_b32 s23, 0x20000
    s_mov_b32 s24, s72
    s_mov_b32 s25, s73
    s_mov_b32 s26, 268435456
    s_mov_b32 s27, 0x20000
    s_mov_b32 s4, s58
    s_mov_b32 s5, s59
    s_mov_b32 s6, 1990656
    s_mov_b32 s7, 0x20000
    s_mov_b32 s12, s60
    s_mov_b32 s13, s61
    s_mov_b32 s14, 663552
    s_mov_b32 s15, 0x20000
    s_mov_b32 s58, 9453568
    buffer_load_dword v11, v255, s[24:27], s58 offen sc1
    s_lshl_b32 s3, s45, 7
    s_lshl_b32 s56, s49, 6
    s_add_u32 s56, s56, s3
    s_lshl_b32 s57, s44, 4
    s_add_u32 s56, s56, s57
    v_add_u32 v14, s56, v198
    v_mul_u32_u24 v14, 1152, v14
    s_mul_i32 s57, s50, 144
    v_add_u32 v14, s57, v14
    v_and_b32 v17, 1, v199
    v_lshrrev_b32 v18, 1, v199
    v_lshl_add_u32 v15, v17, 5, v14
    v_lshl_add_u32 v15, v18, 4, v15
    v_lshl_add_u32 v17, v199, 3, v14
    v_add_u32 v17, 128, v17
    v_cmp_gt_u32 vcc, 2, v199
    s_nop 1
    v_cndmask_b32 v16, v13, v17, vcc
    buffer_load_dwordx4 v[200:203], v15, s[20:23], 0 offen
    buffer_load_dwordx4 v[204:207], v15, s[20:23], 0 offen offset:64
    buffer_load_dwordx2 v[208:209], v16, s[20:23], 0 offen
    s_mov_b32 s8, s64
    s_mov_b32 s9, s65
    s_mov_b32 s10, 1990656
    s_mov_b32 s11, 0x20000
    s_mov_b32 s32, s66
    s_mov_b32 s33, s67
    s_mov_b32 s34, 20736
    s_mov_b32 s35, 0x20000
    s_mov_b32 s16, s68
    s_mov_b32 s17, s69
    s_mov_b32 s18, 663552
    s_mov_b32 s19, 0x20000
    s_mov_b32 s28, s70
    s_mov_b32 s29, s71
    s_mov_b32 s30, 2359296
    s_mov_b32 s31, 0x20000
    s_lshl_b32 s89, s44, 10
    s_mov_b32 s43, s2
    s_cmp_lt_u32 s43, 216
    s_cselect_b32 s96, 1, 0
    s_cselect_b32 s56, 108, 36
    s_cselect_b32 s57, 0, 216
    s_sub_u32 s57, s43, s57
    s_cmp_ge_u32 s57, s56
    s_cselect_b32 s97, 1, 0
    s_cselect_b32 s56, s56, 0
    s_sub_u32 s57, s57, s56
    s_mul_i32 s58, s57, 171
    s_lshr_b32 s58, s58, 9
    s_mul_i32 s59, s58, 3
    s_sub_u32 s99, s57, s59
    s_cmp_eq_u32 s96, 1
    s_cselect_b32 s98, s58, s57
    s_mov_b32 s62, 1152
    s_cselect_b32 s62, 3456, s62
    s_cselect_b32 s56, s4, s12
    s_cselect_b32 s57, s5, s13
    s_cselect_b32 s58, s8, s16
    s_cselect_b32 s59, s9, s17
    s_cselect_b32 s22, s6, s14
    s_cselect_b32 s60, s99, 0
    s_cmp_eq_u32 s97, 1
    s_cselect_b32 s20, s58, s56
    s_cselect_b32 s21, s59, s57
    s_mul_i32 s61, s98, s62
    s_lshl_b32 s61, s61, 4
    s_mul_i32 s60, s60, 1152
    s_add_u32 s61, s61, s60
    v_lshrrev_b32 v3, 3, v197
    v_and_b32 v4, 7, v197
    v_lshlrev_b32 v4, 4, v4
    s_lshl_b32 s56, s44, 3
    v_add_u32 v3, s56, v3
    v_mul_u32_u24 v5, 57, v3
    v_lshrrev_b32 v5, 9, v5
    v_mul_u32_u24 v6, 9, v5
    v_sub_u32 v6, v3, v6
    v_mul_lo_u32 v5, v5, s62
    v_lshl_add_u32 v5, v6, 7, v5
    v_add_u32 v120, v5, v4
    v_add_u32 v3, 32, v3
    v_mul_u32_u24 v5, 57, v3
    v_lshrrev_b32 v5, 9, v5
    v_mul_u32_u24 v6, 9, v5
    v_sub_u32 v6, v3, v6
    v_mul_lo_u32 v5, v5, s62
    v_lshl_add_u32 v5, v6, 7, v5
    v_add_u32 v121, v5, v4
    v_add_u32 v3, 32, v3
    v_mul_u32_u24 v5, 57, v3
    v_lshrrev_b32 v5, 9, v5
    v_mul_u32_u24 v6, 9, v5
    v_sub_u32 v6, v3, v6
    v_mul_lo_u32 v5, v5, s62
    v_lshl_add_u32 v5, v6, 7, v5
    v_add_u32 v122, v5, v4
    v_add_u32 v3, 32, v3
    v_mul_u32_u24 v5, 57, v3
    v_lshrrev_b32 v5, 9, v5
    v_mul_u32_u24 v6, 9, v5
    v_sub_u32 v6, v3, v6
    v_mul_lo_u32 v5, v5, s62
    v_lshl_add_u32 v5, v6, 7, v5
    v_add_u32 v123, v5, v4
    v_add_u32 v3, 32, v3
    v_mul_u32_u24 v5, 57, v3
    v_lshrrev_b32 v5, 9, v5
    v_mul_u32_u24 v6, 9, v5
    v_sub_u32 v6, v3, v6
    v_mul_lo_u32 v5, v5, s62
    v_lshl_add_u32 v5, v6, 7, v5
    v_add_u32 v124, v5, v4
    s_mov_b32 s88, s61
    s_cmp_ge_u32 s44, 2
    s_cselect_b64 vcc, -1, 0
    v_cndmask_b32 v124, v124, v13, vcc
    s_lshr_b32 s56, s2, 3
    s_add_u32 s56, s56, 4
    s_mul_i32 s56, s56, 18432
    s_and_b32 s57, s2, 7
    s_mul_i32 s57, s57, 144
    s_add_u32 s90, s56, s57
    s_lshl_b32 s57, s44, 6
    v_add_u32 v3, s57, v197
    v_mul_u32_u24 v5, 57, v3
    v_lshrrev_b32 v5, 9, v5
    v_mul_u32_u24 v6, 9, v5
    v_sub_u32 v6, v3, v6
    v_mul_u32_u24 v5, 1152, v5
    v_lshl_add_u32 v5, v6, 4, v5
    v_cmp_gt_u32 vcc, 144, v3
    s_nop 1
    v_cndmask_b32 v119, v13, v5, vcc
    s_cmp_lt_u32 s43, 108
    s_cbranch_scc0 Lnc0_2
    s_add_u32 m0, s89, 0
    s_nop 0
    buffer_load_dwordx4 v120, s[20:23], s88 offen lds
    s_add_u32 m0, s89, 4096
    s_nop 0
    buffer_load_dwordx4 v121, s[20:23], s88 offen lds
    s_add_u32 m0, s89, 8192
    s_nop 0
    buffer_load_dwordx4 v122, s[20:23], s88 offen lds
    s_add_u32 m0, s89, 12288
    s_nop 0
    buffer_load_dwordx4 v123, s[20:23], s88 offen lds
    s_add_u32 s56, s89, 16384
    s_cmp_lt_u32 s44, 2
    s_cselect_b32 m0, s56, 129024
    s_nop 0
    buffer_load_dwordx4 v124, s[20:23], s88 offen lds
    s_add_u32 m0, s89, 18432
    s_nop 0
    buffer_load_dwordx4 v119, s[16:19], s90 offen lds
Lnc0_2:
    s_mul_i32 s57, s46, 1296
    s_mov_b32 m0, 158720
    s_nop 0
    buffer_load_dwordx4 v254, s[32:35], s57 offen lds
    s_add_u32 s57, s57, 1024
    s_mov_b32 m0, 159744
    s_mov_b64 exec, 0x1ffff
    buffer_load_dwordx4 v254, s[32:35], s57 offen lds
    s_mov_b64 exec, -1
    s_mov_b32 s64, -1
    s_mov_b32 s65, 0x0fffffff
    s_mov_b32 s66, 0xfffefffe
    s_mov_b32 s67, 0xfffefffe
    s_mov_b32 s68, 0xffff
    s_mov_b32 s69, 0x0
    s_mov_b32 s70, 0xffff0000
    s_mov_b32 s71, 0x0
    s_mov_b32 s72, 0x0
    s_mov_b32 s73, 0xffff
    s_mov_b32 s74, 0x0
    s_mov_b32 s75, 0xffff0000
    s_lshl_b32 s56, s45, 3
    s_lshl_b32 s57, s49, 2
    s_add_u32 s56, s56, s57
    s_add_u32 s56, s56, s44
    s_mul_i32 s57, s56, 18432
    s_add_u32 s58, s57, 0
    v_add_u32 v187, s58, v254
    s_mul_i32 s58, s50, 2304
    s_add_u32 s58, s58, s57
    s_add_u32 s58, s58, 2359296
    v_lshlrev_b32 v17, 4, v198
    v_add_u32 v17, s58, v17
    v_and_b32 v18, 1, v199
    v_lshlrev_b32 v18, 9, v18
    v_lshrrev_b32 v19, 1, v199
    v_lshlrev_b32 v19, 8, v19
    v_add3_u32 v191, v17, v18, v19
    v_lshl_add_u32 v18, v199, 3, v17
    v_add_u32 v18, 2048, v18
    v_cmp_gt_u32 vcc, 2, v199
    s_nop 1
    v_cndmask_b32 v192, v13, v18, vcc
    s_lshl_b32 s58, s56, 10
    s_lshr_b32 s59, s50, 1
    s_lshl_b32 s59, s59, 8
    s_add_u32 s58, s58, s59
    s_and_b32 s59, s50, 1
    s_lshl_b32 s59, s59, 3
    s_add_u32 s58, s58, s59
    s_add_u32 s58, s58, 4718592
    v_lshlrev_b32 v18, 4, v198
    v_lshl_add_u32 v18, v199, 2, v18
    v_add_u32 v18, s58, v18
    v_cndmask_b32 v193, v13, v18, vcc
    s_add_u32 s58, s45, 1
    s_mul_i32 s59, s58, 18432
    s_add_u32 s59, s59, 2490368
    s_sub_u32 s38, s59, s57
    s_lshl_b32 s59, s58, 10
    s_add_u32 s59, s59, 720896
    s_lshl_b32 s57, s56, 10
    s_sub_u32 s39, s59, s57
    s_lshl_b32 s40, s58, 7
    s_lshl_b32 s59, s50, 3
    s_add_u32 s40, s40, s59
    s_add_u32 s40, s40, 9445376
    s_cmp_lt_u32 s45, 15
    s_cselect_b32 s87, s49, 0
    s_mul_i32 s58, s45, 18432
    s_add_u32 s58, s58, 4849664
    s_lshl_b32 s59, s45, 10
    s_add_u32 s59, s59, 5439488
    s_cmp_eq_u32 s45, 0
    s_cselect_b32 s36, 2359296, s58
    s_cselect_b32 s37, 4718592, s59
    s_lshl_b32 s56, s45, 3
    s_lshl_b32 s57, s44, 1
    s_add_u32 s56, s56, s57
    s_mul_i32 s57, s56, 18432
    s_add_u32 s58, s57, 2359296
    v_add_u32 v176, s58, v254
    s_lshl_b32 s58, s56, 10
    s_add_u32 s58, s58, 4718592
    v_add_u32 v194, s58, v254
    s_mul_i32 s58, s46, 9
    s_add_u32 s59, s57, 0
    v_lshlrev_b32 v17, 4, v198
    v_add_u32 v17, s59, v17
    v_add_u32 v18, s58, v199
    v_lshrrev_b32 v19, 1, v18
    v_lshlrev_b32 v19, 8, v19
    v_and_b32 v18, 1, v18
    v_lshlrev_b32 v18, 3, v18
    v_add3_u32 v188, v17, v18, v19
    v_add_u32 v18, s58, v199
    v_add_u32 v18, 5, v18
    v_lshrrev_b32 v19, 1, v18
    v_lshlrev_b32 v19, 8, v19
    v_and_b32 v18, 1, v18
    v_lshlrev_b32 v18, 3, v18
    v_add3_u32 v189, v17, v18, v19
    s_add_u32 s58, s58, 4
    s_lshr_b32 s60, s58, 1
    s_lshl_b32 s60, s60, 8
    s_and_b32 s58, s58, 1
    s_lshl_b32 s58, s58, 3
    s_add_u32 s58, s58, s60
    v_add_u32 v18, s58, v17
    v_cndmask_b32 v190, v13, v18, s[68:69]
    s_mov_b32 s77, 18432
    s_mov_b32 s76, 0x3f803f80
    s_mov_b32 s78, 0x3fb8aa3b
    s_mov_b32 s79, 0x3fb8aa3b
    s_mov_b32 s80, 0x3eae1a93
    s_mov_b32 s81, 0x3eae1a93
    s_mov_b32 s91, 0x358637bd
    s_mov_b32 s51, 0
    s_mov_b32 s41, 0
    v_lshrrev_b32 v1, 2, v198
    v_and_b32 v2, 3, v197
    v_mov_b32 v10, s76
    v_accvgpr_write_b32 a232, v10
    v_accvgpr_write_b32 a233, v10
    v_accvgpr_write_b32 a234, v10
    v_accvgpr_write_b32 a235, v10
    v_mov_b32 v177, v254
    v_add_u32 v178, 64512, v254
    s_add_u32 s56, s89, 2048
    v_add_u32 v179, s56, v254
    v_add_u32 v180, 64512, v179
    s_cmp_lt_u32 s44, 2
    s_cselect_b32 s56, s89, 6144
    v_add_u32 v185, s56, v254
    v_add_u32 v186, 64512, v185
    v_add_u32 v181, 0, v254
    v_add_u32 v182, 41472, v254
    v_and_b32 v26, 7, v197
    v_lshl_add_u32 v26, v199, 3, v26
    v_lshlrev_b32 v26, 4, v26
    v_add_u32 v183, 4096, v26
    v_add_u32 v184, 45568, v26
    s_cmp_eq_u32 s44, 0
    s_cselect_b32 s93, 0, 1024
    s_add_u32 s93, s93, 81920
    v_and_b32 v24, 1, v199
    v_lshrrev_b32 v25, 1, v199
    v_lshl_add_u32 v26, v24, 3, v1
    v_mul_u32_u24 v26, 1152, v26
    s_mul_i32 s56, s44, 288
    v_lshl_add_u32 v27, v2, 3, v26
    v_add_u32 v27, s56, v27
    v_mul_u32_u24 v28, 40, v25
    v_add_u32 v168, v27, v28
    v_lshl_add_u32 v169, v25, 5, v27
    v_and_b32 v28, 31, v197
    v_lshlrev_b32 v28, 4, v28
    v_lshl_add_u32 v170, v25, 10, v28
    s_and_b32 s56, s44, 1
    s_lshl_b32 s56, s56, 1
    v_add_u32 v28, s56, v25
    v_lshl_add_u32 v29, v28, 2, v2
    v_mul_u32_u24 v29, 72, v29
    v_add_u32 v29, 32, v29
    v_add_u32 v171, v26, v29
    v_lshrrev_b32 v29, 1, v2
    v_lshl_add_u32 v29, v28, 1, v29
    v_mul_u32_u24 v29, 144, v29
    v_and_b32 v21, 1, v2
    v_lshl_add_u32 v29, v21, 3, v29
    v_add_u32 v29, 128, v29
    v_add_u32 v125, v26, v29
    v_lshl_add_u32 v29, v28, 2, v1
    s_mov_b32 s57, 129024
    v_mul_lo_u32 v29, v29, s57
    v_lshl_add_u32 v21, v24, 4, v2
    v_lshl_add_u32 v126, v21, 4, v29
    v_lshrrev_b32 v29, 3, v198
    v_lshl_add_u32 v29, v28, 1, v29
    s_mov_b32 s57, 82944
    v_mul_lo_u32 v29, v29, s57
    v_and_b32 v21, 7, v198
    v_lshl_add_u32 v21, v24, 3, v21
    v_lshl_add_u32 v127, v21, 4, v29
    s_lshl_b32 s56, s44, 5
    v_add_u32 v26, s56, v198
    v_mul_u32_u24 v27, 168, v26
    v_lshl_add_u32 v28, v199, 3, v27
    v_add_u32 v225, 138240, v28
    v_add_u32 v223, 140928, v28
    v_add_u32 v226, 138376, v27
    v_mul_u32_u24 v27, 168, v198
    v_lshl_add_u32 v27, v199, 3, v27
    s_lshl_b32 s57, s44, 5
    s_add_u32 s57, s57, 138240
    v_add_u32 v224, s57, v27
    v_lshl_add_u32 v27, v199, 2, v1
    v_add_u32 v27, s56, v27
    v_mul_u32_u24 v27, 168, v27
    v_add_u32 v228, 138384, v27
    v_lshl_add_u32 v27, v2, 3, v27
    v_add_u32 v227, 138304, v27
    v_cndmask_b32 v222, 0, -1, s[68:69]
    v_lshlrev_b32 v27, 2, v199
    v_sub_u32 v27, v198, v27
    v_mov_b32 v28, 0xf149f2ca
    v_subrev_u32 v29, 0, v27
    v_and_b32 v21, 1, v29
    v_cmp_eq_u32 s[60:61], 0, v21
    v_cmp_le_i32 vcc, 0, v29
    s_and_b64 vcc, vcc, s[60:61]
    s_nop 0
    v_cndmask_b32 v218, v28, v255, vcc
    v_cmp_ge_i32 vcc, -2, v29
    s_and_b64 vcc, vcc, s[60:61]
    s_nop 0
    v_cndmask_b32 v214, v28, v255, vcc
    v_subrev_u32 v29, 1, v27
    v_and_b32 v21, 1, v29
    v_cmp_eq_u32 s[60:61], 0, v21
    v_cmp_le_i32 vcc, 0, v29
    s_and_b64 vcc, vcc, s[60:61]
    s_nop 0
    v_cndmask_b32 v219, v28, v255, vcc
    v_cmp_ge_i32 vcc, -2, v29
    s_and_b64 vcc, vcc, s[60:61]
    s_nop 0
    v_cndmask_b32 v215, v28, v255, vcc
    v_subrev_u32 v29, 2, v27
    v_and_b32 v21, 1, v29
    v_cmp_eq_u32 s[60:61], 0, v21
    v_cmp_le_i32 vcc, 0, v29
    s_and_b64 vcc, vcc, s[60:61]
    s_nop 0
    v_cndmask_b32 v220, v28, v255, vcc
    v_cmp_ge_i32 vcc, -2, v29
    s_and_b64 vcc, vcc, s[60:61]
    s_nop 0
    v_cndmask_b32 v216, v28, v255, vcc
    v_subrev_u32 v29, 3, v27
    v_and_b32 v21, 1, v29
    v_cmp_eq_u32 s[60:61], 0, v21
    v_cmp_le_i32 vcc, 0, v29
    s_and_b64 vcc, vcc, s[60:61]
    s_nop 0
    v_cndmask_b32 v221, v28, v255, vcc
    v_cmp_ge_i32 vcc, -2, v29
    s_and_b64 vcc, vcc, s[60:61]
    s_nop 0
    v_cndmask_b32 v217, v28, v255, vcc
    s_or_b32 s56, s45, s44
    s_cmp_eq_u32 s56, 0
    s_cselect_b64 vcc, -1, 0
    v_cndmask_b32 v210, v214, v28, vcc
    v_cndmask_b32 v211, v215, v28, vcc
    v_cndmask_b32 v212, v216, v28, vcc
    v_cndmask_b32 v213, v217, v28, vcc
    s_cmp_lt_u32 s43, 108
    s_cbranch_scc1 Lnc1_3
    s_add_u32 m0, s89, 0
    s_nop 0
    buffer_load_dwordx4 v120, s[20:23], s88 offen lds
    s_add_u32 m0, s89, 4096
    s_nop 0
    buffer_load_dwordx4 v121, s[20:23], s88 offen lds
    s_add_u32 m0, s89, 8192
    s_nop 0
    buffer_load_dwordx4 v122, s[20:23], s88 offen lds
    s_add_u32 m0, s89, 12288
    s_nop 0
    buffer_load_dwordx4 v123, s[20:23], s88 offen lds
    s_add_u32 s56, s89, 16384
    s_cmp_lt_u32 s44, 2
    s_cselect_b32 m0, s56, 129024
    s_nop 0
    buffer_load_dwordx4 v124, s[20:23], s88 offen lds
    s_add_u32 m0, s89, 18432
    s_nop 0
    buffer_load_dwordx4 v119, s[16:19], s90 offen lds
Lnc1_3:
    s_waitcnt vmcnt(8)
    v_readfirstlane_b32 s48, v11
    s_add_u32 s48, s48, 9
    v_mov_b32 v100, v200
    v_mov_b32 v101, v201
    v_mov_b32 v102, v202
    v_mov_b32 v103, v203
    v_mov_b32 v104, v204
    v_mov_b32 v105, v205
    v_mov_b32 v106, v206
    v_mov_b32 v107, v207
    v_mov_b32 v108, v208
    v_mov_b32 v109, v209
    v_permlane16_swap_b32 v100, v102
    v_permlane16_swap_b32 v101, v103
    v_permlane16_swap_b32 v104, v106
    v_permlane16_swap_b32 v105, v107
    v_lshlrev_b32 v0, 16, v100
    v_and_b32 v1, 0xffff0000, v100
    v_lshlrev_b32 v2, 16, v101
    v_and_b32 v3, 0xffff0000, v101
    v_lshlrev_b32 v4, 16, v102
    v_and_b32 v5, 0xffff0000, v102
    v_lshlrev_b32 v6, 16, v103
    v_and_b32 v7, 0xffff0000, v103
    v_lshlrev_b32 v8, 16, v104
    v_and_b32 v9, 0xffff0000, v104
    v_lshlrev_b32 v10, 16, v105
    v_and_b32 v11, 0xffff0000, v105
    v_lshlrev_b32 v12, 16, v106
    v_and_b32 v13, 0xffff0000, v106
    v_lshlrev_b32 v14, 16, v107
    v_and_b32 v15, 0xffff0000, v107
    v_lshlrev_b32 v16, 16, v108
    v_and_b32 v17, 0xffff0000, v108
    v_lshlrev_b32 v18, 16, v109
    v_and_b32 v19, 0xffff0000, v109
    s_mov_b32 s47, -1
    s_lshl_b32 s92, s47, 3
    s_add_u32 s92, s92, s48
    s_add_u32 s92, s92, 5
    s_lshl_b32 s92, s92, 3
    s_or_b32 s92, s92, s42
    v_cvt_pk_bf16_f32 v200, v0, v1
    v_cvt_pk_bf16_f32 v201, v2, v3
    v_cvt_pk_bf16_f32 v202, v4, v5
    v_cvt_pk_bf16_f32 v203, v6, v7
    v_cvt_pk_bf16_f32 v204, v8, v9
    v_cvt_pk_bf16_f32 v205, v10, v11
    v_cvt_pk_bf16_f32 v206, v12, v13
    v_cvt_pk_bf16_f32 v207, v14, v15
    v_cvt_pk_bf16_f32 v208, v16, v17
    v_cvt_pk_bf16_f32 v209, v18, v19
    v_permlane16_swap_b32 v200, v202
    v_permlane16_swap_b32 v201, v203
    v_permlane16_swap_b32 v204, v206
    v_permlane16_swap_b32 v205, v207
    buffer_store_dwordx4 v[200:203], v191, s[24:27], 0 offen sc1
    buffer_store_dwordx4 v[204:207], v191, s[24:27], 0 offen offset:1024 sc1
    buffer_store_dwordx2 v[208:209], v192, s[24:27], 0 offen sc1
    v_pk_add_f32 v[56:57], v[0:1], v[2:3]
    v_pk_mul_f32 v[58:59], v[0:1], v[0:1]
    v_pk_fma_f32 v[58:59], v[2:3], v[2:3], v[58:59]
    v_pk_add_f32 v[56:57], v[56:57], v[4:5]
    v_pk_fma_f32 v[58:59], v[4:5], v[4:5], v[58:59]
    v_pk_add_f32 v[56:57], v[56:57], v[6:7]
    v_pk_fma_f32 v[58:59], v[6:7], v[6:7], v[58:59]
    v_pk_add_f32 v[56:57], v[56:57], v[8:9]
    v_pk_fma_f32 v[58:59], v[8:9], v[8:9], v[58:59]
    v_pk_add_f32 v[56:57], v[56:57], v[10:11]
    v_pk_fma_f32 v[58:59], v[10:11], v[10:11], v[58:59]
    v_pk_add_f32 v[56:57], v[56:57], v[12:13]
    v_pk_fma_f32 v[58:59], v[12:13], v[12:13], v[58:59]
    v_pk_add_f32 v[56:57], v[56:57], v[14:15]
    v_pk_fma_f32 v[58:59], v[14:15], v[14:15], v[58:59]
    s_mov_b32 exec_hi, 0
    v_pk_add_f32 v[56:57], v[56:57], v[16:17]
    v_pk_fma_f32 v[58:59], v[16:17], v[16:17], v[58:59]
    v_pk_add_f32 v[56:57], v[56:57], v[18:19]
    v_pk_fma_f32 v[58:59], v[18:19], v[18:19], v[58:59]
    s_mov_b32 exec_hi, -1
    v_add_f32 v56, v56, v57
    v_add_f32 v57, v58, v59
    s_nop 1
    v_permlane16_swap_b32 v56, v57
    v_add_f32 v56, v56, v57
    v_mov_b32 v58, v56
    s_nop 1
    v_permlane32_swap_b32 v56, v58
    v_add_f32 v56, v56, v58
    buffer_store_dword v56, v193, s[24:27], 0 offen sc1
    s_cmp_eq_u32 s44, 3
    s_cselect_b32 s56, s87, 0
    s_cmp_eq_u32 s56, 0
    s_cbranch_scc1 Lhx_4
    v_add_u32 v60, s38, v191
    v_add_u32 v61, s38, v192
    v_add_u32 v62, s39, v193
    buffer_store_dwordx4 v[200:203], v60, s[24:27], 0 offen sc1
    buffer_store_dwordx4 v[204:207], v60, s[24:27], 0 offen offset:1024 sc1
    buffer_store_dwordx2 v[208:209], v61, s[24:27], 0 offen sc1
    buffer_store_dword v56, v62, s[24:27], 0 offen sc1
Lhx_4:
    s_cmp_lt_u32 s43, 108
    s_cbranch_scc1 Lc1_5
    s_waitcnt vmcnt(0)
    s_barrier
    s_cmp_eq_u32 s44, 0
    s_cbranch_scc0 Lw0_7
    s_mul_i32 s59, s45, 256
    s_lshl_b32 s60, s46, 2
    s_add_u32 s59, s59, s60
    s_add_u32 s59, s59, 9502720
    v_mov_b32 v173, s92
    v_lshlrev_b32 v174, 12, v197
    s_mov_b64 exec, 255
    buffer_store_dword v173, v174, s[24:27], s59 offen sc1
    s_mov_b64 exec, -1
Lw0_7:
    s_nop 0
    s_branch Lc2_6
Lc1_5:
    s_waitcnt vmcnt(4)
    s_barrier
Lc2_6:
    s_cmp_eq_u32 s96, 1
    s_cbranch_scc0 Lb0_9
    ds_read_b64_tr_b16 v[128:129], v168 offset:0
    ds_read_b64_tr_b16 v[130:131], v168 offset:4608
    ds_read_b64_tr_b16 v[132:133], v168 offset:72
    ds_read_b64_tr_b16 v[134:135], v168 offset:4680
    ds_read_b64_tr_b16 v[136:137], v168 offset:144
    ds_read_b64_tr_b16 v[138:139], v168 offset:4752
    ds_read_b64_tr_b16 v[140:141], v168 offset:216
    ds_read_b64_tr_b16 v[142:143], v168 offset:4824
    ds_read_b64_tr_b16 v[144:145], v171 offset:0
    ds_read_b64_tr_b16 v[146:147], v171 offset:4608
    s_lshr_b32 s57, s98, 1
    s_and_b32 s58, s98, 1
    s_mul_i32 s56, s97, 2064384
    s_add_u32 s56, s56, 10485760
    s_mul_i32 s57, s57, 7168
    s_add_u32 s56, s56, s57
    s_lshl_b32 s59, s58, 9
    s_add_u32 s56, s56, s59
    s_mul_i32 s59, s44, 516096
    s_lshl_b32 s60, s99, 11
    s_add_u32 s59, s59, s60
    s_add_u32 s59, s59, s56
    s_lshl_b32 s60, s99, 6
    s_add_u32 s60, s60, s56
    s_add_u32 s60, s60, 6144
    s_waitcnt lgkmcnt(0)
    s_add_u32 s57, s59, 0
    buffer_store_dwordx4 v[128:131], v170, s[24:27], s57 offen sc1
    s_add_u32 s57, s59, 129024
    buffer_store_dwordx4 v[132:135], v170, s[24:27], s57 offen sc1
    s_add_u32 s57, s59, 258048
    buffer_store_dwordx4 v[136:139], v170, s[24:27], s57 offen sc1
    s_add_u32 s57, s59, 387072
    buffer_store_dwordx4 v[140:143], v170, s[24:27], s57 offen sc1
    s_cmp_lt_u32 s44, 2
    s_cbranch_scc0 Lbt_11
    buffer_store_dwordx4 v[144:147], v126, s[24:27], s60 offen sc1
    s_cmp_eq_u32 s99, 0
    s_cbranch_scc0 Lbt_11
    buffer_store_dwordx4 v[144:147], v126, s[24:27], s60 offen offset:192 sc1
Lbt_11:
    s_branch Lb1_10
Lb0_9:
    ds_read_b64_tr_b16 v[128:129], v169 offset:0
    ds_read_b64_tr_b16 v[130:131], v169 offset:4608
    ds_read_b64_tr_b16 v[132:133], v169 offset:64
    ds_read_b64_tr_b16 v[134:135], v169 offset:4672
    ds_read_b64_tr_b16 v[136:137], v169 offset:144
    ds_read_b64_tr_b16 v[138:139], v169 offset:4752
    ds_read_b64_tr_b16 v[140:141], v169 offset:208
    ds_read_b64_tr_b16 v[142:143], v169 offset:4816
    ds_read_b64_tr_b16 v[144:145], v125 offset:0
    ds_read_b64_tr_b16 v[146:147], v125 offset:4608
    s_lshr_b32 s57, s98, 1
    s_and_b32 s58, s98, 1
    s_mul_i32 s56, s97, 663552
    s_add_u32 s56, s56, 14680064
    s_mul_i32 s57, s57, 4608
    s_add_u32 s56, s56, s57
    s_lshl_b32 s59, s58, 8
    s_add_u32 s60, s56, s59
    s_add_u32 s60, s60, 4096
    s_lshl_b32 s59, s58, 9
    s_add_u32 s56, s56, s59
    s_mul_i32 s59, s44, 165888
    s_add_u32 s59, s59, s56
    s_waitcnt lgkmcnt(0)
    s_add_u32 s57, s59, 0
    buffer_store_dwordx4 v[128:131], v170, s[24:27], s57 offen sc1
    s_add_u32 s57, s59, 2048
    buffer_store_dwordx4 v[132:135], v170, s[24:27], s57 offen sc1
    s_add_u32 s57, s59, 82944
    buffer_store_dwordx4 v[136:139], v170, s[24:27], s57 offen sc1
    s_add_u32 s57, s59, 84992
    buffer_store_dwordx4 v[140:143], v170, s[24:27], s57 offen sc1
    s_cmp_lt_u32 s44, 2
    s_cbranch_scc0 Lbt_12
    buffer_store_dwordx4 v[144:147], v127, s[24:27], s60 offen sc1
Lbt_12:
Lb1_10:
    s_cmp_lt_u32 s43, 108
    s_cbranch_scc0 Lc3_13
    s_waitcnt vmcnt(0)
    s_barrier
    s_cmp_eq_u32 s44, 0
    s_cbranch_scc0 Lw0_14
    s_mul_i32 s59, s45, 256
    s_lshl_b32 s60, s46, 2
    s_add_u32 s59, s59, s60
    s_add_u32 s59, s59, 9502720
    v_mov_b32 v173, s92
    v_lshlrev_b32 v174, 12, v197
    s_mov_b64 exec, 255
    buffer_store_dword v173, v174, s[24:27], s59 offen sc1
    s_mov_b64 exec, -1
Lw0_14:
    s_nop 0
Lc3_13:
    s_nop 0
    v_lshrrev_b32 v1, 2, v198
    v_and_b32 v2, 3, v197
    v_lshl_add_u32 v26, v24, 3, v1
    v_mul_u32_u24 v26, 144, v26
    v_lshl_add_u32 v27, v2, 3, v26
    v_lshl_add_u32 v27, v25, 5, v27
    s_lshl_b32 s56, s44, 6
    v_add_u32 v27, s56, v27
    v_and_b32 v28, 1, v2
    v_lshl_add_u32 v28, v28, 3, v26
    v_add_u32 v28, 128, v28
    s_cmp_lt_u32 s44, 2
    s_cselect_b64 vcc, -1, 0
    v_cndmask_b32 v27, v28, v27, vcc
    ds_read_b64_tr_b16 v[148:149], v27 offset:18432
    ds_read_b64_tr_b16 v[150:151], v27 offset:19008
    s_lshr_b32 s56, s2, 3
    s_add_u32 s56, s56, 4
    s_and_b32 s58, s56, 1
    s_lshr_b32 s56, s56, 1
    s_mul_i32 s56, s56, 4608
    s_and_b32 s57, s2, 7
    s_add_u32 s57, s57, 8
    s_mul_i32 s57, s57, 82944
    s_add_u32 s56, s56, s57
    s_add_u32 s56, s56, 14680064
    s_lshl_b32 s59, s58, 9
    s_lshl_b32 s60, s44, 11
    s_add_u32 s59, s59, s60
    s_lshl_b32 s60, s58, 8
    s_add_u32 s60, s60, 4096
    s_cmp_lt_u32 s44, 2
    s_cselect_b32 s59, s59, s60
    s_add_u32 s56, s56, s59
    v_and_b32 v28, 7, v198
    v_lshl_add_u32 v28, v24, 3, v28
    v_lshlrev_b32 v28, 4, v28
    v_mov_b32 v29, 1073741824
    s_mov_b32 s60, 0x00ff00ff
    s_cmp_eq_u32 s44, 2
    s_cselect_b32 s60, s60, 0
    s_mov_b32 s61, 0
    v_cndmask_b32 v28, v29, v28, s[60:61]
    v_cndmask_b32 v28, v28, v170, vcc
    s_waitcnt lgkmcnt(0)
    buffer_store_dwordx4 v[148:151], v28, s[24:27], s56 offen sc1
    s_mul_i32 s8, s46, 129024
    s_add_u32 s8, s8, s89
    s_add_u32 s8, s8, 10485760
    s_add_u32 s9, s8, 2064384
    s_mul_i32 s10, s50, 82944
    s_add_u32 s10, s10, s89
    s_add_u32 s10, s10, 14680064
    s_add_u32 s11, s10, 663552
    s_add_u32 s56, s89, 126976
    s_mov_b32 s57, 129024
    s_cmp_lt_u32 s44, 2
    s_cselect_b32 s12, s56, s57
    s_cselect_b32 s13, 126976, 0
    s_cmp_eq_u32 s44, 0
    s_cselect_b32 s14, 81920, 0
    s_mov_b32 s4, s24
    s_mov_b32 s5, s25
    s_mov_b32 s6, s26
    s_mov_b32 s7, s27
    s_lshl_b32 s56, s44, 5
    v_add_u32 v26, s56, v198
    v_mul_u32_u24 v26, 248, v26
    v_lshl_add_u32 v229, v199, 3, v26
    v_add_u32 v229, 86016, v229
    v_lshrrev_b32 v27, 1, v199
    v_lshlrev_b32 v27, 4, v27
    v_add_u32 v27, v27, v198
    v_add_u32 v27, s56, v27
    v_mul_u32_u24 v27, 248, v27
    v_and_b32 v28, 1, v199
    v_lshl_add_u32 v27, v28, 3, v27
    v_add_u32 v230, 86144, v27
    v_lshrrev_b32 v1, 2, v198
    v_and_b32 v2, 3, v197
    v_mov_b32 v13, 1073741824
    v_and_b32 v27, 1, v199
    v_lshlrev_b32 v27, 4, v27
    v_lshl_add_u32 v27, v1, 2, v27
    v_lshrrev_b32 v28, 1, v199
    v_lshl_add_u32 v27, v28, 1, v27
    v_mul_u32_u24 v27, 248, v27
    v_add_u32 v27, 86016, v27
    s_lshr_b32 s56, s44, 1
    s_and_b32 s57, s44, 1
    s_lshl_b32 s58, s56, 6
    v_lshl_add_u32 v28, v2, 3, v27
    v_add_u32 v248, s58, v28
    s_lshl_b32 s58, s56, 3
    s_add_u32 s58, s58, 128
    v_add_u32 v249, s58, v27
    s_lshl_b32 s58, s56, 5
    s_add_u32 s58, s58, 144
    v_add_u32 v28, s58, v28
    v_cmp_eq_u32 vcc, 0, v2
    v_mov_b32 v29, 232
    v_mov_b32 v21, 224
    v_cndmask_b32 v29, v29, v21, vcc
    v_add_u32 v29, v29, v27
    s_cmp_eq_u32 s57, 0
    s_cselect_b64 vcc, -1, 0
    v_cndmask_b32 v250, v29, v28, vcc
    v_mul_u32_u24 v27, 5, v199
    v_add_u32 v27, v27, v198
    v_lshlrev_b32 v27, 4, v27
    v_add_u32 v27, 1152, v27
    v_cmp_gt_u32 s[60:61], 5, v198
    s_nop 1
    v_cndmask_b32 v27, v13, v27, s[60:61]
    v_cndmask_b32 v251, v27, v254, vcc
    s_mul_i32 s58, s56, 1536
    v_add_u32 v251, s58, v251
    v_lshlrev_b32 v28, 3, v198
    v_add_u32 v29, 1472, v28
    v_cndmask_b32 v29, v13, v29, s[60:61]
    v_add_u32 v28, 1024, v28
    v_cndmask_b32 v28, v29, v28, vcc
    v_add_u32 v28, s58, v28
    v_cndmask_b32 v253, v13, v28, s[68:69]
    s_lshl_b32 s56, s45, 7
    s_add_u32 s58, s56, 9437184
    s_lshl_b32 s57, s46, 3
    s_add_u32 s52, s58, s57
    v_lshlrev_b32 v26, 3, v197
    v_add_u32 v195, s58, v26
    s_add_u32 s58, s56, 9445248
    v_add_u32 v27, s58, v26
    v_cmp_lt_u32 vcc, 15, v197
    s_nop 1
    v_cndmask_b32 v195, v195, v27, vcc
    s_lshl_b32 s56, s46, 7
    s_add_u32 s56, s56, 9441280
    s_lshl_b32 s57, s45, 3
    s_add_u32 s53, s56, s57
    v_add_u32 v196, s56, v26
    s_mov_b32 s56, 0xffffff
    s_cmp_eq_u32 s45, 0
    s_cselect_b32 s54, 0xffff, s56
    s_mov_b32 s55, 0
    s_mul_i32 s83, s46, 49152
    s_add_u32 s83, s83, 5505024
    s_mov_b32 s47, 0
    s_add_u32 s38, s38, 294912
    s_add_u32 s39, s39, 16384
    v_mul_u32_u24 v19, 144, v199
    v_add_u32 v19, 158720, v19
    v_lshl_add_u32 v20, v198, 1, v19
    v_and_b32 v21, 1, v198
    v_lshlrev_b32 v21, 1, v21
    v_add_u32 v21, 158752, v21
    v_subrev_u32 v22, 158720, v21
    v_add_u32 v22, v19, v22
    v_lshlrev_b32 v23, 1, v198
    v_add_u32 v23, 158720, v23
    ds_read_u16 v120, v20 offset:0
    ds_read_u16 v121, v20 offset:36
    ds_read_u16 v122, v20 offset:72
    ds_read_u16 v123, v20 offset:108
    ds_read_u16 v124, v23 offset:576
    ds_read_u16 v125, v23 offset:612
    ds_read_u16 v126, v22 offset:0
    ds_read_u16 v127, v22 offset:36
    ds_read_u16 v128, v22 offset:72
    ds_read_u16 v129, v22 offset:108
    ds_read_u16 v130, v21 offset:576
    ds_read_u16 v131, v21 offset:612
    s_waitcnt lgkmcnt(0)
    ds_read_u16 v132, v20 offset:720
    ds_read_u16 v133, v20 offset:756
    ds_read_u16 v134, v20 offset:792
    ds_read_u16 v135, v20 offset:828
    ds_read_u16 v136, v23 offset:648
    ds_read_u16 v137, v23 offset:684
    ds_read_u16 v138, v22 offset:720
    ds_read_u16 v139, v22 offset:756
    ds_read_u16 v140, v22 offset:792
    ds_read_u16 v141, v22 offset:828
    ds_read_u16 v142, v21 offset:648
    ds_read_u16 v143, v21 offset:684
    s_waitcnt lgkmcnt(0)
    v_lshl_or_b32 v150, v121, 16, v120
    v_lshl_or_b32 v151, v123, 16, v122
    v_lshl_or_b32 v152, v125, 16, v124
    v_lshl_or_b32 v153, v127, 16, v126
    v_lshl_or_b32 v154, v129, 16, v128
    v_lshl_or_b32 v155, v131, 16, v130
    v_lshl_or_b32 v156, v133, 16, v132
    v_lshl_or_b32 v157, v135, 16, v134
    v_lshl_or_b32 v158, v137, 16, v136
    v_lshl_or_b32 v159, v139, 16, v138
    v_lshl_or_b32 v160, v141, 16, v140
    v_lshl_or_b32 v161, v143, 16, v142
    v_cndmask_b32 v26, 0, v152, s[68:69]
    v_accvgpr_write_b32 a216, v150
    v_accvgpr_write_b32 a217, v151
    v_accvgpr_write_b32 a218, v26
    v_accvgpr_write_b32 a219, v255
    v_cndmask_b32 v26, 0, v152, s[70:71]
    v_accvgpr_write_b32 a224, v150
    v_accvgpr_write_b32 a225, v151
    v_accvgpr_write_b32 a226, v26
    v_accvgpr_write_b32 a227, v255
    v_cndmask_b32 v26, 0, v158, s[68:69]
    v_accvgpr_write_b32 a220, v255
    v_accvgpr_write_b32 a221, v26
    v_accvgpr_write_b32 a222, v156
    v_accvgpr_write_b32 a223, v157
    v_cndmask_b32 v26, 0, v158, s[70:71]
    v_accvgpr_write_b32 a228, v255
    v_accvgpr_write_b32 a229, v26
    v_accvgpr_write_b32 a230, v156
    v_accvgpr_write_b32 a231, v157
    v_lshrrev_b32 v27, 1, v198
    v_cmp_eq_u32 vcc, 0, v27
    s_nop 1
    v_cndmask_b32 v28, 0, v153, vcc
    v_cndmask_b32 v29, 0, v154, vcc
    v_cndmask_b32 v21, 0, v155, vcc
    v_cndmask_b32 v26, 0, v21, s[68:69]
    v_mov_b32 v232, v28
    v_mov_b32 v233, v29
    v_mov_b32 v234, v26
    v_mov_b32 v235, v255
    v_cndmask_b32 v26, 0, v21, s[70:71]
    v_accvgpr_write_b32 a236, v28
    v_accvgpr_write_b32 a237, v29
    v_accvgpr_write_b32 a238, v26
    v_accvgpr_write_b32 a239, v255
    v_lshrrev_b32 v27, 1, v198
    v_cmp_eq_u32 vcc, 2, v27
    s_nop 1
    v_cndmask_b32 v28, 0, v159, vcc
    v_cndmask_b32 v29, 0, v160, vcc
    v_cndmask_b32 v21, 0, v161, vcc
    v_cndmask_b32 v26, 0, v21, s[68:69]
    v_mov_b32 v236, v255
    v_mov_b32 v237, v26
    v_mov_b32 v238, v28
    v_mov_b32 v239, v29
    v_cndmask_b32 v26, 0, v21, s[70:71]
    v_accvgpr_write_b32 a240, v255
    v_accvgpr_write_b32 a241, v26
    v_accvgpr_write_b32 a242, v28
    v_accvgpr_write_b32 a243, v29
    v_lshrrev_b32 v27, 1, v198
    v_cmp_eq_u32 vcc, 4, v27
    s_nop 1
    v_cndmask_b32 v28, 0, v153, vcc
    v_cndmask_b32 v29, 0, v154, vcc
    v_cndmask_b32 v21, 0, v155, vcc
    v_cndmask_b32 v26, 0, v21, s[68:69]
    v_mov_b32 v240, v28
    v_mov_b32 v241, v29
    v_mov_b32 v242, v26
    v_mov_b32 v243, v255
    v_cndmask_b32 v26, 0, v21, s[70:71]
    v_accvgpr_write_b32 a244, v28
    v_accvgpr_write_b32 a245, v29
    v_accvgpr_write_b32 a246, v26
    v_accvgpr_write_b32 a247, v255
    v_lshrrev_b32 v27, 1, v198
    v_cmp_eq_u32 vcc, 6, v27
    s_nop 1
    v_cndmask_b32 v28, 0, v159, vcc
    v_cndmask_b32 v29, 0, v160, vcc
    v_cndmask_b32 v21, 0, v161, vcc
    v_cndmask_b32 v26, 0, v21, s[68:69]
    v_mov_b32 v244, v255
    v_mov_b32 v245, v26
    v_mov_b32 v246, v28
    v_mov_b32 v247, v29
    v_cndmask_b32 v26, 0, v21, s[70:71]
    v_accvgpr_write_b32 a248, v255
    v_accvgpr_write_b32 a249, v26
    v_accvgpr_write_b32 a250, v28
    v_accvgpr_write_b32 a251, v29
    s_cmp_eq_u32 s44, 0
    s_cbranch_scc0 Lw0_16
    s_and_b32 s60, s2, 7
    s_lshl_b32 s60, s60, 12
    s_add_u32 s60, s60, 9502720
    v_lshrrev_b32 v171, 2, v197
    v_mul_u32_u24 v171, 256, v171
    v_and_b32 v170, 3, v197
    v_lshl_add_u32 v171, v170, 4, v171
    v_add_u32 v171, s60, v171
    s_mov_b32 s59, 0
Lpa_18:
    buffer_load_dwordx4 v[160:163], v171, s[24:27], 0 offen sc1
    s_waitcnt vmcnt(0)
    s_mov_b64 s[62:63], -1
    v_xor_b32 v168, s92, v160
    v_cmp_gt_u32 vcc, 8, v168
    s_nop 1
    s_and_b64 s[62:63], s[62:63], vcc
    v_xor_b32 v168, s92, v161
    v_cmp_gt_u32 vcc, 8, v168
    s_nop 1
    s_and_b64 s[62:63], s[62:63], vcc
    v_xor_b32 v168, s92, v162
    v_cmp_gt_u32 vcc, 8, v168
    s_nop 1
    s_and_b64 s[62:63], s[62:63], vcc
    v_xor_b32 v168, s92, v163
    v_cmp_gt_u32 vcc, 8, v168
    s_nop 1
    s_and_b64 s[62:63], s[62:63], vcc
    s_cmp_eq_u64 s[62:63], -1
    s_cbranch_scc1 Lpag_19
    s_add_u32 s59, s59, 1
    s_cmp_lt_u32 s59, 20000
    s_cbranch_scc1 Lpa_18
    s_add_u32 s51, s51, 1
Lpag_19:
    s_mov_b64 s[62:63], -1
    v_and_b32 v168, 7, v160
    v_cmp_eq_u32 vcc, s42, v168
    s_nop 1
    s_and_b64 s[62:63], s[62:63], vcc
    v_and_b32 v168, 7, v161
    v_cmp_eq_u32 vcc, s42, v168
    s_nop 1
    s_and_b64 s[62:63], s[62:63], vcc
    v_and_b32 v168, 7, v162
    v_cmp_eq_u32 vcc, s42, v168
    s_nop 1
    s_and_b64 s[62:63], s[62:63], vcc
    v_and_b32 v168, 7, v163
    v_cmp_eq_u32 vcc, s42, v168
    s_nop 1
    s_and_b64 s[62:63], s[62:63], vcc
    s_lshl_b32 s60, s45, 2
    s_lshr_b64 s[62:63], s[62:63], s60
    s_and_b32 s60, s62, 15
    s_cmp_eq_u32 s60, 15
    s_cselect_b32 s60, 1, 0
    v_mov_b32 v160, s60
    v_mov_b32 v161, 163456
    s_mov_b64 exec, 1
    ds_write_b32 v161, v160
    s_waitcnt lgkmcnt(0)
    s_mov_b64 exec, -1
Lw0_16:
    s_nop 0
    s_barrier
    v_mov_b32 v1, 163456
    ds_read_b32 v1, v1
    s_waitcnt lgkmcnt(0)
    s_nop 0
    v_readfirstlane_b32 s41, v1
    s_mov_b32 s96, 0
    s_mov_b32 s97, 18432
    s_add_u32 m0, s89, 0
    s_add_u32 s84, s8, 0
    buffer_load_dwordx4 v254, s[24:27], s84 offen lds
    s_add_u32 m0, s89, 4096
    s_add_u32 s84, s8, 4096
    buffer_load_dwordx4 v254, s[24:27], s84 offen lds
    buffer_load_dwordx4 a[0:3], v176, s[24:27], s96 offen offset:0 sc1
    buffer_load_dwordx4 a[72:75], v176, s[24:27], s97 offen offset:0 sc1
    s_add_u32 m0, s89, 8192
    s_add_u32 s84, s8, 8192
    buffer_load_dwordx4 v254, s[24:27], s84 offen lds
    s_add_u32 m0, s89, 12288
    s_add_u32 s84, s8, 12288
    buffer_load_dwordx4 v254, s[24:27], s84 offen lds
    v_mov_b32 v156, s76
    v_mov_b32 v157, s76
    v_mov_b32 v158, s76
    v_mov_b32 v159, s76
    s_add_u32 s58, s89, 138240
    v_add_u32 v153, s58, v254
    s_not_b64 exec, s[66:67]
    ds_write_b128 v153, v[156:159] offset:0
    ds_write_b128 v153, v[156:159] offset:4096
    ds_write_b128 v153, v[156:159] offset:8192
    ds_write_b128 v153, v[156:159] offset:12288
    ds_write_b128 v153, v[156:159] offset:16384
    s_mov_b64 exec, s[66:67]
    s_add_u32 s57, s89, s36
    s_add_u32 m0, s58, 0
    s_add_u32 s59, s57, 0
    buffer_load_dwordx4 v254, s[24:27], s59 offen sc1 lds
    s_add_u32 m0, s58, 4096
    s_add_u32 s59, s57, 4096
    buffer_load_dwordx4 v254, s[24:27], s59 offen sc1 lds
    s_add_u32 m0, s58, 8192
    s_add_u32 s59, s57, 8192
    buffer_load_dwordx4 v254, s[24:27], s59 offen sc1 lds
    s_add_u32 m0, s58, 12288
    s_add_u32 s59, s57, 12288
    buffer_load_dwordx4 v254, s[24:27], s59 offen sc1 lds
    s_add_u32 m0, s58, 16384
    s_add_u32 s59, s57, 16384
    buffer_load_dwordx4 v254, s[24:27], s59 offen sc1 lds
    s_mov_b64 exec, -1
    buffer_load_dwordx4 a[4:7], v176, s[24:27], s96 offen offset:1024 sc1
    buffer_load_dwordx4 a[76:79], v176, s[24:27], s97 offen offset:1024 sc1
    s_add_u32 m0, s89, 16384
    s_add_u32 s84, s8, 16384
    buffer_load_dwordx4 v254, s[24:27], s84 offen lds
    s_add_u32 m0, s89, 20480
    s_add_u32 s84, s8, 20480
    buffer_load_dwordx4 v254, s[24:27], s84 offen lds
    s_add_u32 m0, s89, 24576
    s_add_u32 s84, s8, 24576
    buffer_load_dwordx4 v254, s[24:27], s84 offen lds
    buffer_load_dwordx4 a[8:11], v176, s[24:27], s96 offen offset:2048 sc1
    buffer_load_dwordx4 a[80:83], v176, s[24:27], s97 offen offset:2048 sc1
    buffer_load_dwordx4 v[132:135], v194, s[24:27], 0 offen offset:0 sc1
    buffer_load_dwordx4 v[136:139], v194, s[24:27], 0 offen offset:1024 sc1
    buffer_load_dwordx4 v[140:143], v254, s[24:27], s37 offen sc1
    buffer_load_dwordx4 a[12:15], v176, s[24:27], s96 offen offset:3072 sc1
    buffer_load_dwordx4 a[84:87], v176, s[24:27], s97 offen offset:3072 sc1
    v_add_u32 v175, 138240, v254
    s_waitcnt vmcnt(12)
    s_waitcnt lgkmcnt(0)
    s_barrier
    ds_read_b128 v[56:59], v177 offset:0
    ds_read_b128 v[60:63], v177 offset:1024
    ds_read_b128 v[64:67], v177 offset:2048
    ds_read_b128 v[68:71], v177 offset:3072
    ds_read_b128 v[72:75], v177 offset:4096
    ds_read_b128 v[76:79], v177 offset:5120
    ds_read_b128 v[80:83], v177 offset:6144
    ds_read_b128 v[144:147], v179 offset:0
    ds_read_b128 v[148:151], v185 offset:0
    ds_read_b128 v[152:155], v175 offset:0
    s_and_b32 s60, s2, 7
    s_lshl_b32 s60, s60, 12
    s_add_u32 s60, s60, 9535488
    v_lshrrev_b32 v172, 2, v197
    v_mul_u32_u24 v172, 256, v172
    v_and_b32 v171, 3, v197
    v_lshl_add_u32 v172, v171, 4, v172
    v_add_u32 v172, s60, v172
    s_waitcnt lgkmcnt(8)
    v_mfma_f32_16x16x32_bf16 v[0:3], v[56:59], a[0:3], 0
    ds_read_b128 v[84:87], v177 offset:7168
    v_mfma_f32_16x16x32_bf16 v[4:7], v[56:59], a[72:75], 0
    s_add_u32 m0, s89, 28672
    s_add_u32 s84, s8, 28672
    buffer_load_dwordx4 v254, s[24:27], s84 offen lds
    v_mfma_f32_16x16x32_bf16 v[8:11], v[60:63], a[0:3], 0
    ds_read_b128 v[88:91], v177 offset:8192
    v_mfma_f32_16x16x32_bf16 v[12:15], v[60:63], a[72:75], 0
    s_waitcnt lgkmcnt(8)
    v_mfma_f32_16x16x32_bf16 v[16:19], v[64:67], a[0:3], 0
    ds_read_b128 v[92:95], v177 offset:9216
    v_mfma_f32_16x16x32_bf16 v[20:23], v[64:67], a[72:75], 0
    s_add_u32 m0, s89, 32768
    s_add_u32 s84, s8, 32768
    buffer_load_dwordx4 v254, s[24:27], s84 offen lds
    v_mfma_f32_16x16x32_bf16 v[24:27], v[68:71], a[0:3], 0
    ds_read_b128 v[96:99], v177 offset:10240
    v_mfma_f32_16x16x32_bf16 v[28:31], v[68:71], a[72:75], 0
    s_waitcnt lgkmcnt(8)
    v_mfma_f32_16x16x32_bf16 v[32:35], v[72:75], a[0:3], 0
    ds_read_b128 v[100:103], v177 offset:11264
    v_mfma_f32_16x16x32_bf16 v[36:39], v[72:75], a[72:75], 0
    s_add_u32 m0, s89, 36864
    s_add_u32 s84, s8, 36864
    buffer_load_dwordx4 v254, s[24:27], s84 offen lds
    v_mfma_f32_16x16x32_bf16 v[40:43], v[76:79], a[0:3], 0
    ds_read_b128 v[104:107], v177 offset:12288
    v_mfma_f32_16x16x32_bf16 v[44:47], v[76:79], a[72:75], 0
    s_waitcnt lgkmcnt(6)
    v_mfma_f32_16x16x32_bf16 v[48:51], v[80:83], a[0:3], 0
    ds_read_b128 v[108:111], v177 offset:13312
    v_mfma_f32_16x16x32_bf16 v[52:55], v[80:83], a[72:75], 0
    s_add_u32 m0, s89, 40960
    s_add_u32 s84, s8, 40960
    buffer_load_dwordx4 v254, s[24:27], s84 offen lds
    v_mfma_f32_16x16x32_bf16 v[112:115], v[144:147], v[152:155], 0
    v_mfma_f32_16x16x32_bf16 v[116:119], v[148:151], v[152:155], 0
    ds_read_b128 v[156:159], v179 offset:7168
    ds_read_b128 v[160:163], v185 offset:7168
    ds_read_b128 v[164:167], v175 offset:1024
    s_waitcnt vmcnt(11)
    s_barrier
    s_cmp_eq_u32 s44, 0
    s_cbranch_scc0 Lw0_20
    s_mul_i32 s59, s45, 256
    s_lshl_b32 s60, s46, 2
    s_add_u32 s59, s59, s60
    s_add_u32 s59, s59, 9535488
    v_mov_b32 v173, s92
    v_lshlrev_b32 v174, 12, v197
    s_mov_b64 exec, 255
    buffer_store_dword v173, v174, s[24:27], s59 offen sc1
    s_mov_b64 exec, -1
Lw0_20:
    s_nop 0
    s_waitcnt lgkmcnt(8)
    v_mfma_f32_16x16x32_bf16 v[0:3], v[84:87], a[4:7], v[0:3]
    ds_read_b128 v[56:59], v177 offset:14336
    v_mfma_f32_16x16x32_bf16 v[4:7], v[84:87], a[76:79], v[4:7]
    s_add_u32 s96, s96, 4096
    s_add_u32 s97, s97, 4096
    buffer_load_dwordx4 a[16:19], v176, s[24:27], s96 offen offset:0 sc1
    v_mfma_f32_16x16x32_bf16 v[8:11], v[88:91], a[4:7], v[8:11]
    ds_read_b128 v[60:63], v177 offset:15360
    v_mfma_f32_16x16x32_bf16 v[12:15], v[88:91], a[76:79], v[12:15]
    s_waitcnt lgkmcnt(8)
    v_mfma_f32_16x16x32_bf16 v[16:19], v[92:95], a[4:7], v[16:19]
    ds_read_b128 v[64:67], v177 offset:16384
    v_mfma_f32_16x16x32_bf16 v[20:23], v[92:95], a[76:79], v[20:23]
    buffer_load_dwordx4 a[88:91], v176, s[24:27], s97 offen offset:0 sc1
    v_mfma_f32_16x16x32_bf16 v[24:27], v[96:99], a[4:7], v[24:27]
    ds_read_b128 v[68:71], v177 offset:17408
    v_mfma_f32_16x16x32_bf16 v[28:31], v[96:99], a[76:79], v[28:31]
    s_waitcnt lgkmcnt(8)
    v_mfma_f32_16x16x32_bf16 v[32:35], v[100:103], a[4:7], v[32:35]
    ds_read_b128 v[72:75], v177 offset:18432
    v_mfma_f32_16x16x32_bf16 v[36:39], v[100:103], a[76:79], v[36:39]
    s_add_u32 m0, s89, 45056
    s_add_u32 s84, s8, 45056
    buffer_load_dwordx4 v254, s[24:27], s84 offen lds
    v_mfma_f32_16x16x32_bf16 v[40:43], v[104:107], a[4:7], v[40:43]
    ds_read_b128 v[76:79], v177 offset:19456
    v_mfma_f32_16x16x32_bf16 v[44:47], v[104:107], a[76:79], v[44:47]
    s_waitcnt lgkmcnt(6)
    v_mfma_f32_16x16x32_bf16 v[48:51], v[108:111], a[4:7], v[48:51]
    ds_read_b128 v[80:83], v177 offset:20480
    v_mfma_f32_16x16x32_bf16 v[52:55], v[108:111], a[76:79], v[52:55]
    s_add_u32 m0, s89, 49152
    s_add_u32 s84, s8, 49152
    buffer_load_dwordx4 v254, s[24:27], s84 offen lds
    v_mfma_f32_16x16x32_bf16 v[112:115], v[156:159], v[164:167], v[112:115]
    v_mfma_f32_16x16x32_bf16 v[116:119], v[160:163], v[164:167], v[116:119]
    ds_read_b128 v[144:147], v179 offset:14336
    ds_read_b128 v[148:151], v185 offset:14336
    ds_read_b128 v[152:155], v175 offset:2048
    s_waitcnt vmcnt(13) lgkmcnt(8)
    v_mfma_f32_16x16x32_bf16 v[0:3], v[56:59], a[8:11], v[0:3]
    ds_read_b128 v[84:87], v177 offset:21504
    v_mfma_f32_16x16x32_bf16 v[4:7], v[56:59], a[80:83], v[4:7]
    s_add_u32 m0, s89, 53248
    s_add_u32 s84, s8, 53248
    buffer_load_dwordx4 v254, s[24:27], s84 offen lds
    v_mfma_f32_16x16x32_bf16 v[8:11], v[60:63], a[8:11], v[8:11]
    ds_read_b128 v[88:91], v177 offset:22528
    v_mfma_f32_16x16x32_bf16 v[12:15], v[60:63], a[80:83], v[12:15]
    s_waitcnt lgkmcnt(8)
    v_mfma_f32_16x16x32_bf16 v[16:19], v[64:67], a[8:11], v[16:19]
    ds_read_b128 v[92:95], v177 offset:23552
    v_mfma_f32_16x16x32_bf16 v[20:23], v[64:67], a[80:83], v[20:23]
    buffer_load_dwordx4 a[20:23], v176, s[24:27], s96 offen offset:1024 sc1
    v_mfma_f32_16x16x32_bf16 v[24:27], v[68:71], a[8:11], v[24:27]
    ds_read_b128 v[96:99], v177 offset:24576
    v_mfma_f32_16x16x32_bf16 v[28:31], v[68:71], a[80:83], v[28:31]
    s_waitcnt lgkmcnt(8)
    v_mfma_f32_16x16x32_bf16 v[32:35], v[72:75], a[8:11], v[32:35]
    ds_read_b128 v[100:103], v177 offset:25600
    v_mfma_f32_16x16x32_bf16 v[36:39], v[72:75], a[80:83], v[36:39]
    buffer_load_dwordx4 a[92:95], v176, s[24:27], s97 offen offset:1024 sc1
    v_mfma_f32_16x16x32_bf16 v[40:43], v[76:79], a[8:11], v[40:43]
    ds_read_b128 v[104:107], v177 offset:26624
    v_mfma_f32_16x16x32_bf16 v[44:47], v[76:79], a[80:83], v[44:47]
    s_waitcnt lgkmcnt(6)
    v_mfma_f32_16x16x32_bf16 v[48:51], v[80:83], a[8:11], v[48:51]
    ds_read_b128 v[108:111], v177 offset:27648
    v_mfma_f32_16x16x32_bf16 v[52:55], v[80:83], a[80:83], v[52:55]
    buffer_load_dwordx4 a[24:27], v176, s[24:27], s96 offen offset:2048 sc1
    v_mfma_f32_16x16x32_bf16 v[112:115], v[144:147], v[152:155], v[112:115]
    v_mfma_f32_16x16x32_bf16 v[116:119], v[148:151], v[152:155], v[116:119]
    ds_read_b128 v[156:159], v179 offset:21504
    ds_read_b128 v[160:163], v185 offset:21504
    ds_read_b128 v[164:167], v175 offset:3072
    s_waitcnt vmcnt(8)
    s_barrier
    s_waitcnt lgkmcnt(8)
    v_mfma_f32_16x16x32_bf16 v[0:3], v[84:87], a[12:15], v[0:3]
    ds_read_b128 v[56:59], v177 offset:28672
    v_mfma_f32_16x16x32_bf16 v[4:7], v[84:87], a[84:87], v[4:7]
    buffer_load_dwordx4 a[96:99], v176, s[24:27], s97 offen offset:2048 sc1
    v_mfma_f32_16x16x32_bf16 v[8:11], v[88:91], a[12:15], v[8:11]
    ds_read_b128 v[60:63], v177 offset:29696
    v_mfma_f32_16x16x32_bf16 v[12:15], v[88:91], a[84:87], v[12:15]
    s_waitcnt lgkmcnt(8)
    v_mfma_f32_16x16x32_bf16 v[16:19], v[92:95], a[12:15], v[16:19]
    ds_read_b128 v[64:67], v177 offset:30720
    v_mfma_f32_16x16x32_bf16 v[20:23], v[92:95], a[84:87], v[20:23]
    s_add_u32 m0, s89, 57344
    s_add_u32 s84, s8, 57344
    buffer_load_dwordx4 v254, s[24:27], s84 offen lds
    v_mfma_f32_16x16x32_bf16 v[24:27], v[96:99], a[12:15], v[24:27]
    ds_read_b128 v[68:71], v177 offset:31744
    v_mfma_f32_16x16x32_bf16 v[28:31], v[96:99], a[84:87], v[28:31]
    s_waitcnt lgkmcnt(8)
    v_mfma_f32_16x16x32_bf16 v[32:35], v[100:103], a[12:15], v[32:35]
    ds_read_b128 v[72:75], v177 offset:32768
    v_mfma_f32_16x16x32_bf16 v[36:39], v[100:103], a[84:87], v[36:39]
    s_add_u32 m0, s89, 61440
    s_add_u32 s84, s8, 61440
    buffer_load_dwordx4 v254, s[24:27], s84 offen lds
    v_mfma_f32_16x16x32_bf16 v[40:43], v[104:107], a[12:15], v[40:43]
    ds_read_b128 v[76:79], v177 offset:33792
    v_mfma_f32_16x16x32_bf16 v[44:47], v[104:107], a[84:87], v[44:47]
    s_waitcnt lgkmcnt(6)
    v_mfma_f32_16x16x32_bf16 v[48:51], v[108:111], a[12:15], v[48:51]
    ds_read_b128 v[80:83], v177 offset:34816
    v_mfma_f32_16x16x32_bf16 v[52:55], v[108:111], a[84:87], v[52:55]
    s_add_u32 m0, s89, 65536
    s_add_u32 s84, s8, 65536
    buffer_load_dwordx4 v254, s[24:27], s84 offen lds
    v_mfma_f32_16x16x32_bf16 v[112:115], v[156:159], v[164:167], v[112:115]
    v_mfma_f32_16x16x32_bf16 v[116:119], v[160:163], v[164:167], v[116:119]
    ds_read_b128 v[144:147], v179 offset:28672
    ds_read_b128 v[148:151], v185 offset:28672
    ds_read_b128 v[152:155], v175 offset:4096
    s_waitcnt vmcnt(10) lgkmcnt(8)
    v_mfma_f32_16x16x32_bf16 v[0:3], v[56:59], a[16:19], v[0:3]
    ds_read_b128 v[84:87], v177 offset:35840
    v_mfma_f32_16x16x32_bf16 v[4:7], v[56:59], a[88:91], v[4:7]
    s_add_u32 m0, s89, 69632
    s_add_u32 s84, s8, 69632
    buffer_load_dwordx4 v254, s[24:27], s84 offen lds
    v_mfma_f32_16x16x32_bf16 v[8:11], v[60:63], a[16:19], v[8:11]
    ds_read_b128 v[88:91], v177 offset:36864
    v_mfma_f32_16x16x32_bf16 v[12:15], v[60:63], a[88:91], v[12:15]
    s_waitcnt lgkmcnt(8)
    v_mfma_f32_16x16x32_bf16 v[16:19], v[64:67], a[16:19], v[16:19]
    ds_read_b128 v[92:95], v177 offset:37888
    v_mfma_f32_16x16x32_bf16 v[20:23], v[64:67], a[88:91], v[20:23]
    buffer_load_dwordx4 a[28:31], v176, s[24:27], s96 offen offset:3072 sc1
    v_mfma_f32_16x16x32_bf16 v[24:27], v[68:71], a[16:19], v[24:27]
    ds_read_b128 v[96:99], v177 offset:38912
    v_mfma_f32_16x16x32_bf16 v[28:31], v[68:71], a[88:91], v[28:31]
    s_waitcnt lgkmcnt(8)
    v_mfma_f32_16x16x32_bf16 v[32:35], v[72:75], a[16:19], v[32:35]
    ds_read_b128 v[100:103], v177 offset:39936
    v_mfma_f32_16x16x32_bf16 v[36:39], v[72:75], a[88:91], v[36:39]
    buffer_load_dwordx4 a[100:103], v176, s[24:27], s97 offen offset:3072 sc1
    v_mfma_f32_16x16x32_bf16 v[40:43], v[76:79], a[16:19], v[40:43]
    ds_read_b128 v[104:107], v177 offset:40960
    v_mfma_f32_16x16x32_bf16 v[44:47], v[76:79], a[88:91], v[44:47]
    s_waitcnt lgkmcnt(6)
    v_mfma_f32_16x16x32_bf16 v[48:51], v[80:83], a[16:19], v[48:51]
    ds_read_b128 v[108:111], v177 offset:41984
    v_mfma_f32_16x16x32_bf16 v[52:55], v[80:83], a[88:91], v[52:55]
    s_add_u32 s96, s96, 4096
    s_add_u32 s97, s97, 4096
    buffer_load_dwordx4 a[32:35], v176, s[24:27], s96 offen offset:0 sc1
    v_mfma_f32_16x16x32_bf16 v[112:115], v[144:147], v[152:155], v[112:115]
    v_mfma_f32_16x16x32_bf16 v[116:119], v[148:151], v[152:155], v[116:119]
    ds_read_b128 v[156:159], v179 offset:35840
    ds_read_b128 v[160:163], v185 offset:35840
    ds_read_b128 v[164:167], v175 offset:5120
    s_waitcnt vmcnt(11)
    s_barrier
    s_waitcnt vmcnt(9) lgkmcnt(8)
    v_mfma_f32_16x16x32_bf16 v[0:3], v[84:87], a[20:23], v[0:3]
    ds_read_b128 v[56:59], v177 offset:43008
    v_mfma_f32_16x16x32_bf16 v[4:7], v[84:87], a[92:95], v[4:7]
    v_add_f32 v132, v132, v134
    buffer_load_dwordx4 a[104:107], v176, s[24:27], s97 offen offset:0 sc1
    v_mfma_f32_16x16x32_bf16 v[8:11], v[88:91], a[20:23], v[8:11]
    ds_read_b128 v[60:63], v177 offset:44032
    v_mfma_f32_16x16x32_bf16 v[12:15], v[88:91], a[92:95], v[12:15]
    s_waitcnt lgkmcnt(8)
    v_mfma_f32_16x16x32_bf16 v[16:19], v[92:95], a[20:23], v[16:19]
    ds_read_b128 v[64:67], v177 offset:45056
    v_mfma_f32_16x16x32_bf16 v[20:23], v[92:95], a[92:95], v[20:23]
    v_add_f32 v133, v133, v135
    s_add_u32 m0, s89, 73728
    s_add_u32 s84, s8, 73728
    buffer_load_dwordx4 v254, s[24:27], s84 offen lds
    v_mfma_f32_16x16x32_bf16 v[24:27], v[96:99], a[20:23], v[24:27]
    ds_read_b128 v[68:71], v177 offset:46080
    v_mfma_f32_16x16x32_bf16 v[28:31], v[96:99], a[92:95], v[28:31]
    s_waitcnt lgkmcnt(8)
    v_mfma_f32_16x16x32_bf16 v[32:35], v[100:103], a[20:23], v[32:35]
    ds_read_b128 v[72:75], v177 offset:47104
    v_mfma_f32_16x16x32_bf16 v[36:39], v[100:103], a[92:95], v[36:39]
    v_permlane16_swap_b32 v132, v133
    s_add_u32 m0, s89, 77824
    s_add_u32 s84, s8, 77824
    buffer_load_dwordx4 v254, s[24:27], s84 offen lds
    v_mfma_f32_16x16x32_bf16 v[40:43], v[104:107], a[20:23], v[40:43]
    ds_read_b128 v[76:79], v177 offset:48128
    v_mfma_f32_16x16x32_bf16 v[44:47], v[104:107], a[92:95], v[44:47]
    s_waitcnt lgkmcnt(6)
    v_mfma_f32_16x16x32_bf16 v[48:51], v[108:111], a[20:23], v[48:51]
    ds_read_b128 v[80:83], v177 offset:49152
    v_mfma_f32_16x16x32_bf16 v[52:55], v[108:111], a[92:95], v[52:55]
    v_add_f32 v132, v132, v133
    s_add_u32 m0, s89, 81920
    s_add_u32 s84, s8, 81920
    buffer_load_dwordx4 v254, s[24:27], s84 offen lds
    v_mfma_f32_16x16x32_bf16 v[112:115], v[156:159], v[164:167], v[112:115]
    v_mfma_f32_16x16x32_bf16 v[116:119], v[160:163], v[164:167], v[116:119]
    ds_read_b128 v[144:147], v179 offset:43008
    ds_read_b128 v[148:151], v185 offset:43008
    ds_read_b128 v[152:155], v175 offset:6144
    s_waitcnt vmcnt(11) lgkmcnt(8)
    v_mfma_f32_16x16x32_bf16 v[0:3], v[56:59], a[24:27], v[0:3]
    ds_read_b128 v[84:87], v177 offset:50176
    v_mfma_f32_16x16x32_bf16 v[4:7], v[56:59], a[96:99], v[4:7]
    v_mov_b32 v134, v132
    buffer_load_dwordx4 a[36:39], v176, s[24:27], s96 offen offset:1024 sc1
    v_mfma_f32_16x16x32_bf16 v[8:11], v[60:63], a[24:27], v[8:11]
    ds_read_b128 v[88:91], v177 offset:51200
    v_mfma_f32_16x16x32_bf16 v[12:15], v[60:63], a[96:99], v[12:15]
    s_waitcnt lgkmcnt(8)
    v_mfma_f32_16x16x32_bf16 v[16:19], v[64:67], a[24:27], v[16:19]
    ds_read_b128 v[92:95], v177 offset:52224
    v_mfma_f32_16x16x32_bf16 v[20:23], v[64:67], a[96:99], v[20:23]
    v_permlane32_swap_b32 v132, v134
    buffer_load_dwordx4 a[108:111], v176, s[24:27], s97 offen offset:1024 sc1
    v_mfma_f32_16x16x32_bf16 v[24:27], v[68:71], a[24:27], v[24:27]
    ds_read_b128 v[96:99], v177 offset:53248
    v_mfma_f32_16x16x32_bf16 v[28:31], v[68:71], a[96:99], v[28:31]
    s_waitcnt lgkmcnt(8)
    v_mfma_f32_16x16x32_bf16 v[32:35], v[72:75], a[24:27], v[32:35]
    ds_read_b128 v[100:103], v177 offset:54272
    v_mfma_f32_16x16x32_bf16 v[36:39], v[72:75], a[96:99], v[36:39]
    v_add_f32 v132, v132, v134
    buffer_load_dwordx4 a[40:43], v176, s[24:27], s96 offen offset:2048 sc1
    v_mfma_f32_16x16x32_bf16 v[40:43], v[76:79], a[24:27], v[40:43]
    ds_read_b128 v[104:107], v177 offset:55296
    v_mfma_f32_16x16x32_bf16 v[44:47], v[76:79], a[96:99], v[44:47]
    s_waitcnt lgkmcnt(6)
    v_mfma_f32_16x16x32_bf16 v[48:51], v[80:83], a[24:27], v[48:51]
    ds_read_b128 v[108:111], v177 offset:56320
    v_mfma_f32_16x16x32_bf16 v[52:55], v[80:83], a[96:99], v[52:55]
    v_mov_b32 v133, v132
    buffer_load_dwordx4 a[112:115], v176, s[24:27], s97 offen offset:2048 sc1
    v_mfma_f32_16x16x32_bf16 v[112:115], v[144:147], v[152:155], v[112:115]
    v_mfma_f32_16x16x32_bf16 v[116:119], v[148:151], v[152:155], v[116:119]
    ds_read_b128 v[156:159], v179 offset:50176
    ds_read_b128 v[160:163], v185 offset:50176
    ds_read_b128 v[164:167], v175 offset:7168
    s_waitcnt vmcnt(11)
    s_barrier
    s_waitcnt vmcnt(9) lgkmcnt(8)
    v_mfma_f32_16x16x32_bf16 v[0:3], v[84:87], a[28:31], v[0:3]
    ds_read_b128 v[56:59], v177 offset:57344
    v_mfma_f32_16x16x32_bf16 v[4:7], v[84:87], a[100:103], v[4:7]
    v_permlane16_swap_b32 v132, v133
    s_add_u32 m0, s89, 86016
    s_add_u32 s84, s8, 86016
    buffer_load_dwordx4 v254, s[24:27], s84 offen lds
    v_mfma_f32_16x16x32_bf16 v[8:11], v[88:91], a[28:31], v[8:11]
    ds_read_b128 v[60:63], v177 offset:58368
    v_mfma_f32_16x16x32_bf16 v[12:15], v[88:91], a[100:103], v[12:15]
    s_waitcnt lgkmcnt(8)
    v_mfma_f32_16x16x32_bf16 v[16:19], v[92:95], a[28:31], v[16:19]
    ds_read_b128 v[64:67], v177 offset:59392
    v_mfma_f32_16x16x32_bf16 v[20:23], v[92:95], a[100:103], v[20:23]
    v_mul_f32 v120, 0xbae38e39, v132
    s_add_u32 m0, s89, 90112
    s_add_u32 s84, s8, 90112
    buffer_load_dwordx4 v254, s[24:27], s84 offen lds
    v_mfma_f32_16x16x32_bf16 v[24:27], v[96:99], a[28:31], v[24:27]
    ds_read_b128 v[68:71], v177 offset:60416
    v_mfma_f32_16x16x32_bf16 v[28:31], v[96:99], a[100:103], v[28:31]
    s_waitcnt lgkmcnt(8)
    v_mfma_f32_16x16x32_bf16 v[32:35], v[100:103], a[28:31], v[32:35]
    ds_read_b128 v[72:75], v177 offset:61440
    v_mfma_f32_16x16x32_bf16 v[36:39], v[100:103], a[100:103], v[36:39]
    v_mul_f32 v133, 0x3ae38e39, v133
    s_add_u32 m0, s89, 94208
    s_add_u32 s84, s8, 94208
    buffer_load_dwordx4 v254, s[24:27], s84 offen lds
    v_mfma_f32_16x16x32_bf16 v[40:43], v[104:107], a[28:31], v[40:43]
    ds_read_b128 v[76:79], v177 offset:62464
    v_mfma_f32_16x16x32_bf16 v[44:47], v[104:107], a[100:103], v[44:47]
    s_waitcnt lgkmcnt(6)
    v_mfma_f32_16x16x32_bf16 v[48:51], v[108:111], a[28:31], v[48:51]
    ds_read_b128 v[80:83], v177 offset:63488
    v_mfma_f32_16x16x32_bf16 v[52:55], v[108:111], a[100:103], v[52:55]
    v_fma_f32 v133, -v120, v120, v133
    s_add_u32 m0, s89, 98304
    s_add_u32 s84, s8, 98304
    buffer_load_dwordx4 v254, s[24:27], s84 offen lds
    v_mfma_f32_16x16x32_bf16 v[112:115], v[156:159], v[164:167], v[112:115]
    v_mfma_f32_16x16x32_bf16 v[116:119], v[160:163], v[164:167], v[116:119]
    ds_read_b128 v[144:147], v179 offset:57344
    ds_read_b128 v[148:151], v185 offset:57344
    ds_read_b128 v[152:155], v175 offset:8192
    s_waitcnt vmcnt(11) lgkmcnt(8)
    v_mfma_f32_16x16x32_bf16 v[0:3], v[56:59], a[32:35], v[0:3]
    ds_read_b128 v[84:87], v178 offset:0
    v_mfma_f32_16x16x32_bf16 v[4:7], v[56:59], a[104:107], v[4:7]
    v_max_f32 v133, 0, v133
    buffer_load_dwordx4 a[44:47], v176, s[24:27], s96 offen offset:3072 sc1
    v_mfma_f32_16x16x32_bf16 v[8:11], v[60:63], a[32:35], v[8:11]
    ds_read_b128 v[88:91], v178 offset:1024
    v_mfma_f32_16x16x32_bf16 v[12:15], v[60:63], a[104:107], v[12:15]
    s_waitcnt lgkmcnt(8)
    v_mfma_f32_16x16x32_bf16 v[16:19], v[64:67], a[32:35], v[16:19]
    ds_read_b128 v[92:95], v178 offset:2048
    v_mfma_f32_16x16x32_bf16 v[20:23], v[64:67], a[104:107], v[20:23]
    v_add_f32 v133, 0x3727c5ac, v133
    buffer_load_dwordx4 a[116:119], v176, s[24:27], s97 offen offset:3072 sc1
    v_mfma_f32_16x16x32_bf16 v[24:27], v[68:71], a[32:35], v[24:27]
    ds_read_b128 v[96:99], v178 offset:3072
    v_mfma_f32_16x16x32_bf16 v[28:31], v[68:71], a[104:107], v[28:31]
    s_waitcnt lgkmcnt(8)
    v_mfma_f32_16x16x32_bf16 v[32:35], v[72:75], a[32:35], v[32:35]
    ds_read_b128 v[100:103], v178 offset:4096
    v_mfma_f32_16x16x32_bf16 v[36:39], v[72:75], a[104:107], v[36:39]
    v_rsq_f32 v126, v133
    buffer_load_dwordx4 v[168:171], v172, s[24:27], 0 offen sc1
    v_mfma_f32_16x16x32_bf16 v[40:43], v[76:79], a[32:35], v[40:43]
    ds_read_b128 v[104:107], v178 offset:5120
    v_mfma_f32_16x16x32_bf16 v[44:47], v[76:79], a[104:107], v[44:47]
    s_waitcnt lgkmcnt(6)
    v_mfma_f32_16x16x32_bf16 v[48:51], v[80:83], a[32:35], v[48:51]
    ds_read_b128 v[108:111], v178 offset:6144
    v_mfma_f32_16x16x32_bf16 v[52:55], v[80:83], a[104:107], v[52:55]
    v_add_f32 v136, v136, v138
    s_add_u32 s96, s96, 4096
    s_add_u32 s97, s97, 4096
    buffer_load_dwordx4 a[48:51], v176, s[24:27], s96 offen offset:0 sc1
    v_mfma_f32_16x16x32_bf16 v[112:115], v[144:147], v[152:155], v[112:115]
    v_mfma_f32_16x16x32_bf16 v[116:119], v[148:151], v[152:155], v[116:119]
    ds_read_b128 v[156:159], v180 offset:0
    ds_read_b128 v[160:163], v186 offset:0
    ds_read_b128 v[164:167], v175 offset:9216
    s_waitcnt vmcnt(12)
    s_barrier
    s_waitcnt vmcnt(10) lgkmcnt(8)
    v_mfma_f32_16x16x32_bf16 v[0:3], v[84:87], a[36:39], v[0:3]
    ds_read_b128 v[56:59], v178 offset:7168
    v_mfma_f32_16x16x32_bf16 v[4:7], v[84:87], a[108:111], v[4:7]
    v_add_f32 v137, v137, v139
    buffer_load_dwordx4 a[120:123], v176, s[24:27], s97 offen offset:0 sc1
    v_mfma_f32_16x16x32_bf16 v[8:11], v[88:91], a[36:39], v[8:11]
    ds_read_b128 v[60:63], v178 offset:8192
    v_mfma_f32_16x16x32_bf16 v[12:15], v[88:91], a[108:111], v[12:15]
    s_waitcnt lgkmcnt(8)
    v_mfma_f32_16x16x32_bf16 v[16:19], v[92:95], a[36:39], v[16:19]
    ds_read_b128 v[64:67], v178 offset:9216
    v_mfma_f32_16x16x32_bf16 v[20:23], v[92:95], a[108:111], v[20:23]
    v_permlane16_swap_b32 v136, v137
    s_add_u32 m0, s89, 102400
    s_add_u32 s84, s8, 102400
    buffer_load_dwordx4 v254, s[24:27], s84 offen lds
    v_mfma_f32_16x16x32_bf16 v[24:27], v[96:99], a[36:39], v[24:27]
    ds_read_b128 v[68:71], v178 offset:10240
    v_mfma_f32_16x16x32_bf16 v[28:31], v[96:99], a[108:111], v[28:31]
    s_waitcnt lgkmcnt(8)
    v_mfma_f32_16x16x32_bf16 v[32:35], v[100:103], a[36:39], v[32:35]
    ds_read_b128 v[72:75], v178 offset:11264
    v_mfma_f32_16x16x32_bf16 v[36:39], v[100:103], a[108:111], v[36:39]
    v_add_f32 v136, v136, v137
    s_add_u32 m0, s89, 106496
    s_add_u32 s84, s8, 106496
    buffer_load_dwordx4 v254, s[24:27], s84 offen lds
    v_mfma_f32_16x16x32_bf16 v[40:43], v[104:107], a[36:39], v[40:43]
    ds_read_b128 v[76:79], v178 offset:12288
    v_mfma_f32_16x16x32_bf16 v[44:47], v[104:107], a[108:111], v[44:47]
    s_waitcnt lgkmcnt(6)
    v_mfma_f32_16x16x32_bf16 v[48:51], v[108:111], a[36:39], v[48:51]
    ds_read_b128 v[80:83], v178 offset:13312
    v_mfma_f32_16x16x32_bf16 v[52:55], v[108:111], a[108:111], v[52:55]
    v_mov_b32 v138, v136
    s_add_u32 m0, s89, 110592
    s_add_u32 s84, s8, 110592
    buffer_load_dwordx4 v254, s[24:27], s84 offen lds
    v_mfma_f32_16x16x32_bf16 v[112:115], v[156:159], v[164:167], v[112:115]
    v_mfma_f32_16x16x32_bf16 v[116:119], v[160:163], v[164:167], v[116:119]
    ds_read_b128 v[144:147], v180 offset:7168
    ds_read_b128 v[148:151], v186 offset:7168
    ds_read_b128 v[152:155], v175 offset:10240
    s_waitcnt vmcnt(12) lgkmcnt(8)
    v_mfma_f32_16x16x32_bf16 v[0:3], v[56:59], a[40:43], v[0:3]
    ds_read_b128 v[84:87], v178 offset:14336
    v_mfma_f32_16x16x32_bf16 v[4:7], v[56:59], a[112:115], v[4:7]
    v_permlane32_swap_b32 v136, v138
    buffer_load_dwordx4 a[52:55], v176, s[24:27], s96 offen offset:1024 sc1
    v_mfma_f32_16x16x32_bf16 v[8:11], v[60:63], a[40:43], v[8:11]
    ds_read_b128 v[88:91], v178 offset:15360
    v_mfma_f32_16x16x32_bf16 v[12:15], v[60:63], a[112:115], v[12:15]
    s_waitcnt lgkmcnt(8)
    v_mfma_f32_16x16x32_bf16 v[16:19], v[64:67], a[40:43], v[16:19]
    ds_read_b128 v[92:95], v178 offset:16384
    v_mfma_f32_16x16x32_bf16 v[20:23], v[64:67], a[112:115], v[20:23]
    v_add_f32 v136, v136, v138
    buffer_load_dwordx4 a[124:127], v176, s[24:27], s97 offen offset:1024 sc1
    v_mfma_f32_16x16x32_bf16 v[24:27], v[68:71], a[40:43], v[24:27]
    ds_read_b128 v[96:99], v178 offset:17408
    v_mfma_f32_16x16x32_bf16 v[28:31], v[68:71], a[112:115], v[28:31]
    s_waitcnt lgkmcnt(8)
    v_mfma_f32_16x16x32_bf16 v[32:35], v[72:75], a[40:43], v[32:35]
    ds_read_b128 v[100:103], v178 offset:18432
    v_mfma_f32_16x16x32_bf16 v[36:39], v[72:75], a[112:115], v[36:39]
    v_mov_b32 v137, v136
    buffer_load_dwordx4 a[56:59], v176, s[24:27], s96 offen offset:2048 sc1
    v_mfma_f32_16x16x32_bf16 v[40:43], v[76:79], a[40:43], v[40:43]
    ds_read_b128 v[104:107], v178 offset:19456
    v_mfma_f32_16x16x32_bf16 v[44:47], v[76:79], a[112:115], v[44:47]
    s_waitcnt lgkmcnt(6)
    v_mfma_f32_16x16x32_bf16 v[48:51], v[80:83], a[40:43], v[48:51]
    ds_read_b128 v[108:111], v178 offset:20480
    v_mfma_f32_16x16x32_bf16 v[52:55], v[80:83], a[112:115], v[52:55]
    v_permlane16_swap_b32 v136, v137
    buffer_load_dwordx4 a[128:131], v176, s[24:27], s97 offen offset:2048 sc1
    v_mfma_f32_16x16x32_bf16 v[112:115], v[144:147], v[152:155], v[112:115]
    v_mfma_f32_16x16x32_bf16 v[116:119], v[148:151], v[152:155], v[116:119]
    ds_read_b128 v[156:159], v180 offset:14336
    ds_read_b128 v[160:163], v186 offset:14336
    ds_read_b128 v[164:167], v175 offset:11264
    s_waitcnt vmcnt(12)
    s_barrier
    s_waitcnt vmcnt(10) lgkmcnt(8)
    v_mfma_f32_16x16x32_bf16 v[0:3], v[84:87], a[44:47], v[0:3]
    ds_read_b128 v[56:59], v178 offset:21504
    v_mfma_f32_16x16x32_bf16 v[4:7], v[84:87], a[116:119], v[4:7]
    v_mul_f32 v122, 0xbae38e39, v136
    s_add_u32 m0, s89, 114688
    s_add_u32 s84, s8, 114688
    buffer_load_dwordx4 v254, s[24:27], s84 offen lds
    v_mfma_f32_16x16x32_bf16 v[8:11], v[88:91], a[44:47], v[8:11]
    ds_read_b128 v[60:63], v178 offset:22528
    v_mfma_f32_16x16x32_bf16 v[12:15], v[88:91], a[116:119], v[12:15]
    s_waitcnt lgkmcnt(8)
    v_mfma_f32_16x16x32_bf16 v[16:19], v[92:95], a[44:47], v[16:19]
    ds_read_b128 v[64:67], v178 offset:23552
    v_mfma_f32_16x16x32_bf16 v[20:23], v[92:95], a[116:119], v[20:23]
    v_mul_f32 v137, 0x3ae38e39, v137
    s_add_u32 m0, s89, 118784
    s_add_u32 s84, s8, 118784
    buffer_load_dwordx4 v254, s[24:27], s84 offen lds
    v_mfma_f32_16x16x32_bf16 v[24:27], v[96:99], a[44:47], v[24:27]
    ds_read_b128 v[68:71], v178 offset:24576
    v_mfma_f32_16x16x32_bf16 v[28:31], v[96:99], a[116:119], v[28:31]
    s_waitcnt lgkmcnt(8)
    v_mfma_f32_16x16x32_bf16 v[32:35], v[100:103], a[44:47], v[32:35]
    ds_read_b128 v[72:75], v178 offset:25600
    v_mfma_f32_16x16x32_bf16 v[36:39], v[100:103], a[116:119], v[36:39]
    v_fma_f32 v137, -v122, v122, v137
    s_add_u32 m0, s89, 122880
    s_add_u32 s84, s8, 122880
    buffer_load_dwordx4 v254, s[24:27], s84 offen lds
    v_mfma_f32_16x16x32_bf16 v[40:43], v[104:107], a[44:47], v[40:43]
    ds_read_b128 v[76:79], v178 offset:26624
    v_mfma_f32_16x16x32_bf16 v[44:47], v[104:107], a[116:119], v[44:47]
    s_waitcnt lgkmcnt(6)
    v_mfma_f32_16x16x32_bf16 v[48:51], v[108:111], a[44:47], v[48:51]
    ds_read_b128 v[80:83], v178 offset:27648
    v_mfma_f32_16x16x32_bf16 v[52:55], v[108:111], a[116:119], v[52:55]
    v_max_f32 v137, 0, v137
    s_mov_b32 m0, s12
    s_add_u32 s84, s8, s13
    buffer_load_dwordx4 v254, s[24:27], s84 offen lds
    v_mfma_f32_16x16x32_bf16 v[112:115], v[156:159], v[164:167], v[112:115]
    v_mfma_f32_16x16x32_bf16 v[116:119], v[160:163], v[164:167], v[116:119]
    ds_read_b128 v[144:147], v180 offset:21504
    ds_read_b128 v[148:151], v186 offset:21504
    ds_read_b128 v[152:155], v175 offset:12288
    s_waitcnt vmcnt(13)
    s_mov_b64 s[62:63], -1
    v_xor_b32 v173, s92, v168
    v_cmp_gt_u32 vcc, 8, v173
    s_nop 1
    s_and_b64 s[62:63], s[62:63], vcc
    v_xor_b32 v173, s92, v169
    v_cmp_gt_u32 vcc, 8, v173
    s_nop 1
    s_and_b64 s[62:63], s[62:63], vcc
    v_xor_b32 v173, s92, v170
    v_cmp_gt_u32 vcc, 8, v173
    s_nop 1
    s_and_b64 s[62:63], s[62:63], vcc
    v_xor_b32 v173, s92, v171
    v_cmp_gt_u32 vcc, 8, v173
    s_nop 1
    s_and_b64 s[62:63], s[62:63], vcc
    s_cmp_eq_u64 s[62:63], -1
    s_cbranch_scc1 Lp2g_23
    s_mov_b32 s59, 0
Lp2_22:
    buffer_load_dwordx4 v[168:171], v172, s[24:27], 0 offen sc1
    s_waitcnt vmcnt(0)
    s_mov_b64 s[62:63], -1
    v_xor_b32 v173, s92, v168
    v_cmp_gt_u32 vcc, 8, v173
    s_nop 1
    s_and_b64 s[62:63], s[62:63], vcc
    v_xor_b32 v173, s92, v169
    v_cmp_gt_u32 vcc, 8, v173
    s_nop 1
    s_and_b64 s[62:63], s[62:63], vcc
    v_xor_b32 v173, s92, v170
    v_cmp_gt_u32 vcc, 8, v173
    s_nop 1
    s_and_b64 s[62:63], s[62:63], vcc
    v_xor_b32 v173, s92, v171
    v_cmp_gt_u32 vcc, 8, v173
    s_nop 1
    s_and_b64 s[62:63], s[62:63], vcc
    s_cmp_eq_u64 s[62:63], -1
    s_cbranch_scc1 Lp2g_23
    s_add_u32 s59, s59, 1
    s_cmp_lt_u32 s59, 20000
    s_cbranch_scc1 Lp2_22
    s_add_u32 s51, s51, 1
Lp2g_23:
    s_nop 0
    s_barrier
    s_waitcnt vmcnt(11) lgkmcnt(8)
    v_mfma_f32_16x16x32_bf16 v[0:3], v[56:59], a[48:51], v[0:3]
    ds_read_b128 v[84:87], v178 offset:28672
    v_mfma_f32_16x16x32_bf16 v[4:7], v[56:59], a[120:123], v[4:7]
    v_add_f32 v137, 0x3727c5ac, v137
    buffer_load_dwordx4 a[60:63], v176, s[24:27], s96 offen offset:3072 sc1
    v_mfma_f32_16x16x32_bf16 v[8:11], v[60:63], a[48:51], v[8:11]
    ds_read_b128 v[88:91], v178 offset:29696
    v_mfma_f32_16x16x32_bf16 v[12:15], v[60:63], a[120:123], v[12:15]
    s_waitcnt lgkmcnt(8)
    v_mfma_f32_16x16x32_bf16 v[16:19], v[64:67], a[48:51], v[16:19]
    ds_read_b128 v[92:95], v178 offset:30720
    v_mfma_f32_16x16x32_bf16 v[20:23], v[64:67], a[120:123], v[20:23]
    v_rsq_f32 v128, v137
    buffer_load_dwordx4 a[132:135], v176, s[24:27], s97 offen offset:3072 sc1
    v_mfma_f32_16x16x32_bf16 v[24:27], v[68:71], a[48:51], v[24:27]
    ds_read_b128 v[96:99], v178 offset:31744
    v_mfma_f32_16x16x32_bf16 v[28:31], v[68:71], a[120:123], v[28:31]
    s_waitcnt lgkmcnt(8)
    v_mfma_f32_16x16x32_bf16 v[32:35], v[72:75], a[48:51], v[32:35]
    ds_read_b128 v[100:103], v178 offset:32768
    v_mfma_f32_16x16x32_bf16 v[36:39], v[72:75], a[120:123], v[36:39]
    v_add_f32 v140, v140, v142
    s_add_u32 s96, s96, 4096
    s_add_u32 s97, s97, 4096
    buffer_load_dwordx4 a[64:67], v176, s[24:27], s96 offen offset:0 sc1
    v_mfma_f32_16x16x32_bf16 v[40:43], v[76:79], a[48:51], v[40:43]
    ds_read_b128 v[104:107], v178 offset:33792
    v_mfma_f32_16x16x32_bf16 v[44:47], v[76:79], a[120:123], v[44:47]
    s_waitcnt lgkmcnt(6)
    v_mfma_f32_16x16x32_bf16 v[48:51], v[80:83], a[48:51], v[48:51]
    ds_read_b128 v[108:111], v178 offset:34816
    v_mfma_f32_16x16x32_bf16 v[52:55], v[80:83], a[120:123], v[52:55]
    v_add_f32 v141, v141, v143
    buffer_load_dwordx4 a[136:139], v176, s[24:27], s97 offen offset:0 sc1
    v_mfma_f32_16x16x32_bf16 v[112:115], v[144:147], v[152:155], v[112:115]
    v_mfma_f32_16x16x32_bf16 v[116:119], v[148:151], v[152:155], v[116:119]
    ds_read_b128 v[156:159], v180 offset:28672
    ds_read_b128 v[160:163], v186 offset:28672
    ds_read_b128 v[164:167], v175 offset:13312
    s_waitcnt vmcnt(12)
    s_barrier
    s_waitcnt vmcnt(10) lgkmcnt(8)
    v_mfma_f32_16x16x32_bf16 v[0:3], v[84:87], a[52:55], v[0:3]
    ds_read_b128 v[56:59], v178 offset:35840
    v_mfma_f32_16x16x32_bf16 v[4:7], v[84:87], a[124:127], v[4:7]
    v_permlane16_swap_b32 v140, v141
    buffer_load_dwordx4 a[68:71], v176, s[24:27], s96 offen offset:1024 sc1
    v_mfma_f32_16x16x32_bf16 v[8:11], v[88:91], a[52:55], v[8:11]
    ds_read_b128 v[60:63], v178 offset:36864
    v_mfma_f32_16x16x32_bf16 v[12:15], v[88:91], a[124:127], v[12:15]
    s_waitcnt lgkmcnt(8)
    v_mfma_f32_16x16x32_bf16 v[16:19], v[92:95], a[52:55], v[16:19]
    ds_read_b128 v[64:67], v178 offset:37888
    v_mfma_f32_16x16x32_bf16 v[20:23], v[92:95], a[124:127], v[20:23]
    v_add_f32 v140, v140, v141
    buffer_load_dwordx4 a[140:143], v176, s[24:27], s97 offen offset:1024 sc1
    v_mfma_f32_16x16x32_bf16 v[24:27], v[96:99], a[52:55], v[24:27]
    ds_read_b128 v[68:71], v178 offset:38912
    v_mfma_f32_16x16x32_bf16 v[28:31], v[96:99], a[124:127], v[28:31]
    s_waitcnt lgkmcnt(8)
    v_mfma_f32_16x16x32_bf16 v[32:35], v[100:103], a[52:55], v[32:35]
    ds_read_b128 v[72:75], v178 offset:39936
    v_mfma_f32_16x16x32_bf16 v[36:39], v[100:103], a[124:127], v[36:39]
    v_mov_b32 v142, v140
    s_add_u32 s84, s9, 0
    buffer_load_dwordx4 a[144:147], v254, s[24:27], s84 offen
    v_mfma_f32_16x16x32_bf16 v[40:43], v[104:107], a[52:55], v[40:43]
    ds_read_b128 v[76:79], v178 offset:40960
    v_mfma_f32_16x16x32_bf16 v[44:47], v[104:107], a[124:127], v[44:47]
    s_waitcnt lgkmcnt(6)
    v_mfma_f32_16x16x32_bf16 v[48:51], v[108:111], a[52:55], v[48:51]
    ds_read_b128 v[80:83], v178 offset:41984
    v_mfma_f32_16x16x32_bf16 v[52:55], v[108:111], a[124:127], v[52:55]
    v_permlane32_swap_b32 v140, v142
    s_add_u32 s84, s9, 4096
    buffer_load_dwordx4 a[148:151], v254, s[24:27], s84 offen
    v_mfma_f32_16x16x32_bf16 v[112:115], v[156:159], v[164:167], v[112:115]
    v_mfma_f32_16x16x32_bf16 v[116:119], v[160:163], v[164:167], v[116:119]
    ds_read_b128 v[144:147], v180 offset:35840
    ds_read_b128 v[148:151], v186 offset:35840
    ds_read_b128 v[152:155], v175 offset:14336
    s_waitcnt vmcnt(12) lgkmcnt(8)
    v_mfma_f32_16x16x32_bf16 v[0:3], v[56:59], a[56:59], v[0:3]
    ds_read_b128 v[84:87], v178 offset:43008
    v_mfma_f32_16x16x32_bf16 v[4:7], v[56:59], a[128:131], v[4:7]
    v_add_f32 v140, v140, v142
    s_add_u32 s84, s9, 8192
    buffer_load_dwordx4 a[152:155], v254, s[24:27], s84 offen
    v_mfma_f32_16x16x32_bf16 v[8:11], v[60:63], a[56:59], v[8:11]
    ds_read_b128 v[88:91], v178 offset:44032
    v_mfma_f32_16x16x32_bf16 v[12:15], v[60:63], a[128:131], v[12:15]
    s_waitcnt lgkmcnt(8)
    v_mfma_f32_16x16x32_bf16 v[16:19], v[64:67], a[56:59], v[16:19]
    ds_read_b128 v[92:95], v178 offset:45056
    v_mfma_f32_16x16x32_bf16 v[20:23], v[64:67], a[128:131], v[20:23]
    v_mov_b32 v141, v140
    s_add_u32 s84, s9, 12288
    buffer_load_dwordx4 a[156:159], v254, s[24:27], s84 offen
    v_mfma_f32_16x16x32_bf16 v[24:27], v[68:71], a[56:59], v[24:27]
    ds_read_b128 v[96:99], v178 offset:46080
    v_mfma_f32_16x16x32_bf16 v[28:31], v[68:71], a[128:131], v[28:31]
    s_waitcnt lgkmcnt(8)
    v_mfma_f32_16x16x32_bf16 v[32:35], v[72:75], a[56:59], v[32:35]
    ds_read_b128 v[100:103], v178 offset:47104
    v_mfma_f32_16x16x32_bf16 v[36:39], v[72:75], a[128:131], v[36:39]
    v_permlane16_swap_b32 v140, v141
    s_add_u32 s84, s9, 16384
    buffer_load_dwordx4 a[160:163], v254, s[24:27], s84 offen
    v_mfma_f32_16x16x32_bf16 v[40:43], v[76:79], a[56:59], v[40:43]
    ds_read_b128 v[104:107], v178 offset:48128
    v_mfma_f32_16x16x32_bf16 v[44:47], v[76:79], a[128:131], v[44:47]
    s_waitcnt lgkmcnt(6)
    v_mfma_f32_16x16x32_bf16 v[48:51], v[80:83], a[56:59], v[48:51]
    ds_read_b128 v[108:111], v178 offset:49152
    v_mfma_f32_16x16x32_bf16 v[52:55], v[80:83], a[128:131], v[52:55]
    v_mul_f32 v124, 0xbae38e39, v140
    s_add_u32 m0, s89, 0
    s_add_u32 s98, s10, 0
    buffer_load_dwordx4 v254, s[24:27], s98 offen lds
    v_mfma_f32_16x16x32_bf16 v[112:115], v[144:147], v[152:155], v[112:115]
    v_mfma_f32_16x16x32_bf16 v[116:119], v[148:151], v[152:155], v[116:119]
    ds_read_b128 v[156:159], v180 offset:43008
    ds_read_b128 v[160:163], v186 offset:43008
    ds_read_b128 v[164:167], v175 offset:15360
    s_waitcnt vmcnt(12)
    s_barrier
    s_waitcnt vmcnt(10) lgkmcnt(8)
    v_mfma_f32_16x16x32_bf16 v[0:3], v[84:87], a[60:63], v[0:3]
    ds_read_b128 v[56:59], v178 offset:50176
    v_mfma_f32_16x16x32_bf16 v[4:7], v[84:87], a[132:135], v[4:7]
    v_mul_f32 v141, 0x3ae38e39, v141
    s_add_u32 m0, s89, 4096
    s_add_u32 s98, s10, 4096
    buffer_load_dwordx4 v254, s[24:27], s98 offen lds
    v_mfma_f32_16x16x32_bf16 v[8:11], v[88:91], a[60:63], v[8:11]
    ds_read_b128 v[60:63], v178 offset:51200
    v_mfma_f32_16x16x32_bf16 v[12:15], v[88:91], a[132:135], v[12:15]
    s_waitcnt lgkmcnt(8)
    v_mfma_f32_16x16x32_bf16 v[16:19], v[92:95], a[60:63], v[16:19]
    ds_read_b128 v[64:67], v178 offset:52224
    v_mfma_f32_16x16x32_bf16 v[20:23], v[92:95], a[132:135], v[20:23]
    v_fma_f32 v141, -v124, v124, v141
    s_add_u32 m0, s89, 8192
    s_add_u32 s98, s10, 8192
    buffer_load_dwordx4 v254, s[24:27], s98 offen lds
    v_mfma_f32_16x16x32_bf16 v[24:27], v[96:99], a[60:63], v[24:27]
    ds_read_b128 v[68:71], v178 offset:53248
    v_mfma_f32_16x16x32_bf16 v[28:31], v[96:99], a[132:135], v[28:31]
    s_waitcnt lgkmcnt(8)
    v_mfma_f32_16x16x32_bf16 v[32:35], v[100:103], a[60:63], v[32:35]
    ds_read_b128 v[72:75], v178 offset:54272
    v_mfma_f32_16x16x32_bf16 v[36:39], v[100:103], a[132:135], v[36:39]
    v_max_f32 v141, 0, v141
    s_add_u32 m0, s89, 12288
    s_add_u32 s98, s10, 12288
    buffer_load_dwordx4 v254, s[24:27], s98 offen lds
    v_mfma_f32_16x16x32_bf16 v[40:43], v[104:107], a[60:63], v[40:43]
    ds_read_b128 v[76:79], v178 offset:55296
    v_mfma_f32_16x16x32_bf16 v[44:47], v[104:107], a[132:135], v[44:47]
    s_waitcnt lgkmcnt(6)
    v_mfma_f32_16x16x32_bf16 v[48:51], v[108:111], a[60:63], v[48:51]
    ds_read_b128 v[80:83], v178 offset:56320
    v_mfma_f32_16x16x32_bf16 v[52:55], v[108:111], a[132:135], v[52:55]
    v_add_f32 v141, 0x3727c5ac, v141
    s_add_u32 m0, s89, 16384
    s_add_u32 s98, s10, 16384
    buffer_load_dwordx4 v254, s[24:27], s98 offen lds
    v_mfma_f32_16x16x32_bf16 v[112:115], v[156:159], v[164:167], v[112:115]
    v_mfma_f32_16x16x32_bf16 v[116:119], v[160:163], v[164:167], v[116:119]
    ds_read_b128 v[144:147], v180 offset:50176
    ds_read_b128 v[148:151], v186 offset:50176
    ds_read_b128 v[152:155], v175 offset:16384
    s_waitcnt vmcnt(12) lgkmcnt(8)
    v_mfma_f32_16x16x32_bf16 v[0:3], v[56:59], a[64:67], v[0:3]
    ds_read_b128 v[84:87], v178 offset:57344
    v_mfma_f32_16x16x32_bf16 v[4:7], v[56:59], a[136:139], v[4:7]
    v_rsq_f32 v130, v141
    s_add_u32 m0, s89, 20480
    s_add_u32 s98, s10, 20480
    buffer_load_dwordx4 v254, s[24:27], s98 offen lds
    v_mfma_f32_16x16x32_bf16 v[8:11], v[60:63], a[64:67], v[8:11]
    ds_read_b128 v[88:91], v178 offset:58368
    v_mfma_f32_16x16x32_bf16 v[12:15], v[60:63], a[136:139], v[12:15]
    s_waitcnt lgkmcnt(8)
    v_mfma_f32_16x16x32_bf16 v[16:19], v[64:67], a[64:67], v[16:19]
    ds_read_b128 v[92:95], v178 offset:59392
    v_mfma_f32_16x16x32_bf16 v[20:23], v[64:67], a[136:139], v[20:23]
    s_add_u32 m0, s89, 24576
    s_add_u32 s98, s10, 24576
    buffer_load_dwordx4 v254, s[24:27], s98 offen lds
    v_mfma_f32_16x16x32_bf16 v[24:27], v[68:71], a[64:67], v[24:27]
    ds_read_b128 v[96:99], v178 offset:60416
    v_mfma_f32_16x16x32_bf16 v[28:31], v[68:71], a[136:139], v[28:31]
    s_waitcnt lgkmcnt(8)
    v_mfma_f32_16x16x32_bf16 v[32:35], v[72:75], a[64:67], v[32:35]
    ds_read_b128 v[100:103], v178 offset:61440
    v_mfma_f32_16x16x32_bf16 v[36:39], v[72:75], a[136:139], v[36:39]
    s_add_u32 m0, s89, 28672
    s_add_u32 s98, s10, 28672
    buffer_load_dwordx4 v254, s[24:27], s98 offen lds
    v_mfma_f32_16x16x32_bf16 v[40:43], v[76:79], a[64:67], v[40:43]
    ds_read_b128 v[104:107], v178 offset:62464
    v_mfma_f32_16x16x32_bf16 v[44:47], v[76:79], a[136:139], v[44:47]
    s_waitcnt lgkmcnt(6)
    v_mfma_f32_16x16x32_bf16 v[48:51], v[80:83], a[64:67], v[48:51]
    ds_read_b128 v[108:111], v178 offset:63488
    v_mfma_f32_16x16x32_bf16 v[52:55], v[80:83], a[136:139], v[52:55]
    s_add_u32 m0, s89, 32768
    s_add_u32 s98, s10, 32768
    buffer_load_dwordx4 v254, s[24:27], s98 offen lds
    v_mfma_f32_16x16x32_bf16 v[112:115], v[144:147], v[152:155], v[112:115]
    v_mfma_f32_16x16x32_bf16 v[116:119], v[148:151], v[152:155], v[116:119]
    ds_read_b128 v[156:159], v180 offset:57344
    ds_read_b128 v[160:163], v186 offset:57344
    ds_read_b128 v[164:167], v175 offset:17408
    s_waitcnt vmcnt(14) lgkmcnt(8)
    v_mfma_f32_16x16x32_bf16 v[0:3], v[84:87], a[68:71], v[0:3]
    v_mfma_f32_16x16x32_bf16 v[4:7], v[84:87], a[140:143], v[4:7]
    s_add_u32 m0, s89, 36864
    s_add_u32 s98, s10, 36864
    buffer_load_dwordx4 v254, s[24:27], s98 offen lds
    v_mfma_f32_16x16x32_bf16 v[8:11], v[88:91], a[68:71], v[8:11]
    v_mfma_f32_16x16x32_bf16 v[12:15], v[88:91], a[140:143], v[12:15]
    s_waitcnt lgkmcnt(6)
    v_mfma_f32_16x16x32_bf16 v[16:19], v[92:95], a[68:71], v[16:19]
    v_mfma_f32_16x16x32_bf16 v[20:23], v[92:95], a[140:143], v[20:23]
    s_add_u32 m0, s89, 40960
    s_add_u32 s98, s10, 40960
    buffer_load_dwordx4 v254, s[24:27], s98 offen lds
    v_mfma_f32_16x16x32_bf16 v[24:27], v[96:99], a[68:71], v[24:27]
    v_mfma_f32_16x16x32_bf16 v[28:31], v[96:99], a[140:143], v[28:31]
    s_waitcnt lgkmcnt(4)
    v_mfma_f32_16x16x32_bf16 v[32:35], v[100:103], a[68:71], v[32:35]
    v_mfma_f32_16x16x32_bf16 v[36:39], v[100:103], a[140:143], v[36:39]
    s_add_u32 m0, s89, 45056
    s_add_u32 s98, s10, 45056
    buffer_load_dwordx4 v254, s[24:27], s98 offen lds
    v_mfma_f32_16x16x32_bf16 v[40:43], v[104:107], a[68:71], v[40:43]
    v_mfma_f32_16x16x32_bf16 v[44:47], v[104:107], a[140:143], v[44:47]
    s_waitcnt lgkmcnt(0)
    v_mfma_f32_16x16x32_bf16 v[48:51], v[108:111], a[68:71], v[48:51]
    v_mfma_f32_16x16x32_bf16 v[52:55], v[108:111], a[140:143], v[52:55]
    s_add_u32 m0, s89, 49152
    s_add_u32 s98, s10, 49152
    buffer_load_dwordx4 v254, s[24:27], s98 offen lds
    v_mfma_f32_16x16x32_bf16 v[112:115], v[156:159], v[164:167], v[112:115]
    v_mfma_f32_16x16x32_bf16 v[116:119], v[160:163], v[164:167], v[116:119]
    s_add_u32 m0, s89, 53248
    s_add_u32 s98, s10, 53248
    buffer_load_dwordx4 v254, s[24:27], s98 offen lds
    s_add_u32 m0, s89, 57344
    s_add_u32 s98, s10, 57344
    buffer_load_dwordx4 v254, s[24:27], s98 offen lds
    s_add_u32 m0, s89, 61440
    s_add_u32 s98, s10, 61440
    buffer_load_dwordx4 v254, s[24:27], s98 offen lds
    s_add_u32 m0, s89, 65536
    s_add_u32 s98, s10, 65536
    buffer_load_dwordx4 v254, s[24:27], s98 offen lds
    s_add_u32 m0, s89, 69632
    s_add_u32 s98, s10, 69632
    buffer_load_dwordx4 v254, s[24:27], s98 offen lds
    s_add_u32 s56, s44, 2
    s_lshl_b32 s56, s56, 6
    s_add_u32 s56, s56, 162432
    s_add_u32 s57, s44, 4
    s_cmp_ge_u32 s44, 2
    s_cselect_b32 s57, s57, s44
    s_lshl_b32 s57, s57, 6
    s_add_u32 s57, s57, 162432
    v_lshlrev_b32 v148, 4, v199
    v_add_u32 v149, s57, v148
    v_add_u32 v148, s56, v148
    s_not_b64 exec, s[66:67]
    ds_write_b128 v148, v[112:115]
    ds_write_b128 v149, v[116:119]
    s_mov_b64 exec, -1
L_POST:
    v_mov_b32_dpp v152, v112 row_newbcast:0 row_mask:0xf bank_mask:0xf
    v_mov_b32_dpp v153, v113 row_newbcast:0 row_mask:0xf bank_mask:0xf
    v_mov_b32_dpp v154, v114 row_newbcast:0 row_mask:0xf bank_mask:0xf
    v_mov_b32_dpp v155, v115 row_newbcast:0 row_mask:0xf bank_mask:0xf
    v_pk_fma_f32 v[112:113], v[152:153], v[124:125], v[112:113] op_sel_hi:[1,0,1]
    v_pk_mul_f32 v[112:113], v[112:113], v[130:131] op_sel_hi:[1,0]
    v_pk_fma_f32 v[114:115], v[154:155], v[124:125], v[114:115] op_sel_hi:[1,0,1]
    v_pk_mul_f32 v[114:115], v[114:115], v[130:131] op_sel_hi:[1,0]
    v_cvt_pk_bf16_f32 v152, v112, v113
    v_cvt_pk_bf16_f32 v153, v114, v115
    v_mov_b32_dpp v156, v116 row_newbcast:0 row_mask:0xf bank_mask:0xf
    v_mov_b32_dpp v157, v117 row_newbcast:0 row_mask:0xf bank_mask:0xf
    v_mov_b32_dpp v158, v118 row_newbcast:0 row_mask:0xf bank_mask:0xf
    v_mov_b32_dpp v159, v119 row_newbcast:0 row_mask:0xf bank_mask:0xf
    v_pk_fma_f32 v[116:117], v[156:157], v[124:125], v[116:117] op_sel_hi:[1,0,1]
    v_pk_mul_f32 v[116:117], v[116:117], v[130:131] op_sel_hi:[1,0]
    v_pk_fma_f32 v[118:119], v[158:159], v[124:125], v[118:119] op_sel_hi:[1,0,1]
    v_pk_mul_f32 v[118:119], v[118:119], v[130:131] op_sel_hi:[1,0]
    v_cvt_pk_bf16_f32 v156, v116, v117
    v_cvt_pk_bf16_f32 v157, v118, v119
    s_waitcnt lgkmcnt(0)
    s_barrier
    ds_write_b64 v224, v[152:153]
    s_cmp_eq_u32 s44, 2
    s_cbranch_scc0 Lht_24
    ds_write_b64 v224, v[156:157] offset:64
Lht_24:
    v_lshlrev_b32 v148, 4, v199
    v_add_u32 v148, 162432, v148
    ds_read_b128 v[56:59], v148 offset:0
    ds_read_b128 v[60:63], v148 offset:64
    ds_read_b128 v[64:67], v148 offset:128
    ds_read_b128 v[68:71], v148 offset:192
    ds_read_b128 v[72:75], v148 offset:256
    ds_read_b128 v[76:79], v148 offset:320
    ds_read_b128 v[80:83], v148 offset:384
    s_waitcnt lgkmcnt(6)
    v_pk_fma_f32 v[0:1], v[56:57], v[120:121], v[0:1] op_sel_hi:[1,0,1]
    v_pk_mul_f32 v[0:1], v[0:1], v[126:127] op_sel_hi:[1,0]
    v_pk_fma_f32 v[2:3], v[58:59], v[120:121], v[2:3] op_sel_hi:[1,0,1]
    v_pk_mul_f32 v[2:3], v[2:3], v[126:127] op_sel_hi:[1,0]
    v_pk_fma_f32 v[4:5], v[56:57], v[122:123], v[4:5] op_sel_hi:[1,0,1]
    v_pk_mul_f32 v[4:5], v[4:5], v[128:129] op_sel_hi:[1,0]
    v_pk_fma_f32 v[6:7], v[58:59], v[122:123], v[6:7] op_sel_hi:[1,0,1]
    v_pk_mul_f32 v[6:7], v[6:7], v[128:129] op_sel_hi:[1,0]
    s_waitcnt lgkmcnt(5)
    v_pk_fma_f32 v[8:9], v[60:61], v[120:121], v[8:9] op_sel_hi:[1,0,1]
    v_pk_mul_f32 v[8:9], v[8:9], v[126:127] op_sel_hi:[1,0]
    v_pk_fma_f32 v[10:11], v[62:63], v[120:121], v[10:11] op_sel_hi:[1,0,1]
    v_pk_mul_f32 v[10:11], v[10:11], v[126:127] op_sel_hi:[1,0]
    v_pk_fma_f32 v[12:13], v[60:61], v[122:123], v[12:13] op_sel_hi:[1,0,1]
    v_pk_mul_f32 v[12:13], v[12:13], v[128:129] op_sel_hi:[1,0]
    v_pk_fma_f32 v[14:15], v[62:63], v[122:123], v[14:15] op_sel_hi:[1,0,1]
    v_pk_mul_f32 v[14:15], v[14:15], v[128:129] op_sel_hi:[1,0]
    s_cmp_eq_u32 s44, 3
    s_cbranch_scc0 Lpf_25
    s_getpc_b64 s[84:85]
Lpf_25_pc:
    s_sub_u32 s84, s84, Lpf_25_pc-interleave_layers__sliding_local_dilated__linear_kernel_hedgehog__prompt_kernel
    s_subb_u32 s85, s85, 0
    s_lshr_b32 s86, s2, 3
    s_and_b32 s86, s86, 31
    s_lshl_b32 s86, s86, 10
    v_add_u32 v140, s86, v254
    v_min_u32 v140, L_PF2-(L_PF1)-16, v140
    v_add_u32 v140, L_PF1-interleave_layers__sliding_local_dilated__linear_kernel_hedgehog__prompt_kernel, v140
    v_mov_b32 v141, s85
    v_add_co_u32 v140, vcc, s84, v140
    s_nop 1
    v_addc_co_u32 v141, vcc, 0, v141, vcc
    global_load_dwordx4 a[252:255], v[140:141], off
Lpf_25:
    s_waitcnt lgkmcnt(4)
    v_pk_fma_f32 v[16:17], v[64:65], v[120:121], v[16:17] op_sel_hi:[1,0,1]
    v_pk_mul_f32 v[16:17], v[16:17], v[126:127] op_sel_hi:[1,0]
    v_pk_fma_f32 v[18:19], v[66:67], v[120:121], v[18:19] op_sel_hi:[1,0,1]
    v_pk_mul_f32 v[18:19], v[18:19], v[126:127] op_sel_hi:[1,0]
    v_pk_fma_f32 v[20:21], v[64:65], v[122:123], v[20:21] op_sel_hi:[1,0,1]
    v_pk_mul_f32 v[20:21], v[20:21], v[128:129] op_sel_hi:[1,0]
    v_pk_fma_f32 v[22:23], v[66:67], v[122:123], v[22:23] op_sel_hi:[1,0,1]
    v_pk_mul_f32 v[22:23], v[22:23], v[128:129] op_sel_hi:[1,0]
    s_waitcnt lgkmcnt(3)
    v_pk_fma_f32 v[24:25], v[68:69], v[120:121], v[24:25] op_sel_hi:[1,0,1]
    v_pk_mul_f32 v[24:25], v[24:25], v[126:127] op_sel_hi:[1,0]
    v_pk_fma_f32 v[26:27], v[70:71], v[120:121], v[26:27] op_sel_hi:[1,0,1]
    v_pk_mul_f32 v[26:27], v[26:27], v[126:127] op_sel_hi:[1,0]
    v_pk_fma_f32 v[28:29], v[68:69], v[122:123], v[28:29] op_sel_hi:[1,0,1]
    v_pk_mul_f32 v[28:29], v[28:29], v[128:129] op_sel_hi:[1,0]
    v_pk_fma_f32 v[30:31], v[70:71], v[122:123], v[30:31] op_sel_hi:[1,0,1]
    v_pk_mul_f32 v[30:31], v[30:31], v[128:129] op_sel_hi:[1,0]
    s_add_u32 m0, s89, 73728
    s_add_u32 s98, s10, 73728
    buffer_load_dwordx4 v254, s[24:27], s98 offen lds
    s_waitcnt lgkmcnt(2)
    v_pk_fma_f32 v[32:33], v[72:73], v[120:121], v[32:33] op_sel_hi:[1,0,1]
    v_pk_mul_f32 v[32:33], v[32:33], v[126:127] op_sel_hi:[1,0]
    v_pk_fma_f32 v[34:35], v[74:75], v[120:121], v[34:35] op_sel_hi:[1,0,1]
    v_pk_mul_f32 v[34:35], v[34:35], v[126:127] op_sel_hi:[1,0]
    v_pk_fma_f32 v[36:37], v[72:73], v[122:123], v[36:37] op_sel_hi:[1,0,1]
    v_pk_mul_f32 v[36:37], v[36:37], v[128:129] op_sel_hi:[1,0]
    v_pk_fma_f32 v[38:39], v[74:75], v[122:123], v[38:39] op_sel_hi:[1,0,1]
    v_pk_mul_f32 v[38:39], v[38:39], v[128:129] op_sel_hi:[1,0]
    s_waitcnt lgkmcnt(1)
    v_pk_fma_f32 v[40:41], v[76:77], v[120:121], v[40:41] op_sel_hi:[1,0,1]
    v_pk_mul_f32 v[40:41], v[40:41], v[126:127] op_sel_hi:[1,0]
    v_pk_fma_f32 v[42:43], v[78:79], v[120:121], v[42:43] op_sel_hi:[1,0,1]
    v_pk_mul_f32 v[42:43], v[42:43], v[126:127] op_sel_hi:[1,0]
    v_pk_fma_f32 v[44:45], v[76:77], v[122:123], v[44:45] op_sel_hi:[1,0,1]
    v_pk_mul_f32 v[44:45], v[44:45], v[128:129] op_sel_hi:[1,0]
    v_pk_fma_f32 v[46:47], v[78:79], v[122:123], v[46:47] op_sel_hi:[1,0,1]
    v_pk_mul_f32 v[46:47], v[46:47], v[128:129] op_sel_hi:[1,0]
    s_add_u32 m0, s89, 77824
    s_add_u32 s98, s10, 77824
    buffer_load_dwordx4 v254, s[24:27], s98 offen lds
    s_waitcnt lgkmcnt(0)
    v_pk_fma_f32 v[48:49], v[80:81], v[120:121], v[48:49] op_sel_hi:[1,0,1]
    v_pk_mul_f32 v[48:49], v[48:49], v[126:127] op_sel_hi:[1,0]
    v_pk_fma_f32 v[50:51], v[82:83], v[120:121], v[50:51] op_sel_hi:[1,0,1]
    v_pk_mul_f32 v[50:51], v[50:51], v[126:127] op_sel_hi:[1,0]
    v_pk_fma_f32 v[52:53], v[80:81], v[122:123], v[52:53] op_sel_hi:[1,0,1]
    v_pk_mul_f32 v[52:53], v[52:53], v[128:129] op_sel_hi:[1,0]
    v_pk_fma_f32 v[54:55], v[82:83], v[122:123], v[54:55] op_sel_hi:[1,0,1]
    v_pk_mul_f32 v[54:55], v[54:55], v[128:129] op_sel_hi:[1,0]
    v_cvt_pk_bf16_f32 v84, v16, v17
    v_cvt_pk_bf16_f32 v85, v18, v19
    v_cvt_pk_bf16_f32 v86, v24, v25
    v_cvt_pk_bf16_f32 v87, v26, v27
    v_cvt_pk_bf16_f32 v88, v32, v33
    v_cvt_pk_bf16_f32 v89, v34, v35
    v_cvt_pk_bf16_f32 v90, v40, v41
    v_cvt_pk_bf16_f32 v91, v42, v43
    v_cvt_pk_bf16_f32 v92, v48, v49
    v_cvt_pk_bf16_f32 v93, v50, v51
    ds_write_b64 v223, v[84:85] offset:0
    ds_write_b64 v223, v[86:87] offset:32
    ds_write_b64 v223, v[88:89] offset:64
    ds_write_b64 v223, v[90:91] offset:96
    ds_write_b64 v223, v[92:93] offset:128
    s_mov_b32 m0, s93
    s_add_u32 s98, s10, s14
    buffer_load_dwordx4 v254, s[24:27], s98 offen lds
    v_cvt_pk_bf16_f32 v148, v0, v1
    v_cvt_pk_bf16_f32 v149, v2, v3
    v_cvt_pk_bf16_f32 v154, v8, v9
    v_cvt_pk_bf16_f32 v155, v10, v11
    v_and_b32 v150, v222, v92
    v_and_b32 v153, v222, v93
    v_mov_b32 v151, 0
    v_mov_b32 v152, 0
    v_cvt_pk_bf16_f32 v94, v20, v21
    v_cvt_pk_bf16_f32 v95, v22, v23
    v_cvt_pk_bf16_f32 v96, v28, v29
    v_cvt_pk_bf16_f32 v97, v30, v31
    v_cvt_pk_bf16_f32 v98, v36, v37
    v_cvt_pk_bf16_f32 v99, v38, v39
    v_cvt_pk_bf16_f32 v100, v44, v45
    v_cvt_pk_bf16_f32 v101, v46, v47
    v_cvt_pk_bf16_f32 v102, v52, v53
    v_cvt_pk_bf16_f32 v103, v54, v55
    ds_write_b64 v223, v[94:95] offset:2688
    ds_write_b64 v223, v[96:97] offset:2720
    ds_write_b64 v223, v[98:99] offset:2752
    ds_write_b64 v223, v[100:101] offset:2784
    ds_write_b64 v223, v[102:103] offset:2816
    s_add_u32 m0, s89, 86016
    s_add_u32 s84, s9, 86016
    buffer_load_dwordx4 v254, s[24:27], s84 offen lds
    v_cvt_pk_bf16_f32 v156, v4, v5
    v_cvt_pk_bf16_f32 v157, v6, v7
    v_cvt_pk_bf16_f32 v162, v12, v13
    v_cvt_pk_bf16_f32 v163, v14, v15
    v_and_b32 v158, v222, v102
    v_and_b32 v161, v222, v103
    v_mov_b32 v159, 0
    v_mov_b32 v160, 0
    s_add_u32 m0, s89, 90112
    s_add_u32 s84, s9, 90112
    buffer_load_dwordx4 v254, s[24:27], s84 offen lds
    s_waitcnt lgkmcnt(0)
    s_barrier
    s_add_u32 m0, s89, 94208
    s_add_u32 s84, s9, 94208
    buffer_load_dwordx4 v254, s[24:27], s84 offen lds
    ds_read_b64 v[0:1], v225 offset:0
    ds_read_b64 v[2:3], v226 offset:0
    ds_read_b64 v[4:5], v225 offset:32
    ds_read_b64 v[6:7], v225 offset:2688
    ds_read_b64 v[8:9], v226 offset:2688
    ds_read_b64 v[10:11], v225 offset:2720
    ds_read_b64 v[12:13], v225 offset:5376
    ds_read_b64 v[14:15], v226 offset:5376
    ds_read_b64 v[16:17], v225 offset:5408
    ds_read_b64_tr_b16 v[20:21], v227 offset:0
    ds_read_b64_tr_b16 v[22:23], v227 offset:2688
    ds_read_b64_tr_b16 v[24:25], v227 offset:5376
    ds_read_b64_tr_b16 v[26:27], v227 offset:32
    ds_read_b64_tr_b16 v[28:29], v227 offset:2720
    ds_read_b64_tr_b16 v[30:31], v227 offset:5408
    ds_read_b64_tr_b16 v[32:33], v228 offset:0
    ds_read_b64_tr_b16 v[34:35], v228 offset:2688
    ds_read_b64_tr_b16 v[36:37], v228 offset:5376
    s_waitcnt lgkmcnt(9)
    v_mfma_f32_16x16x32_bf16 v[56:59], v[0:3], v[148:151], v[210:213]
    v_mfma_f32_16x16x32_bf16 v[60:63], v[6:9], v[148:151], v[218:221]
    v_mfma_f32_16x16x32_bf16 v[64:67], v[2:5], v[152:155], v[210:213]
    v_mfma_f32_16x16x32_bf16 v[68:71], v[8:11], v[152:155], v[218:221]
    v_mfma_f32_16x16x32_bf16 v[72:75], v[6:9], v[156:159], v[214:217]
    v_mfma_f32_16x16x32_bf16 v[76:79], v[12:15], v[156:159], v[218:221]
    v_mfma_f32_16x16x32_bf16 v[80:83], v[8:11], v[160:163], v[214:217]
    v_mfma_f32_16x16x32_bf16 v[84:87], v[14:17], v[160:163], v[218:221]
    s_nop 0
    v_max3_f32 v88, v56, v57, v58
    v_max3_f32 v88, v88, v59, v60
    v_max3_f32 v88, v88, v61, v62
    v_max_f32 v88, v88, v63
    v_max3_f32 v89, v64, v65, v66
    v_max3_f32 v89, v89, v67, v68
    v_max3_f32 v89, v89, v69, v70
    v_max_f32 v89, v89, v71
    s_add_u32 m0, s89, 98304
    s_add_u32 s84, s9, 98304
    buffer_load_dwordx4 v254, s[24:27], s84 offen lds
    v_max3_f32 v90, v72, v73, v74
    v_max3_f32 v90, v90, v75, v76
    v_max3_f32 v90, v90, v77, v78
    v_max_f32 v90, v90, v79
    v_max3_f32 v91, v80, v81, v82
    v_max3_f32 v91, v91, v83, v84
    v_max3_f32 v91, v91, v85, v86
    v_max_f32 v91, v91, v87
    s_add_u32 m0, s89, 102400
    s_add_u32 s84, s9, 102400
    buffer_load_dwordx4 v254, s[24:27], s84 offen lds
    v_permlane16_swap_b32 v88, v89
    v_permlane16_swap_b32 v90, v91
    v_max_f32 v88, v88, v89
    v_max_f32 v90, v90, v91
    s_nop 1
    v_permlane32_swap_b32 v88, v90
    v_max_f32 v88, v88, v90
    v_mul_f32 v88, s80, v88
    v_sub_f32 v88, 0, v88
    v_mov_b32 v96, v88
    v_mov_b32 v98, v88
    s_nop 1
    v_permlane16_swap_b32 v96, v98
    v_mov_b32 v100, v96
    v_mov_b32 v102, v98
    s_nop 0
    v_permlane32_swap_b32 v96, v100
    v_permlane32_swap_b32 v98, v102
    v_pk_fma_f32 v[56:57], v[56:57], s[80:81], v[96:97] op_sel_hi:[1,1,0]
    v_pk_fma_f32 v[58:59], v[58:59], s[80:81], v[96:97] op_sel_hi:[1,1,0]
    v_pk_fma_f32 v[60:61], v[60:61], s[80:81], v[96:97] op_sel_hi:[1,1,0]
    v_pk_fma_f32 v[62:63], v[62:63], s[80:81], v[96:97] op_sel_hi:[1,1,0]
    v_exp_f32 v56, v56
    v_exp_f32 v57, v57
    v_exp_f32 v58, v58
    v_exp_f32 v59, v59
    s_add_u32 m0, s89, 106496
    s_add_u32 s84, s9, 106496
    buffer_load_dwordx4 v254, s[24:27], s84 offen lds
    v_exp_f32 v60, v60
    v_exp_f32 v61, v61
    v_exp_f32 v62, v62
    v_exp_f32 v63, v63
    s_add_u32 m0, s89, 110592
    s_add_u32 s84, s9, 110592
    buffer_load_dwordx4 v254, s[24:27], s84 offen lds
    v_pk_fma_f32 v[64:65], v[64:65], s[80:81], v[98:99] op_sel_hi:[1,1,0]
    v_pk_fma_f32 v[66:67], v[66:67], s[80:81], v[98:99] op_sel_hi:[1,1,0]
    v_pk_fma_f32 v[68:69], v[68:69], s[80:81], v[98:99] op_sel_hi:[1,1,0]
    v_pk_fma_f32 v[70:71], v[70:71], s[80:81], v[98:99] op_sel_hi:[1,1,0]
    v_exp_f32 v64, v64
    v_exp_f32 v65, v65
    v_exp_f32 v66, v66
    v_exp_f32 v67, v67
    s_add_u32 m0, s89, 114688
    s_add_u32 s84, s9, 114688
    buffer_load_dwordx4 v254, s[24:27], s84 offen lds
    v_exp_f32 v68, v68
    v_exp_f32 v69, v69
    v_exp_f32 v70, v70
    v_exp_f32 v71, v71
    s_add_u32 m0, s89, 118784
    s_add_u32 s84, s9, 118784
    buffer_load_dwordx4 v254, s[24:27], s84 offen lds
    v_pk_fma_f32 v[72:73], v[72:73], s[80:81], v[100:101] op_sel_hi:[1,1,0]
    v_pk_fma_f32 v[74:75], v[74:75], s[80:81], v[100:101] op_sel_hi:[1,1,0]
    v_pk_fma_f32 v[76:77], v[76:77], s[80:81], v[100:101] op_sel_hi:[1,1,0]
    v_pk_fma_f32 v[78:79], v[78:79], s[80:81], v[100:101] op_sel_hi:[1,1,0]
    v_exp_f32 v72, v72
    v_exp_f32 v73, v73
    v_exp_f32 v74, v74
    v_exp_f32 v75, v75
    s_add_u32 m0, s89, 122880
    s_add_u32 s84, s9, 122880
    buffer_load_dwordx4 v254, s[24:27], s84 offen lds
    v_exp_f32 v76, v76
    v_exp_f32 v77, v77
    v_exp_f32 v78, v78
    v_exp_f32 v79, v79
    s_mov_b32 m0, s12
    s_add_u32 s84, s9, s13
    buffer_load_dwordx4 v254, s[24:27], s84 offen lds
    v_pk_fma_f32 v[80:81], v[80:81], s[80:81], v[102:103] op_sel_hi:[1,1,0]
    v_pk_fma_f32 v[82:83], v[82:83], s[80:81], v[102:103] op_sel_hi:[1,1,0]
    v_pk_fma_f32 v[84:85], v[84:85], s[80:81], v[102:103] op_sel_hi:[1,1,0]
    v_pk_fma_f32 v[86:87], v[86:87], s[80:81], v[102:103] op_sel_hi:[1,1,0]
    v_exp_f32 v80, v80
    v_exp_f32 v81, v81
    v_exp_f32 v82, v82
    v_exp_f32 v83, v83
    s_add_u32 s84, s9, 20480
    buffer_load_dwordx4 a[164:167], v254, s[24:27], s84 offen
    v_exp_f32 v84, v84
    v_exp_f32 v85, v85
    v_exp_f32 v86, v86
    v_exp_f32 v87, v87
    s_add_u32 s84, s9, 24576
    buffer_load_dwordx4 a[168:171], v254, s[24:27], s84 offen
    v_cvt_pk_bf16_f32 v40, v56, v57
    v_cvt_pk_bf16_f32 v41, v58, v59
    v_cvt_pk_bf16_f32 v42, v60, v61
    v_cvt_pk_bf16_f32 v43, v62, v63
    v_cvt_pk_bf16_f32 v44, v64, v65
    v_cvt_pk_bf16_f32 v45, v66, v67
    v_cvt_pk_bf16_f32 v46, v68, v69
    v_cvt_pk_bf16_f32 v47, v70, v71
    s_add_u32 s84, s9, 28672
    buffer_load_dwordx4 a[172:175], v254, s[24:27], s84 offen
    v_cvt_pk_bf16_f32 v48, v72, v73
    v_cvt_pk_bf16_f32 v49, v74, v75
    v_cvt_pk_bf16_f32 v50, v76, v77
    v_cvt_pk_bf16_f32 v51, v78, v79
    v_cvt_pk_bf16_f32 v52, v80, v81
    v_cvt_pk_bf16_f32 v53, v82, v83
    v_cvt_pk_bf16_f32 v54, v84, v85
    v_cvt_pk_bf16_f32 v55, v86, v87
    s_add_u32 s84, s9, 32768
    buffer_load_dwordx4 a[176:179], v254, s[24:27], s84 offen
    s_waitcnt lgkmcnt(0)
    v_mfma_f32_16x16x32_bf16 v[88:91], a[232:235], v[40:43], 0
    v_mfma_f32_16x16x32_bf16 v[56:59], v[20:23], v[40:43], 0
    v_mfma_f32_16x16x32_bf16 v[72:75], v[32:35], v[40:43], 0
    v_mfma_f32_16x16x32_bf16 v[92:95], a[232:235], v[44:47], 0
    v_mfma_f32_16x16x32_bf16 v[60:63], v[26:29], v[44:47], 0
    v_mfma_f32_16x16x32_bf16 v[76:79], v[32:35], v[44:47], 0
    v_mfma_f32_16x16x32_bf16 v[96:99], a[232:235], v[48:51], 0
    v_mfma_f32_16x16x32_bf16 v[64:67], v[22:25], v[48:51], 0
    v_mfma_f32_16x16x32_bf16 v[80:83], v[34:37], v[48:51], 0
    v_mfma_f32_16x16x32_bf16 v[100:103], a[232:235], v[52:55], 0
    v_mfma_f32_16x16x32_bf16 v[68:71], v[28:31], v[52:55], 0
    v_mfma_f32_16x16x32_bf16 v[84:87], v[34:37], v[52:55], 0
    v_rcp_f32 v112, v88
    v_rcp_f32 v114, v92
    s_nop 0
    v_rcp_f32 v116, v96
    s_nop 1
    v_rcp_f32 v118, v100
    v_pk_mul_f32 v[56:57], v[56:57], v[112:113] op_sel_hi:[1,0]
    v_pk_mul_f32 v[58:59], v[58:59], v[112:113] op_sel_hi:[1,0]
    v_pk_mul_f32 v[72:73], v[72:73], v[112:113] op_sel_hi:[1,0]
    v_cvt_pk_bf16_f32 v120, v56, v57
    v_cvt_pk_bf16_f32 v121, v58, v59
    v_cvt_pk_bf16_f32 v128, v72, v73
    v_pk_mul_f32 v[60:61], v[60:61], v[114:115] op_sel_hi:[1,0]
    v_pk_mul_f32 v[62:63], v[62:63], v[114:115] op_sel_hi:[1,0]
    v_pk_mul_f32 v[78:79], v[78:79], v[114:115] op_sel_hi:[1,0]
    v_cvt_pk_bf16_f32 v122, v60, v61
    v_cvt_pk_bf16_f32 v123, v62, v63
    v_cvt_pk_bf16_f32 v129, v78, v79
    v_pk_mul_f32 v[64:65], v[64:65], v[116:117] op_sel_hi:[1,0]
    v_pk_mul_f32 v[66:67], v[66:67], v[116:117] op_sel_hi:[1,0]
    v_pk_mul_f32 v[80:81], v[80:81], v[116:117] op_sel_hi:[1,0]
    v_cvt_pk_bf16_f32 v124, v64, v65
    v_cvt_pk_bf16_f32 v125, v66, v67
    v_cvt_pk_bf16_f32 v130, v80, v81
    v_pk_mul_f32 v[68:69], v[68:69], v[118:119] op_sel_hi:[1,0]
    v_pk_mul_f32 v[70:71], v[70:71], v[118:119] op_sel_hi:[1,0]
    v_pk_mul_f32 v[86:87], v[86:87], v[118:119] op_sel_hi:[1,0]
    v_cvt_pk_bf16_f32 v126, v68, v69
    v_cvt_pk_bf16_f32 v127, v70, v71
    v_cvt_pk_bf16_f32 v131, v86, v87
    s_add_u32 s84, s9, 36864
    buffer_load_dwordx4 a[180:183], v254, s[24:27], s84 offen
    s_cmp_eq_u32 s41, 0
    s_cbranch_scc1 Lss_26
    buffer_store_dwordx2 v[120:121], v188, s[24:27], 0 offen
    buffer_store_dwordx2 v[122:123], v189, s[24:27], 0 offen
    buffer_store_dwordx2 v[124:125], v188, s[24:27], s77 offen
    buffer_store_dwordx2 v[126:127], v189, s[24:27], s77 offen
    buffer_store_dwordx2 v[128:129], v190, s[24:27], 0 offen
    buffer_store_dwordx2 v[130:131], v190, s[24:27], s77 offen
Lsj_27:
    v_mov_b32 v100, v200
    v_mov_b32 v101, v201
    v_mov_b32 v102, v202
    v_mov_b32 v103, v203
    v_mov_b32 v104, v204
    v_mov_b32 v105, v205
    v_mov_b32 v106, v206
    v_mov_b32 v107, v207
    v_mov_b32 v108, v208
    v_mov_b32 v109, v209
    v_permlane16_swap_b32 v100, v102
    v_permlane16_swap_b32 v101, v103
    v_permlane16_swap_b32 v104, v106
    v_permlane16_swap_b32 v105, v107
    v_lshlrev_b32 v0, 16, v100
    v_and_b32 v1, 0xffff0000, v100
    v_lshlrev_b32 v2, 16, v101
    v_and_b32 v3, 0xffff0000, v101
    v_lshlrev_b32 v4, 16, v102
    v_and_b32 v5, 0xffff0000, v102
    v_lshlrev_b32 v6, 16, v103
    v_and_b32 v7, 0xffff0000, v103
    v_lshlrev_b32 v8, 16, v104
    v_and_b32 v9, 0xffff0000, v104
    v_lshlrev_b32 v10, 16, v105
    v_and_b32 v11, 0xffff0000, v105
    v_lshlrev_b32 v12, 16, v106
    v_and_b32 v13, 0xffff0000, v106
    v_lshlrev_b32 v14, 16, v107
    v_and_b32 v15, 0xffff0000, v107
    v_lshlrev_b32 v16, 16, v108
    v_and_b32 v17, 0xffff0000, v108
    v_lshlrev_b32 v18, 16, v109
    v_and_b32 v19, 0xffff0000, v109
L_PF1:
    s_waitcnt vmcnt(0)
    s_barrier
    s_cmp_eq_u32 s44, 0
    s_cbranch_scc0 Lw0_28
    s_lshl_b32 s58, s47, 3
    s_add_u32 s58, s58, s48
    s_add_u32 s58, s58, 1
    s_not_b32 s59, s58
    s_xor_b32 s59, s59, s42
    v_mov_b32 v172, s58
    v_mov_b32 v173, s59
    s_mov_b64 exec, 1
    s_cmp_eq_u32 s41, 0
    s_cbranch_scc1 Lss_30
    buffer_store_dwordx2 v[172:173], v255, s[24:27], s52 offen
Lsj_31:
    s_mov_b64 exec, -1
    s_lshl_b32 s58, s47, 3
    s_add_u32 s58, s58, s48
    s_add_u32 s58, s58, 1
    s_mov_b64 exec, 0xffff
    s_mov_b32 s59, 0
    buffer_load_dwordx2 v[172:173], v195, s[24:27], 0 offen sc1
    s_sleep 2
    buffer_load_dwordx2 v[170:171], v195, s[24:27], 0 offen sc1
    s_sleep 2
    buffer_load_dwordx2 v[168:169], v195, s[24:27], 0 offen sc1
Lpoll_32:
    s_waitcnt vmcnt(2)
    v_subrev_u32 v174, s58, v172
    v_xor_b32 v175, v172, v173
    v_cmp_gt_u32 vcc, 32, v174
    v_or_b32 v174, 7, v175
    v_cmp_eq_u32 s[60:61], -1, v174
    s_nop 1
    s_and_b64 vcc, vcc, s[60:61]
    s_cmp_eq_u64 vcc, exec
    s_cbranch_scc1 Lgot_33
    buffer_load_dwordx2 v[172:173], v195, s[24:27], 0 offen sc1
    s_waitcnt vmcnt(2)
    v_subrev_u32 v174, s58, v170
    v_xor_b32 v175, v170, v171
    v_cmp_gt_u32 vcc, 32, v174
    v_or_b32 v174, 7, v175
    v_cmp_eq_u32 s[60:61], -1, v174
    s_nop 1
    s_and_b64 vcc, vcc, s[60:61]
    s_cmp_eq_u64 vcc, exec
    s_cbranch_scc1 Lgot_33
    buffer_load_dwordx2 v[170:171], v195, s[24:27], 0 offen sc1
    s_waitcnt vmcnt(2)
    v_subrev_u32 v174, s58, v168
    v_xor_b32 v175, v168, v169
    v_cmp_gt_u32 vcc, 32, v174
    v_or_b32 v174, 7, v175
    v_cmp_eq_u32 s[60:61], -1, v174
    s_nop 1
    s_and_b64 vcc, vcc, s[60:61]
    s_cmp_eq_u64 vcc, exec
    s_cbranch_scc1 Lgot_33
    buffer_load_dwordx2 v[168:169], v195, s[24:27], 0 offen sc1
    s_add_u32 s59, s59, 1
    s_cmp_lt_u32 s59, 20000
    s_cbranch_scc1 Lpoll_32
    s_add_u32 s51, s51, 1
Lgot_33:
    s_mov_b64 exec, -1
Lw0_28:
    s_nop 0
    s_barrier
    s_mov_b32 s96, 0
    buffer_load_dwordx4 a[0:3], v187, s[24:27], s96 offen offset:0 sc1
    buffer_load_dwordx4 a[4:7], v187, s[24:27], s96 offen offset:1024 sc1
    buffer_load_dwordx4 a[8:11], v187, s[24:27], s96 offen offset:2048 sc1
    buffer_load_dwordx4 a[12:15], v187, s[24:27], s96 offen offset:3072 sc1
    s_mov_b32 s96, 4096
    buffer_load_dwordx4 a[16:19], v187, s[24:27], s96 offen offset:0 sc1
    buffer_load_dwordx4 a[20:23], v187, s[24:27], s96 offen offset:1024 sc1
    buffer_load_dwordx4 a[24:27], v187, s[24:27], s96 offen offset:2048 sc1
    buffer_load_dwordx4 a[28:31], v187, s[24:27], s96 offen offset:3072 sc1
    s_mov_b32 s96, 8192
    buffer_load_dwordx4 a[32:35], v187, s[24:27], s96 offen offset:0 sc1
    buffer_load_dwordx4 a[36:39], v187, s[24:27], s96 offen offset:1024 sc1
    ds_read_b128 v[56:59], v181 offset:0
    ds_read_b128 v[60:63], v181 offset:1024
    ds_read_b128 v[64:67], v181 offset:2048
    ds_read_b128 v[68:71], v181 offset:3072
    ds_read_b128 v[72:75], v183 offset:0
    s_waitcnt vmcnt(9) lgkmcnt(3)
    v_mfma_f32_16x16x32_bf16 v[0:3], v[56:59], a[0:3], v[0:3]
    ds_read_b128 v[76:79], v181 offset:4608
    v_mfma_f32_16x16x32_bf16 v[4:7], v[60:63], a[0:3], v[4:7]
    ds_read_b128 v[80:83], v181 offset:5632
    buffer_load_dwordx4 a[40:43], v187, s[24:27], s96 offen offset:2048 sc1
    s_waitcnt lgkmcnt(2)
    v_mfma_f32_16x16x32_bf16 v[8:11], v[64:67], a[0:3], v[8:11]
    ds_read_b128 v[84:87], v181 offset:6656
    v_mfma_f32_16x16x32_bf16 v[12:15], v[68:71], a[0:3], v[12:15]
    ds_read_b128 v[88:91], v181 offset:7680
    v_mfma_f32_16x16x32_bf16 v[16:19], v[72:75], a[0:3], v[16:19]
    ds_read_b128 v[92:95], v183 offset:4608
    s_waitcnt vmcnt(9) lgkmcnt(3)
    v_mfma_f32_16x16x32_bf16 v[0:3], v[76:79], a[4:7], v[0:3]
    ds_read_b128 v[56:59], v181 offset:9216
    v_mfma_f32_16x16x32_bf16 v[4:7], v[80:83], a[4:7], v[4:7]
    ds_read_b128 v[60:63], v181 offset:10240
    buffer_load_dwordx4 a[44:47], v187, s[24:27], s96 offen offset:3072 sc1
    s_waitcnt lgkmcnt(2)
    v_mfma_f32_16x16x32_bf16 v[8:11], v[84:87], a[4:7], v[8:11]
    ds_read_b128 v[64:67], v181 offset:11264
    v_mfma_f32_16x16x32_bf16 v[12:15], v[88:91], a[4:7], v[12:15]
    ds_read_b128 v[68:71], v181 offset:12288
    v_mfma_f32_16x16x32_bf16 v[16:19], v[92:95], a[4:7], v[16:19]
    ds_read_b128 v[72:75], v183 offset:9216
    s_waitcnt vmcnt(9) lgkmcnt(3)
    v_mfma_f32_16x16x32_bf16 v[0:3], v[56:59], a[8:11], v[0:3]
    ds_read_b128 v[76:79], v181 offset:13824
    v_mfma_f32_16x16x32_bf16 v[4:7], v[60:63], a[8:11], v[4:7]
    ds_read_b128 v[80:83], v181 offset:14848
    s_mov_b32 s96, 12288
    buffer_load_dwordx4 a[48:51], v187, s[24:27], s96 offen offset:0 sc1
    s_waitcnt lgkmcnt(2)
    v_mfma_f32_16x16x32_bf16 v[8:11], v[64:67], a[8:11], v[8:11]
    ds_read_b128 v[84:87], v181 offset:15872
    v_mfma_f32_16x16x32_bf16 v[12:15], v[68:71], a[8:11], v[12:15]
    ds_read_b128 v[88:91], v181 offset:16896
    v_mfma_f32_16x16x32_bf16 v[16:19], v[72:75], a[8:11], v[16:19]
    ds_read_b128 v[92:95], v183 offset:13824
    s_waitcnt vmcnt(9) lgkmcnt(3)
    v_mfma_f32_16x16x32_bf16 v[0:3], v[76:79], a[12:15], v[0:3]
    ds_read_b128 v[56:59], v181 offset:18432
    v_mfma_f32_16x16x32_bf16 v[4:7], v[80:83], a[12:15], v[4:7]
    ds_read_b128 v[60:63], v181 offset:19456
    buffer_load_dwordx4 a[52:55], v187, s[24:27], s96 offen offset:1024 sc1
    s_waitcnt lgkmcnt(2)
    v_mfma_f32_16x16x32_bf16 v[8:11], v[84:87], a[12:15], v[8:11]
    ds_read_b128 v[64:67], v181 offset:20480
    v_mfma_f32_16x16x32_bf16 v[12:15], v[88:91], a[12:15], v[12:15]
    ds_read_b128 v[68:71], v181 offset:21504
    v_mfma_f32_16x16x32_bf16 v[16:19], v[92:95], a[12:15], v[16:19]
    ds_read_b128 v[72:75], v183 offset:18432
    s_waitcnt vmcnt(9) lgkmcnt(3)
    v_mfma_f32_16x16x32_bf16 v[0:3], v[56:59], a[16:19], v[0:3]
    ds_read_b128 v[76:79], v181 offset:23040
    v_mfma_f32_16x16x32_bf16 v[4:7], v[60:63], a[16:19], v[4:7]
    ds_read_b128 v[80:83], v181 offset:24064
    buffer_load_dwordx4 a[56:59], v187, s[24:27], s96 offen offset:2048 sc1
    s_waitcnt lgkmcnt(2)
    v_mfma_f32_16x16x32_bf16 v[8:11], v[64:67], a[16:19], v[8:11]
    ds_read_b128 v[84:87], v181 offset:25088
    v_mfma_f32_16x16x32_bf16 v[12:15], v[68:71], a[16:19], v[12:15]
    ds_read_b128 v[88:91], v181 offset:26112
    v_mfma_f32_16x16x32_bf16 v[16:19], v[72:75], a[16:19], v[16:19]
    ds_read_b128 v[92:95], v183 offset:23040
    s_waitcnt vmcnt(9) lgkmcnt(3)
    v_mfma_f32_16x16x32_bf16 v[0:3], v[76:79], a[20:23], v[0:3]
    ds_read_b128 v[56:59], v181 offset:27648
    v_mfma_f32_16x16x32_bf16 v[4:7], v[80:83], a[20:23], v[4:7]
    ds_read_b128 v[60:63], v181 offset:28672
    buffer_load_dwordx4 a[60:63], v187, s[24:27], s96 offen offset:3072 sc1
    s_waitcnt lgkmcnt(2)
    v_mfma_f32_16x16x32_bf16 v[8:11], v[84:87], a[20:23], v[8:11]
    ds_read_b128 v[64:67], v181 offset:29696
    v_mfma_f32_16x16x32_bf16 v[12:15], v[88:91], a[20:23], v[12:15]
    ds_read_b128 v[68:71], v181 offset:30720
    v_mfma_f32_16x16x32_bf16 v[16:19], v[92:95], a[20:23], v[16:19]
    ds_read_b128 v[72:75], v183 offset:27648
    s_waitcnt vmcnt(9) lgkmcnt(3)
    v_mfma_f32_16x16x32_bf16 v[0:3], v[56:59], a[24:27], v[0:3]
    ds_read_b128 v[76:79], v181 offset:32256
    v_mfma_f32_16x16x32_bf16 v[4:7], v[60:63], a[24:27], v[4:7]
    ds_read_b128 v[80:83], v181 offset:33280
    s_mov_b32 s96, 16384
    buffer_load_dwordx4 a[64:67], v187, s[24:27], s96 offen offset:0 sc1
    s_waitcnt lgkmcnt(2)
    v_mfma_f32_16x16x32_bf16 v[8:11], v[64:67], a[24:27], v[8:11]
    ds_read_b128 v[84:87], v181 offset:34304
    v_mfma_f32_16x16x32_bf16 v[12:15], v[68:71], a[24:27], v[12:15]
    ds_read_b128 v[88:91], v181 offset:35328
    v_mfma_f32_16x16x32_bf16 v[16:19], v[72:75], a[24:27], v[16:19]
    ds_read_b128 v[92:95], v183 offset:32256
    s_waitcnt vmcnt(9) lgkmcnt(3)
    v_mfma_f32_16x16x32_bf16 v[0:3], v[76:79], a[28:31], v[0:3]
    ds_read_b128 v[56:59], v181 offset:36864
    v_mfma_f32_16x16x32_bf16 v[4:7], v[80:83], a[28:31], v[4:7]
    ds_read_b128 v[60:63], v181 offset:37888
    buffer_load_dwordx4 a[68:71], v187, s[24:27], s96 offen offset:1024 sc1
    s_waitcnt lgkmcnt(2)
    v_mfma_f32_16x16x32_bf16 v[8:11], v[84:87], a[28:31], v[8:11]
    ds_read_b128 v[64:67], v181 offset:38912
    v_mfma_f32_16x16x32_bf16 v[12:15], v[88:91], a[28:31], v[12:15]
    ds_read_b128 v[68:71], v181 offset:39936
    s_add_u32 s84, s9, 40960
    buffer_load_dwordx4 a[184:187], v254, s[24:27], s84 offen
    v_mfma_f32_16x16x32_bf16 v[16:19], v[92:95], a[28:31], v[16:19]
    ds_read_b128 v[72:75], v183 offset:36864
    s_waitcnt vmcnt(10) lgkmcnt(3)
    v_mfma_f32_16x16x32_bf16 v[0:3], v[56:59], a[32:35], v[0:3]
    ds_read_b128 v[76:79], v182 offset:0
    v_mfma_f32_16x16x32_bf16 v[4:7], v[60:63], a[32:35], v[4:7]
    ds_read_b128 v[80:83], v182 offset:1024
    s_add_u32 s84, s9, 45056
    buffer_load_dwordx4 a[188:191], v254, s[24:27], s84 offen
    s_waitcnt lgkmcnt(2)
    v_mfma_f32_16x16x32_bf16 v[8:11], v[64:67], a[32:35], v[8:11]
    ds_read_b128 v[84:87], v182 offset:2048
    v_mfma_f32_16x16x32_bf16 v[12:15], v[68:71], a[32:35], v[12:15]
    ds_read_b128 v[88:91], v182 offset:3072
    v_mfma_f32_16x16x32_bf16 v[16:19], v[72:75], a[32:35], v[16:19]
    ds_read_b128 v[92:95], v184 offset:0
    s_waitcnt vmcnt(10) lgkmcnt(3)
    v_mfma_f32_16x16x32_bf16 v[0:3], v[76:79], a[36:39], v[0:3]
    ds_read_b128 v[56:59], v182 offset:4608
    v_mfma_f32_16x16x32_bf16 v[4:7], v[80:83], a[36:39], v[4:7]
    ds_read_b128 v[60:63], v182 offset:5632
    s_add_u32 s84, s9, 49152
    buffer_load_dwordx4 a[192:195], v254, s[24:27], s84 offen
    s_waitcnt lgkmcnt(2)
    v_mfma_f32_16x16x32_bf16 v[8:11], v[84:87], a[36:39], v[8:11]
    ds_read_b128 v[64:67], v182 offset:6656
    v_mfma_f32_16x16x32_bf16 v[12:15], v[88:91], a[36:39], v[12:15]
    ds_read_b128 v[68:71], v182 offset:7680
    v_mfma_f32_16x16x32_bf16 v[16:19], v[92:95], a[36:39], v[16:19]
    ds_read_b128 v[72:75], v184 offset:4608
    s_waitcnt vmcnt(10) lgkmcnt(3)
    v_mfma_f32_16x16x32_bf16 v[0:3], v[56:59], a[40:43], v[0:3]
    ds_read_b128 v[76:79], v182 offset:9216
    v_mfma_f32_16x16x32_bf16 v[4:7], v[60:63], a[40:43], v[4:7]
    ds_read_b128 v[80:83], v182 offset:10240
    s_add_u32 s84, s9, 53248
    buffer_load_dwordx4 a[196:199], v254, s[24:27], s84 offen
    s_waitcnt lgkmcnt(2)
    v_mfma_f32_16x16x32_bf16 v[8:11], v[64:67], a[40:43], v[8:11]
    ds_read_b128 v[84:87], v182 offset:11264
    v_mfma_f32_16x16x32_bf16 v[12:15], v[68:71], a[40:43], v[12:15]
    ds_read_b128 v[88:91], v182 offset:12288
    v_mfma_f32_16x16x32_bf16 v[16:19], v[72:75], a[40:43], v[16:19]
    ds_read_b128 v[92:95], v184 offset:9216
    s_waitcnt vmcnt(10) lgkmcnt(3)
    v_mfma_f32_16x16x32_bf16 v[0:3], v[76:79], a[44:47], v[0:3]
    ds_read_b128 v[56:59], v182 offset:13824
    v_mfma_f32_16x16x32_bf16 v[4:7], v[80:83], a[44:47], v[4:7]
    ds_read_b128 v[60:63], v182 offset:14848
    s_add_u32 s84, s9, 57344
    buffer_load_dwordx4 a[200:203], v254, s[24:27], s84 offen
    s_waitcnt lgkmcnt(2)
    v_mfma_f32_16x16x32_bf16 v[8:11], v[84:87], a[44:47], v[8:11]
    ds_read_b128 v[64:67], v182 offset:15872
    v_mfma_f32_16x16x32_bf16 v[12:15], v[88:91], a[44:47], v[12:15]
    ds_read_b128 v[68:71], v182 offset:16896
    v_mfma_f32_16x16x32_bf16 v[16:19], v[92:95], a[44:47], v[16:19]
    ds_read_b128 v[72:75], v184 offset:13824
    s_waitcnt vmcnt(10) lgkmcnt(3)
    v_mfma_f32_16x16x32_bf16 v[0:3], v[56:59], a[48:51], v[0:3]
    ds_read_b128 v[76:79], v182 offset:18432
    v_mfma_f32_16x16x32_bf16 v[4:7], v[60:63], a[48:51], v[4:7]
    ds_read_b128 v[80:83], v182 offset:19456
    s_add_u32 s84, s9, 61440
    buffer_load_dwordx4 a[204:207], v254, s[24:27], s84 offen
    s_waitcnt lgkmcnt(2)
    v_mfma_f32_16x16x32_bf16 v[8:11], v[64:67], a[48:51], v[8:11]
    ds_read_b128 v[84:87], v182 offset:20480
    v_mfma_f32_16x16x32_bf16 v[12:15], v[68:71], a[48:51], v[12:15]
    ds_read_b128 v[88:91], v182 offset:21504
    v_mfma_f32_16x16x32_bf16 v[16:19], v[72:75], a[48:51], v[16:19]
    ds_read_b128 v[92:95], v184 offset:18432
    s_waitcnt vmcnt(10) lgkmcnt(3)
    v_mfma_f32_16x16x32_bf16 v[0:3], v[76:79], a[52:55], v[0:3]
    ds_read_b128 v[56:59], v182 offset:23040
    v_mfma_f32_16x16x32_bf16 v[4:7], v[80:83], a[52:55], v[4:7]
    ds_read_b128 v[60:63], v182 offset:24064
    s_add_u32 s84, s9, 65536
    buffer_load_dwordx4 a[208:211], v254, s[24:27], s84 offen
    s_waitcnt lgkmcnt(2)
    v_mfma_f32_16x16x32_bf16 v[8:11], v[84:87], a[52:55], v[8:11]
    ds_read_b128 v[64:67], v182 offset:25088
    v_mfma_f32_16x16x32_bf16 v[12:15], v[88:91], a[52:55], v[12:15]
    ds_read_b128 v[68:71], v182 offset:26112
    v_mfma_f32_16x16x32_bf16 v[16:19], v[92:95], a[52:55], v[16:19]
    ds_read_b128 v[72:75], v184 offset:23040
    s_waitcnt vmcnt(10) lgkmcnt(3)
    v_mfma_f32_16x16x32_bf16 v[0:3], v[56:59], a[56:59], v[0:3]
    ds_read_b128 v[76:79], v182 offset:27648
    v_mfma_f32_16x16x32_bf16 v[4:7], v[60:63], a[56:59], v[4:7]
    ds_read_b128 v[80:83], v182 offset:28672
    s_add_u32 s84, s9, 69632
    buffer_load_dwordx4 a[212:215], v254, s[24:27], s84 offen
    s_waitcnt lgkmcnt(2)
    v_mfma_f32_16x16x32_bf16 v[8:11], v[64:67], a[56:59], v[8:11]
    ds_read_b128 v[84:87], v182 offset:29696
    v_mfma_f32_16x16x32_bf16 v[12:15], v[68:71], a[56:59], v[12:15]
    ds_read_b128 v[88:91], v182 offset:30720
    v_mfma_f32_16x16x32_bf16 v[16:19], v[72:75], a[56:59], v[16:19]
    ds_read_b128 v[92:95], v184 offset:27648
    s_waitcnt vmcnt(10) lgkmcnt(3)
    v_mfma_f32_16x16x32_bf16 v[0:3], v[76:79], a[60:63], v[0:3]
    ds_read_b128 v[56:59], v182 offset:32256
    v_mfma_f32_16x16x32_bf16 v[4:7], v[80:83], a[60:63], v[4:7]
    ds_read_b128 v[60:63], v182 offset:33280
    s_add_u32 s84, s9, 73728
    buffer_load_dwordx4 a[132:135], v254, s[24:27], s84 offen
    s_waitcnt lgkmcnt(2)
    v_mfma_f32_16x16x32_bf16 v[8:11], v[84:87], a[60:63], v[8:11]
    ds_read_b128 v[64:67], v182 offset:34304
    v_mfma_f32_16x16x32_bf16 v[12:15], v[88:91], a[60:63], v[12:15]
    ds_read_b128 v[68:71], v182 offset:35328
    v_mfma_f32_16x16x32_bf16 v[16:19], v[92:95], a[60:63], v[16:19]
    ds_read_b128 v[72:75], v184 offset:32256
    s_waitcnt vmcnt(10) lgkmcnt(3)
    v_mfma_f32_16x16x32_bf16 v[0:3], v[56:59], a[64:67], v[0:3]
    ds_read_b128 v[76:79], v182 offset:36864
    v_mfma_f32_16x16x32_bf16 v[4:7], v[60:63], a[64:67], v[4:7]
    ds_read_b128 v[80:83], v182 offset:37888
    s_add_u32 s84, s9, 77824
    buffer_load_dwordx4 a[136:139], v254, s[24:27], s84 offen
    s_waitcnt lgkmcnt(2)
    v_mfma_f32_16x16x32_bf16 v[8:11], v[64:67], a[64:67], v[8:11]
    ds_read_b128 v[84:87], v182 offset:38912
    v_mfma_f32_16x16x32_bf16 v[12:15], v[68:71], a[64:67], v[12:15]
    ds_read_b128 v[88:91], v182 offset:39936
    v_mfma_f32_16x16x32_bf16 v[16:19], v[72:75], a[64:67], v[16:19]
    ds_read_b128 v[92:95], v184 offset:36864
    s_waitcnt vmcnt(10) lgkmcnt(3)
    v_mfma_f32_16x16x32_bf16 v[0:3], v[76:79], a[68:71], v[0:3]
    v_mfma_f32_16x16x32_bf16 v[4:7], v[80:83], a[68:71], v[4:7]
    s_add_u32 s84, s9, 81920
    buffer_load_dwordx4 a[140:143], v254, s[24:27], s84 offen
    s_waitcnt lgkmcnt(0)
    v_mfma_f32_16x16x32_bf16 v[8:11], v[84:87], a[68:71], v[8:11]
    v_mfma_f32_16x16x32_bf16 v[12:15], v[88:91], a[68:71], v[12:15]
    v_mfma_f32_16x16x32_bf16 v[16:19], v[92:95], a[68:71], v[16:19]
    s_nop 0
    v_cvt_pk_bf16_f32 v200, v0, v1
    v_cvt_pk_bf16_f32 v201, v2, v3
    v_cvt_pk_bf16_f32 v202, v4, v5
    v_cvt_pk_bf16_f32 v203, v6, v7
    s_nop 0
    v_cvt_pk_bf16_f32 v204, v8, v9
    v_cvt_pk_bf16_f32 v205, v10, v11
    v_cvt_pk_bf16_f32 v206, v12, v13
    v_cvt_pk_bf16_f32 v207, v14, v15
    v_cvt_pk_bf16_f32 v208, v16, v17
    v_cvt_pk_bf16_f32 v209, v18, v19
    v_permlane16_swap_b32 v200, v202
    v_permlane16_swap_b32 v201, v203
    v_permlane16_swap_b32 v204, v206
    v_permlane16_swap_b32 v205, v207
    s_cmp_eq_u32 s41, 0
    s_cbranch_scc1 Lss_34
    buffer_store_dwordx4 v[200:203], v191, s[24:27], 0 offen
    buffer_store_dwordx4 v[204:207], v191, s[24:27], 0 offen offset:1024
    buffer_store_dwordx2 v[208:209], v192, s[24:27], 0 offen
Lsj_35:
    v_pk_add_f32 v[56:57], v[0:1], v[2:3]
    v_pk_mul_f32 v[58:59], v[0:1], v[0:1]
    v_pk_fma_f32 v[58:59], v[2:3], v[2:3], v[58:59]
    v_pk_add_f32 v[56:57], v[56:57], v[4:5]
    v_pk_fma_f32 v[58:59], v[4:5], v[4:5], v[58:59]
    v_pk_add_f32 v[56:57], v[56:57], v[6:7]
    v_pk_fma_f32 v[58:59], v[6:7], v[6:7], v[58:59]
    v_pk_add_f32 v[56:57], v[56:57], v[8:9]
    v_pk_fma_f32 v[58:59], v[8:9], v[8:9], v[58:59]
    v_pk_add_f32 v[56:57], v[56:57], v[10:11]
    v_pk_fma_f32 v[58:59], v[10:11], v[10:11], v[58:59]
    v_pk_add_f32 v[56:57], v[56:57], v[12:13]
    v_pk_fma_f32 v[58:59], v[12:13], v[12:13], v[58:59]
    v_pk_add_f32 v[56:57], v[56:57], v[14:15]
    v_pk_fma_f32 v[58:59], v[14:15], v[14:15], v[58:59]
    s_mov_b32 exec_hi, 0
    v_pk_add_f32 v[56:57], v[56:57], v[16:17]
    v_pk_fma_f32 v[58:59], v[16:17], v[16:17], v[58:59]
    v_pk_add_f32 v[56:57], v[56:57], v[18:19]
    v_pk_fma_f32 v[58:59], v[18:19], v[18:19], v[58:59]
    s_mov_b32 exec_hi, -1
    v_add_f32 v56, v56, v57
    v_add_f32 v57, v58, v59
    s_nop 1
    v_permlane16_swap_b32 v56, v57
    v_add_f32 v56, v56, v57
    v_mov_b32 v58, v56
    s_nop 1
    v_permlane32_swap_b32 v56, v58
    v_add_f32 v56, v56, v58
    s_cmp_eq_u32 s41, 0
    s_cbranch_scc1 Lss_36
    buffer_store_dword v56, v193, s[24:27], 0 offen
Lsj_37:
    s_waitcnt vmcnt(0)
    s_barrier
    s_cmp_eq_u32 s44, 0
    s_cbranch_scc0 Lw0_38
    s_lshl_b32 s58, s47, 3
    s_add_u32 s58, s58, s48
    s_add_u32 s58, s58, 2
    s_not_b32 s59, s58
    s_xor_b32 s59, s59, s42
    v_mov_b32 v172, s58
    v_mov_b32 v173, s59
    s_mov_b64 exec, 1
    s_cmp_eq_u32 s41, 0
    s_cbranch_scc1 Lss_40
    buffer_store_dwordx2 v[172:173], v255, s[24:27], s52 offen
Lsj_41:
    s_mov_b64 exec, -1
    s_lshl_b32 s58, s47, 3
    s_add_u32 s58, s58, s48
    s_add_u32 s58, s58, 2
    s_mov_b64 exec, 0xffff
    s_mov_b32 s59, 0
    buffer_load_dwordx2 v[172:173], v195, s[24:27], 0 offen sc1
    s_sleep 2
    buffer_load_dwordx2 v[170:171], v195, s[24:27], 0 offen sc1
    s_sleep 2
    buffer_load_dwordx2 v[168:169], v195, s[24:27], 0 offen sc1
Lpoll_42:
    s_waitcnt vmcnt(2)
    v_subrev_u32 v174, s58, v172
    v_xor_b32 v175, v172, v173
    v_cmp_gt_u32 vcc, 32, v174
    v_or_b32 v174, 7, v175
    v_cmp_eq_u32 s[60:61], -1, v174
    s_nop 1
    s_and_b64 vcc, vcc, s[60:61]
    s_cmp_eq_u64 vcc, exec
    s_cbranch_scc1 Lgot_43
    buffer_load_dwordx2 v[172:173], v195, s[24:27], 0 offen sc1
    s_waitcnt vmcnt(2)
    v_subrev_u32 v174, s58, v170
    v_xor_b32 v175, v170, v171
    v_cmp_gt_u32 vcc, 32, v174
    v_or_b32 v174, 7, v175
    v_cmp_eq_u32 s[60:61], -1, v174
    s_nop 1
    s_and_b64 vcc, vcc, s[60:61]
    s_cmp_eq_u64 vcc, exec
    s_cbranch_scc1 Lgot_43
    buffer_load_dwordx2 v[170:171], v195, s[24:27], 0 offen sc1
    s_waitcnt vmcnt(2)
    v_subrev_u32 v174, s58, v168
    v_xor_b32 v175, v168, v169
    v_cmp_gt_u32 vcc, 32, v174
    v_or_b32 v174, 7, v175
    v_cmp_eq_u32 s[60:61], -1, v174
    s_nop 1
    s_and_b64 vcc, vcc, s[60:61]
    s_cmp_eq_u64 vcc, exec
    s_cbranch_scc1 Lgot_43
    buffer_load_dwordx2 v[168:169], v195, s[24:27], 0 offen sc1
    s_add_u32 s59, s59, 1
    s_cmp_lt_u32 s59, 20000
    s_cbranch_scc1 Lpoll_42
    s_add_u32 s51, s51, 1
Lgot_43:
    s_mov_b64 exec, -1
    s_branch Lw0j_39
Lw0_38:
    v_add_u32 v152, s89, v254
    v_add_u32 v153, 65536, v152
    ds_write_b128 v152, a[144:147] offset:0
    ds_write_b128 v152, a[148:151] offset:4096
    ds_write_b128 v152, a[152:155] offset:8192
    ds_write_b128 v152, a[156:159] offset:12288
    ds_write_b128 v152, a[160:163] offset:16384
    ds_write_b128 v152, a[164:167] offset:20480
    ds_write_b128 v152, a[168:171] offset:24576
    ds_write_b128 v152, a[172:175] offset:28672
    ds_write_b128 v152, a[176:179] offset:32768
    ds_write_b128 v152, a[180:183] offset:36864
    ds_write_b128 v152, a[184:187] offset:40960
    ds_write_b128 v152, a[188:191] offset:45056
    ds_write_b128 v152, a[192:195] offset:49152
    ds_write_b128 v152, a[196:199] offset:53248
    ds_write_b128 v152, a[200:203] offset:57344
    ds_write_b128 v152, a[204:207] offset:61440
    ds_write_b128 v153, a[208:211] offset:0
    ds_write_b128 v153, a[212:215] offset:4096
    ds_write_b128 v153, a[132:135] offset:8192
    ds_write_b128 v153, a[136:139] offset:12288
    ds_write_b128 v153, a[140:143] offset:16384
Lw0j_39:
    s_nop 0
    s_barrier
    s_mov_b32 s96, 0
    s_mov_b32 s97, 18432
    buffer_load_dwordx4 a[0:3], v176, s[24:27], s96 offen offset:0 sc1
    buffer_load_dwordx4 a[72:75], v176, s[24:27], s97 offen offset:0 sc1
    buffer_load_dwordx4 a[4:7], v176, s[24:27], s96 offen offset:1024 sc1
    buffer_load_dwordx4 a[76:79], v176, s[24:27], s97 offen offset:1024 sc1
    buffer_load_dwordx4 a[8:11], v176, s[24:27], s96 offen offset:2048 sc1
    buffer_load_dwordx4 a[80:83], v176, s[24:27], s97 offen offset:2048 sc1
    buffer_load_dwordx4 v[132:135], v194, s[24:27], 0 offen offset:0 sc1
    buffer_load_dwordx4 v[136:139], v194, s[24:27], 0 offen offset:1024 sc1
    buffer_load_dwordx4 a[12:15], v176, s[24:27], s96 offen offset:3072 sc1
    buffer_load_dwordx4 a[84:87], v176, s[24:27], s97 offen offset:3072 sc1
    s_cmp_eq_u32 s44, 0
    s_cbranch_scc0 Lw0_44
    v_add_u32 v152, s89, v254
    v_add_u32 v153, 65536, v152
    ds_write_b128 v152, a[144:147] offset:0
    ds_write_b128 v152, a[148:151] offset:4096
    ds_write_b128 v152, a[152:155] offset:8192
    ds_write_b128 v152, a[156:159] offset:12288
    ds_write_b128 v152, a[160:163] offset:16384
    ds_write_b128 v152, a[164:167] offset:20480
    ds_write_b128 v152, a[168:171] offset:24576
    ds_write_b128 v152, a[172:175] offset:28672
    ds_write_b128 v152, a[176:179] offset:32768
    ds_write_b128 v152, a[180:183] offset:36864
    ds_write_b128 v152, a[184:187] offset:40960
    ds_write_b128 v152, a[188:191] offset:45056
    ds_write_b128 v152, a[192:195] offset:49152
    ds_write_b128 v152, a[196:199] offset:53248
    ds_write_b128 v152, a[200:203] offset:57344
    ds_write_b128 v152, a[204:207] offset:61440
    ds_write_b128 v153, a[208:211] offset:0
    ds_write_b128 v153, a[212:215] offset:4096
    ds_write_b128 v153, a[132:135] offset:8192
    ds_write_b128 v153, a[136:139] offset:12288
    ds_write_b128 v153, a[140:143] offset:16384
Lw0_44:
    s_nop 0
    s_cmp_eq_u32 s47, 1
    s_cbranch_scc1 Lnox_46
    s_waitcnt vmcnt(8)
    s_waitcnt lgkmcnt(0)
    s_barrier
    ds_read_b128 v[56:59], v177 offset:0
    ds_read_b128 v[60:63], v177 offset:1024
    ds_read_b128 v[64:67], v177 offset:2048
    ds_read_b128 v[68:71], v177 offset:3072
    ds_read_b128 v[72:75], v177 offset:4096
    ds_read_b128 v[76:79], v177 offset:5120
    ds_read_b128 v[80:83], v177 offset:6144
    ds_read_b128 v[144:147], v179 offset:0
    ds_read_b128 v[148:151], v185 offset:0
    s_waitcnt lgkmcnt(7)
    v_mfma_f32_16x16x32_bf16 v[0:3], v[56:59], a[0:3], 0
    ds_read_b128 v[84:87], v177 offset:7168
    v_mfma_f32_16x16x32_bf16 v[4:7], v[56:59], a[72:75], 0
    v_mfma_f32_16x16x32_bf16 v[8:11], v[60:63], a[0:3], 0
    ds_read_b128 v[88:91], v177 offset:8192
    v_mfma_f32_16x16x32_bf16 v[12:15], v[60:63], a[72:75], 0
    s_add_u32 s96, s96, 4096
    s_add_u32 s97, s97, 4096
    buffer_load_dwordx4 a[16:19], v176, s[24:27], s96 offen offset:0 sc1
    s_waitcnt lgkmcnt(7)
    v_mfma_f32_16x16x32_bf16 v[16:19], v[64:67], a[0:3], 0
    ds_read_b128 v[92:95], v177 offset:9216
    v_mfma_f32_16x16x32_bf16 v[20:23], v[64:67], a[72:75], 0
    v_mfma_f32_16x16x32_bf16 v[24:27], v[68:71], a[0:3], 0
    ds_read_b128 v[96:99], v177 offset:10240
    v_mfma_f32_16x16x32_bf16 v[28:31], v[68:71], a[72:75], 0
    buffer_load_dwordx4 a[88:91], v176, s[24:27], s97 offen offset:0 sc1
    s_waitcnt lgkmcnt(7)
    v_mfma_f32_16x16x32_bf16 v[32:35], v[72:75], a[0:3], 0
    ds_read_b128 v[100:103], v177 offset:11264
    v_mfma_f32_16x16x32_bf16 v[36:39], v[72:75], a[72:75], 0
    v_mfma_f32_16x16x32_bf16 v[40:43], v[76:79], a[0:3], 0
    ds_read_b128 v[104:107], v177 offset:12288
    v_mfma_f32_16x16x32_bf16 v[44:47], v[76:79], a[72:75], 0
    buffer_load_dwordx4 a[20:23], v176, s[24:27], s96 offen offset:1024 sc1
    s_waitcnt lgkmcnt(6)
    v_mfma_f32_16x16x32_bf16 v[48:51], v[80:83], a[0:3], 0
    ds_read_b128 v[108:111], v177 offset:13312
    v_mfma_f32_16x16x32_bf16 v[52:55], v[80:83], a[72:75], 0
    v_mfma_f32_16x16x32_bf16 v[112:115], v[144:147], a[232:235], 0
    v_mfma_f32_16x16x32_bf16 v[116:119], v[148:151], a[232:235], 0
    ds_read_b128 v[156:159], v179 offset:7168
    ds_read_b128 v[160:163], v185 offset:7168
    s_waitcnt vmcnt(9) lgkmcnt(7)
    v_mfma_f32_16x16x32_bf16 v[0:3], v[84:87], a[4:7], v[0:3]
    ds_read_b128 v[56:59], v177 offset:14336
    v_mfma_f32_16x16x32_bf16 v[4:7], v[84:87], a[76:79], v[4:7]
    v_mfma_f32_16x16x32_bf16 v[8:11], v[88:91], a[4:7], v[8:11]
    ds_read_b128 v[60:63], v177 offset:15360
    v_mfma_f32_16x16x32_bf16 v[12:15], v[88:91], a[76:79], v[12:15]
    buffer_load_dwordx4 a[92:95], v176, s[24:27], s97 offen offset:1024 sc1
    s_waitcnt lgkmcnt(7)
    v_mfma_f32_16x16x32_bf16 v[16:19], v[92:95], a[4:7], v[16:19]
    ds_read_b128 v[64:67], v177 offset:16384
    v_mfma_f32_16x16x32_bf16 v[20:23], v[92:95], a[76:79], v[20:23]
    v_mfma_f32_16x16x32_bf16 v[24:27], v[96:99], a[4:7], v[24:27]
    ds_read_b128 v[68:71], v177 offset:17408
    v_mfma_f32_16x16x32_bf16 v[28:31], v[96:99], a[76:79], v[28:31]
    buffer_load_dwordx4 a[24:27], v176, s[24:27], s96 offen offset:2048 sc1
    s_waitcnt lgkmcnt(7)
    v_mfma_f32_16x16x32_bf16 v[32:35], v[100:103], a[4:7], v[32:35]
    ds_read_b128 v[72:75], v177 offset:18432
    v_mfma_f32_16x16x32_bf16 v[36:39], v[100:103], a[76:79], v[36:39]
    v_mfma_f32_16x16x32_bf16 v[40:43], v[104:107], a[4:7], v[40:43]
    ds_read_b128 v[76:79], v177 offset:19456
    v_mfma_f32_16x16x32_bf16 v[44:47], v[104:107], a[76:79], v[44:47]
    buffer_load_dwordx4 a[96:99], v176, s[24:27], s97 offen offset:2048 sc1
    s_waitcnt lgkmcnt(6)
    v_mfma_f32_16x16x32_bf16 v[48:51], v[108:111], a[4:7], v[48:51]
    ds_read_b128 v[80:83], v177 offset:20480
    v_mfma_f32_16x16x32_bf16 v[52:55], v[108:111], a[76:79], v[52:55]
    v_mfma_f32_16x16x32_bf16 v[112:115], v[156:159], a[232:235], v[112:115]
    v_mfma_f32_16x16x32_bf16 v[116:119], v[160:163], a[232:235], v[116:119]
    ds_read_b128 v[144:147], v179 offset:14336
    ds_read_b128 v[148:151], v185 offset:14336
    s_waitcnt vmcnt(10) lgkmcnt(7)
    v_mfma_f32_16x16x32_bf16 v[0:3], v[56:59], a[8:11], v[0:3]
    ds_read_b128 v[84:87], v177 offset:21504
    v_mfma_f32_16x16x32_bf16 v[4:7], v[56:59], a[80:83], v[4:7]
    v_mfma_f32_16x16x32_bf16 v[8:11], v[60:63], a[8:11], v[8:11]
    ds_read_b128 v[88:91], v177 offset:22528
    v_mfma_f32_16x16x32_bf16 v[12:15], v[60:63], a[80:83], v[12:15]
    buffer_load_dwordx4 a[28:31], v176, s[24:27], s96 offen offset:3072 sc1
    s_waitcnt lgkmcnt(7)
    v_mfma_f32_16x16x32_bf16 v[16:19], v[64:67], a[8:11], v[16:19]
    ds_read_b128 v[92:95], v177 offset:23552
    v_mfma_f32_16x16x32_bf16 v[20:23], v[64:67], a[80:83], v[20:23]
    v_mfma_f32_16x16x32_bf16 v[24:27], v[68:71], a[8:11], v[24:27]
    ds_read_b128 v[96:99], v177 offset:24576
    v_mfma_f32_16x16x32_bf16 v[28:31], v[68:71], a[80:83], v[28:31]
    buffer_load_dwordx4 a[100:103], v176, s[24:27], s97 offen offset:3072 sc1
    s_waitcnt lgkmcnt(7)
    v_mfma_f32_16x16x32_bf16 v[32:35], v[72:75], a[8:11], v[32:35]
    ds_read_b128 v[100:103], v177 offset:25600
    v_mfma_f32_16x16x32_bf16 v[36:39], v[72:75], a[80:83], v[36:39]
    v_mfma_f32_16x16x32_bf16 v[40:43], v[76:79], a[8:11], v[40:43]
    ds_read_b128 v[104:107], v177 offset:26624
    v_mfma_f32_16x16x32_bf16 v[44:47], v[76:79], a[80:83], v[44:47]
    s_add_u32 s96, s96, 4096
    s_add_u32 s97, s97, 4096
    buffer_load_dwordx4 a[32:35], v176, s[24:27], s96 offen offset:0 sc1
    s_waitcnt lgkmcnt(6)
    v_mfma_f32_16x16x32_bf16 v[48:51], v[80:83], a[8:11], v[48:51]
    ds_read_b128 v[108:111], v177 offset:27648
    v_mfma_f32_16x16x32_bf16 v[52:55], v[80:83], a[80:83], v[52:55]
    v_mfma_f32_16x16x32_bf16 v[112:115], v[144:147], a[232:235], v[112:115]
    v_mfma_f32_16x16x32_bf16 v[116:119], v[148:151], a[232:235], v[116:119]
    ds_read_b128 v[156:159], v179 offset:21504
    ds_read_b128 v[160:163], v185 offset:21504
    s_waitcnt vmcnt(9) lgkmcnt(7)
    v_mfma_f32_16x16x32_bf16 v[0:3], v[84:87], a[12:15], v[0:3]
    ds_read_b128 v[56:59], v177 offset:28672
    v_mfma_f32_16x16x32_bf16 v[4:7], v[84:87], a[84:87], v[4:7]
    v_mfma_f32_16x16x32_bf16 v[8:11], v[88:91], a[12:15], v[8:11]
    ds_read_b128 v[60:63], v177 offset:29696
    v_mfma_f32_16x16x32_bf16 v[12:15], v[88:91], a[84:87], v[12:15]
    buffer_load_dwordx4 a[104:107], v176, s[24:27], s97 offen offset:0 sc1
    s_waitcnt lgkmcnt(7)
    v_mfma_f32_16x16x32_bf16 v[16:19], v[92:95], a[12:15], v[16:19]
    ds_read_b128 v[64:67], v177 offset:30720
    v_mfma_f32_16x16x32_bf16 v[20:23], v[92:95], a[84:87], v[20:23]
    v_mfma_f32_16x16x32_bf16 v[24:27], v[96:99], a[12:15], v[24:27]
    ds_read_b128 v[68:71], v177 offset:31744
    v_mfma_f32_16x16x32_bf16 v[28:31], v[96:99], a[84:87], v[28:31]
    buffer_load_dwordx4 a[36:39], v176, s[24:27], s96 offen offset:1024 sc1
    s_waitcnt lgkmcnt(7)
    v_mfma_f32_16x16x32_bf16 v[32:35], v[100:103], a[12:15], v[32:35]
    ds_read_b128 v[72:75], v177 offset:32768
    v_mfma_f32_16x16x32_bf16 v[36:39], v[100:103], a[84:87], v[36:39]
    v_mfma_f32_16x16x32_bf16 v[40:43], v[104:107], a[12:15], v[40:43]
    ds_read_b128 v[76:79], v177 offset:33792
    v_mfma_f32_16x16x32_bf16 v[44:47], v[104:107], a[84:87], v[44:47]
    buffer_load_dwordx4 a[108:111], v176, s[24:27], s97 offen offset:1024 sc1
    s_waitcnt lgkmcnt(6)
    v_mfma_f32_16x16x32_bf16 v[48:51], v[108:111], a[12:15], v[48:51]
    ds_read_b128 v[80:83], v177 offset:34816
    v_mfma_f32_16x16x32_bf16 v[52:55], v[108:111], a[84:87], v[52:55]
    v_mfma_f32_16x16x32_bf16 v[112:115], v[156:159], a[232:235], v[112:115]
    v_mfma_f32_16x16x32_bf16 v[116:119], v[160:163], a[232:235], v[116:119]
    ds_read_b128 v[144:147], v179 offset:28672
    ds_read_b128 v[148:151], v185 offset:28672
    s_waitcnt vmcnt(10) lgkmcnt(7)
    v_mfma_f32_16x16x32_bf16 v[0:3], v[56:59], a[16:19], v[0:3]
    ds_read_b128 v[84:87], v177 offset:35840
    v_mfma_f32_16x16x32_bf16 v[4:7], v[56:59], a[88:91], v[4:7]
    v_mfma_f32_16x16x32_bf16 v[8:11], v[60:63], a[16:19], v[8:11]
    ds_read_b128 v[88:91], v177 offset:36864
    v_mfma_f32_16x16x32_bf16 v[12:15], v[60:63], a[88:91], v[12:15]
    buffer_load_dwordx4 a[40:43], v176, s[24:27], s96 offen offset:2048 sc1
    s_waitcnt lgkmcnt(7)
    v_mfma_f32_16x16x32_bf16 v[16:19], v[64:67], a[16:19], v[16:19]
    ds_read_b128 v[92:95], v177 offset:37888
    v_mfma_f32_16x16x32_bf16 v[20:23], v[64:67], a[88:91], v[20:23]
    v_mfma_f32_16x16x32_bf16 v[24:27], v[68:71], a[16:19], v[24:27]
    ds_read_b128 v[96:99], v177 offset:38912
    v_mfma_f32_16x16x32_bf16 v[28:31], v[68:71], a[88:91], v[28:31]
    buffer_load_dwordx4 a[112:115], v176, s[24:27], s97 offen offset:2048 sc1
    s_waitcnt lgkmcnt(7)
    v_mfma_f32_16x16x32_bf16 v[32:35], v[72:75], a[16:19], v[32:35]
    ds_read_b128 v[100:103], v177 offset:39936
    v_mfma_f32_16x16x32_bf16 v[36:39], v[72:75], a[88:91], v[36:39]
    v_mfma_f32_16x16x32_bf16 v[40:43], v[76:79], a[16:19], v[40:43]
    ds_read_b128 v[104:107], v177 offset:40960
    v_mfma_f32_16x16x32_bf16 v[44:47], v[76:79], a[88:91], v[44:47]
    buffer_load_dwordx4 a[44:47], v176, s[24:27], s96 offen offset:3072 sc1
    s_waitcnt lgkmcnt(6)
    v_mfma_f32_16x16x32_bf16 v[48:51], v[80:83], a[16:19], v[48:51]
    ds_read_b128 v[108:111], v177 offset:41984
    v_mfma_f32_16x16x32_bf16 v[52:55], v[80:83], a[88:91], v[52:55]
    v_mfma_f32_16x16x32_bf16 v[112:115], v[144:147], a[232:235], v[112:115]
    v_mfma_f32_16x16x32_bf16 v[116:119], v[148:151], a[232:235], v[116:119]
    ds_read_b128 v[156:159], v179 offset:35840
    ds_read_b128 v[160:163], v185 offset:35840
    s_waitcnt vmcnt(11) lgkmcnt(7)
    v_mfma_f32_16x16x32_bf16 v[0:3], v[84:87], a[20:23], v[0:3]
    ds_read_b128 v[56:59], v177 offset:43008
    v_mfma_f32_16x16x32_bf16 v[4:7], v[84:87], a[92:95], v[4:7]
    v_add_f32 v132, v132, v134
    v_mfma_f32_16x16x32_bf16 v[8:11], v[88:91], a[20:23], v[8:11]
    ds_read_b128 v[60:63], v177 offset:44032
    v_mfma_f32_16x16x32_bf16 v[12:15], v[88:91], a[92:95], v[12:15]
    buffer_load_dwordx4 a[116:119], v176, s[24:27], s97 offen offset:3072 sc1
    s_waitcnt lgkmcnt(7)
    v_mfma_f32_16x16x32_bf16 v[16:19], v[92:95], a[20:23], v[16:19]
    ds_read_b128 v[64:67], v177 offset:45056
    v_mfma_f32_16x16x32_bf16 v[20:23], v[92:95], a[92:95], v[20:23]
    v_add_f32 v133, v133, v135
    v_mfma_f32_16x16x32_bf16 v[24:27], v[96:99], a[20:23], v[24:27]
    ds_read_b128 v[68:71], v177 offset:46080
    v_mfma_f32_16x16x32_bf16 v[28:31], v[96:99], a[92:95], v[28:31]
    s_add_u32 s96, s96, 4096
    s_add_u32 s97, s97, 4096
    buffer_load_dwordx4 a[48:51], v176, s[24:27], s96 offen offset:0 sc1
    s_waitcnt lgkmcnt(7)
    v_mfma_f32_16x16x32_bf16 v[32:35], v[100:103], a[20:23], v[32:35]
    ds_read_b128 v[72:75], v177 offset:47104
    v_mfma_f32_16x16x32_bf16 v[36:39], v[100:103], a[92:95], v[36:39]
    v_permlane16_swap_b32 v132, v133
    v_mfma_f32_16x16x32_bf16 v[40:43], v[104:107], a[20:23], v[40:43]
    ds_read_b128 v[76:79], v177 offset:48128
    v_mfma_f32_16x16x32_bf16 v[44:47], v[104:107], a[92:95], v[44:47]
    buffer_load_dwordx4 a[120:123], v176, s[24:27], s97 offen offset:0 sc1
    s_waitcnt lgkmcnt(6)
    v_mfma_f32_16x16x32_bf16 v[48:51], v[108:111], a[20:23], v[48:51]
    ds_read_b128 v[80:83], v177 offset:49152
    v_mfma_f32_16x16x32_bf16 v[52:55], v[108:111], a[92:95], v[52:55]
    v_add_f32 v132, v132, v133
    v_mfma_f32_16x16x32_bf16 v[112:115], v[156:159], a[232:235], v[112:115]
    v_mfma_f32_16x16x32_bf16 v[116:119], v[160:163], a[232:235], v[116:119]
    ds_read_b128 v[144:147], v179 offset:43008
    ds_read_b128 v[148:151], v185 offset:43008
    s_waitcnt vmcnt(12) lgkmcnt(7)
    v_mfma_f32_16x16x32_bf16 v[0:3], v[56:59], a[24:27], v[0:3]
    ds_read_b128 v[84:87], v177 offset:50176
    v_mfma_f32_16x16x32_bf16 v[4:7], v[56:59], a[96:99], v[4:7]
    v_mov_b32 v134, v132
    v_mfma_f32_16x16x32_bf16 v[8:11], v[60:63], a[24:27], v[8:11]
    ds_read_b128 v[88:91], v177 offset:51200
    v_mfma_f32_16x16x32_bf16 v[12:15], v[60:63], a[96:99], v[12:15]
    buffer_load_dwordx4 a[52:55], v176, s[24:27], s96 offen offset:1024 sc1
    s_waitcnt lgkmcnt(7)
    v_mfma_f32_16x16x32_bf16 v[16:19], v[64:67], a[24:27], v[16:19]
    ds_read_b128 v[92:95], v177 offset:52224
    v_mfma_f32_16x16x32_bf16 v[20:23], v[64:67], a[96:99], v[20:23]
    v_permlane32_swap_b32 v132, v134
    v_mfma_f32_16x16x32_bf16 v[24:27], v[68:71], a[24:27], v[24:27]
    ds_read_b128 v[96:99], v177 offset:53248
    v_mfma_f32_16x16x32_bf16 v[28:31], v[68:71], a[96:99], v[28:31]
    buffer_load_dwordx4 a[124:127], v176, s[24:27], s97 offen offset:1024 sc1
    s_waitcnt lgkmcnt(7)
    v_mfma_f32_16x16x32_bf16 v[32:35], v[72:75], a[24:27], v[32:35]
    ds_read_b128 v[100:103], v177 offset:54272
    v_mfma_f32_16x16x32_bf16 v[36:39], v[72:75], a[96:99], v[36:39]
    v_add_f32 v132, v132, v134
    v_mfma_f32_16x16x32_bf16 v[40:43], v[76:79], a[24:27], v[40:43]
    ds_read_b128 v[104:107], v177 offset:55296
    v_mfma_f32_16x16x32_bf16 v[44:47], v[76:79], a[96:99], v[44:47]
    buffer_load_dwordx4 a[56:59], v176, s[24:27], s96 offen offset:2048 sc1
    s_waitcnt lgkmcnt(6)
    v_mfma_f32_16x16x32_bf16 v[48:51], v[80:83], a[24:27], v[48:51]
    ds_read_b128 v[108:111], v177 offset:56320
    v_mfma_f32_16x16x32_bf16 v[52:55], v[80:83], a[96:99], v[52:55]
    v_mov_b32 v133, v132
    v_mfma_f32_16x16x32_bf16 v[112:115], v[144:147], a[232:235], v[112:115]
    v_mfma_f32_16x16x32_bf16 v[116:119], v[148:151], a[232:235], v[116:119]
    ds_read_b128 v[156:159], v179 offset:50176
    ds_read_b128 v[160:163], v185 offset:50176
    s_waitcnt vmcnt(13) lgkmcnt(7)
    v_mfma_f32_16x16x32_bf16 v[0:3], v[84:87], a[28:31], v[0:3]
    ds_read_b128 v[56:59], v177 offset:57344
    v_mfma_f32_16x16x32_bf16 v[4:7], v[84:87], a[100:103], v[4:7]
    v_permlane16_swap_b32 v132, v133
    v_mfma_f32_16x16x32_bf16 v[8:11], v[88:91], a[28:31], v[8:11]
    ds_read_b128 v[60:63], v177 offset:58368
    v_mfma_f32_16x16x32_bf16 v[12:15], v[88:91], a[100:103], v[12:15]
    buffer_load_dwordx4 a[128:131], v176, s[24:27], s97 offen offset:2048 sc1
    s_waitcnt lgkmcnt(7)
    v_mfma_f32_16x16x32_bf16 v[16:19], v[92:95], a[28:31], v[16:19]
    ds_read_b128 v[64:67], v177 offset:59392
    v_mfma_f32_16x16x32_bf16 v[20:23], v[92:95], a[100:103], v[20:23]
    v_mul_f32 v120, 0xbae38e39, v132
    v_mfma_f32_16x16x32_bf16 v[24:27], v[96:99], a[28:31], v[24:27]
    ds_read_b128 v[68:71], v177 offset:60416
    v_mfma_f32_16x16x32_bf16 v[28:31], v[96:99], a[100:103], v[28:31]
    buffer_load_dwordx4 a[60:63], v176, s[24:27], s96 offen offset:3072 sc1
    s_waitcnt lgkmcnt(7)
    v_mfma_f32_16x16x32_bf16 v[32:35], v[100:103], a[28:31], v[32:35]
    ds_read_b128 v[72:75], v177 offset:61440
    v_mfma_f32_16x16x32_bf16 v[36:39], v[100:103], a[100:103], v[36:39]
    v_mul_f32 v133, 0x3ae38e39, v133
    v_mfma_f32_16x16x32_bf16 v[40:43], v[104:107], a[28:31], v[40:43]
    ds_read_b128 v[76:79], v177 offset:62464
    v_mfma_f32_16x16x32_bf16 v[44:47], v[104:107], a[100:103], v[44:47]
    buffer_load_dwordx4 a[132:135], v176, s[24:27], s97 offen offset:3072 sc1
    s_waitcnt lgkmcnt(6)
    v_mfma_f32_16x16x32_bf16 v[48:51], v[108:111], a[28:31], v[48:51]
    ds_read_b128 v[80:83], v177 offset:63488
    v_mfma_f32_16x16x32_bf16 v[52:55], v[108:111], a[100:103], v[52:55]
    v_fma_f32 v133, -v120, v120, v133
    v_mfma_f32_16x16x32_bf16 v[112:115], v[156:159], a[232:235], v[112:115]
    v_mfma_f32_16x16x32_bf16 v[116:119], v[160:163], a[232:235], v[116:119]
    ds_read_b128 v[144:147], v179 offset:57344
    ds_read_b128 v[148:151], v185 offset:57344
    s_waitcnt vmcnt(14) lgkmcnt(7)
    v_mfma_f32_16x16x32_bf16 v[0:3], v[56:59], a[32:35], v[0:3]
    ds_read_b128 v[84:87], v178 offset:0
    v_mfma_f32_16x16x32_bf16 v[4:7], v[56:59], a[104:107], v[4:7]
    v_max_f32 v133, 0, v133
    v_mfma_f32_16x16x32_bf16 v[8:11], v[60:63], a[32:35], v[8:11]
    ds_read_b128 v[88:91], v178 offset:1024
    v_mfma_f32_16x16x32_bf16 v[12:15], v[60:63], a[104:107], v[12:15]
    s_add_u32 s96, s96, 4096
    s_add_u32 s97, s97, 4096
    buffer_load_dwordx4 a[64:67], v176, s[24:27], s96 offen offset:0 sc1
    s_waitcnt lgkmcnt(7)
    v_mfma_f32_16x16x32_bf16 v[16:19], v[64:67], a[32:35], v[16:19]
    ds_read_b128 v[92:95], v178 offset:2048
    v_mfma_f32_16x16x32_bf16 v[20:23], v[64:67], a[104:107], v[20:23]
    v_add_f32 v133, 0x3727c5ac, v133
    v_mfma_f32_16x16x32_bf16 v[24:27], v[68:71], a[32:35], v[24:27]
    ds_read_b128 v[96:99], v178 offset:3072
    v_mfma_f32_16x16x32_bf16 v[28:31], v[68:71], a[104:107], v[28:31]
    buffer_load_dwordx4 a[136:139], v176, s[24:27], s97 offen offset:0 sc1
    s_waitcnt lgkmcnt(7)
    v_mfma_f32_16x16x32_bf16 v[32:35], v[72:75], a[32:35], v[32:35]
    ds_read_b128 v[100:103], v178 offset:4096
    v_mfma_f32_16x16x32_bf16 v[36:39], v[72:75], a[104:107], v[36:39]
    v_rsq_f32 v126, v133
    v_mfma_f32_16x16x32_bf16 v[40:43], v[76:79], a[32:35], v[40:43]
    ds_read_b128 v[104:107], v178 offset:5120
    v_mfma_f32_16x16x32_bf16 v[44:47], v[76:79], a[104:107], v[44:47]
    buffer_load_dwordx4 a[68:71], v176, s[24:27], s96 offen offset:1024 sc1
    s_waitcnt lgkmcnt(6)
    v_mfma_f32_16x16x32_bf16 v[48:51], v[80:83], a[32:35], v[48:51]
    ds_read_b128 v[108:111], v178 offset:6144
    v_mfma_f32_16x16x32_bf16 v[52:55], v[80:83], a[104:107], v[52:55]
    v_add_f32 v136, v136, v138
    v_mfma_f32_16x16x32_bf16 v[112:115], v[144:147], a[232:235], v[112:115]
    v_mfma_f32_16x16x32_bf16 v[116:119], v[148:151], a[232:235], v[116:119]
    ds_read_b128 v[156:159], v180 offset:0
    ds_read_b128 v[160:163], v186 offset:0
    s_waitcnt vmcnt(15) lgkmcnt(7)
    v_mfma_f32_16x16x32_bf16 v[0:3], v[84:87], a[36:39], v[0:3]
    ds_read_b128 v[56:59], v178 offset:7168
    v_mfma_f32_16x16x32_bf16 v[4:7], v[84:87], a[108:111], v[4:7]
    v_add_f32 v137, v137, v139
    v_mfma_f32_16x16x32_bf16 v[8:11], v[88:91], a[36:39], v[8:11]
    ds_read_b128 v[60:63], v178 offset:8192
    v_mfma_f32_16x16x32_bf16 v[12:15], v[88:91], a[108:111], v[12:15]
    buffer_load_dwordx4 a[140:143], v176, s[24:27], s97 offen offset:1024 sc1
    s_waitcnt lgkmcnt(7)
    v_mfma_f32_16x16x32_bf16 v[16:19], v[92:95], a[36:39], v[16:19]
    ds_read_b128 v[64:67], v178 offset:9216
    v_mfma_f32_16x16x32_bf16 v[20:23], v[92:95], a[108:111], v[20:23]
    v_permlane16_swap_b32 v136, v137
    v_mfma_f32_16x16x32_bf16 v[24:27], v[96:99], a[36:39], v[24:27]
    ds_read_b128 v[68:71], v178 offset:10240
    v_mfma_f32_16x16x32_bf16 v[28:31], v[96:99], a[108:111], v[28:31]
    s_add_u32 s84, s8, 0
    buffer_load_dwordx4 a[144:147], v254, s[4:7], s84 offen
    s_waitcnt lgkmcnt(7)
    v_mfma_f32_16x16x32_bf16 v[32:35], v[100:103], a[36:39], v[32:35]
    ds_read_b128 v[72:75], v178 offset:11264
    v_mfma_f32_16x16x32_bf16 v[36:39], v[100:103], a[108:111], v[36:39]
    v_add_f32 v136, v136, v137
    v_mfma_f32_16x16x32_bf16 v[40:43], v[104:107], a[36:39], v[40:43]
    ds_read_b128 v[76:79], v178 offset:12288
    v_mfma_f32_16x16x32_bf16 v[44:47], v[104:107], a[108:111], v[44:47]
    s_add_u32 s84, s8, 4096
    buffer_load_dwordx4 a[148:151], v254, s[4:7], s84 offen
    s_waitcnt lgkmcnt(6)
    v_mfma_f32_16x16x32_bf16 v[48:51], v[108:111], a[36:39], v[48:51]
    ds_read_b128 v[80:83], v178 offset:13312
    v_mfma_f32_16x16x32_bf16 v[52:55], v[108:111], a[108:111], v[52:55]
    v_mov_b32 v138, v136
    v_mfma_f32_16x16x32_bf16 v[112:115], v[156:159], a[232:235], v[112:115]
    v_mfma_f32_16x16x32_bf16 v[116:119], v[160:163], a[232:235], v[116:119]
    ds_read_b128 v[144:147], v180 offset:7168
    ds_read_b128 v[148:151], v186 offset:7168
    s_waitcnt vmcnt(16) lgkmcnt(7)
    v_mfma_f32_16x16x32_bf16 v[0:3], v[56:59], a[40:43], v[0:3]
    ds_read_b128 v[84:87], v178 offset:14336
    v_mfma_f32_16x16x32_bf16 v[4:7], v[56:59], a[112:115], v[4:7]
    v_permlane32_swap_b32 v136, v138
    v_mfma_f32_16x16x32_bf16 v[8:11], v[60:63], a[40:43], v[8:11]
    ds_read_b128 v[88:91], v178 offset:15360
    v_mfma_f32_16x16x32_bf16 v[12:15], v[60:63], a[112:115], v[12:15]
    s_add_u32 s84, s8, 8192
    buffer_load_dwordx4 a[152:155], v254, s[4:7], s84 offen
    s_waitcnt lgkmcnt(7)
    v_mfma_f32_16x16x32_bf16 v[16:19], v[64:67], a[40:43], v[16:19]
    ds_read_b128 v[92:95], v178 offset:16384
    v_mfma_f32_16x16x32_bf16 v[20:23], v[64:67], a[112:115], v[20:23]
    v_add_f32 v136, v136, v138
    v_mfma_f32_16x16x32_bf16 v[24:27], v[68:71], a[40:43], v[24:27]
    ds_read_b128 v[96:99], v178 offset:17408
    v_mfma_f32_16x16x32_bf16 v[28:31], v[68:71], a[112:115], v[28:31]
    s_add_u32 s84, s8, 12288
    buffer_load_dwordx4 a[156:159], v254, s[4:7], s84 offen
    s_waitcnt lgkmcnt(7)
    v_mfma_f32_16x16x32_bf16 v[32:35], v[72:75], a[40:43], v[32:35]
    ds_read_b128 v[100:103], v178 offset:18432
    v_mfma_f32_16x16x32_bf16 v[36:39], v[72:75], a[112:115], v[36:39]
    v_mov_b32 v137, v136
    v_mfma_f32_16x16x32_bf16 v[40:43], v[76:79], a[40:43], v[40:43]
    ds_read_b128 v[104:107], v178 offset:19456
    v_mfma_f32_16x16x32_bf16 v[44:47], v[76:79], a[112:115], v[44:47]
    s_add_u32 s84, s8, 16384
    buffer_load_dwordx4 a[160:163], v254, s[4:7], s84 offen
    s_waitcnt lgkmcnt(6)
    v_mfma_f32_16x16x32_bf16 v[48:51], v[80:83], a[40:43], v[48:51]
    ds_read_b128 v[108:111], v178 offset:20480
    v_mfma_f32_16x16x32_bf16 v[52:55], v[80:83], a[112:115], v[52:55]
    v_permlane16_swap_b32 v136, v137
    v_mfma_f32_16x16x32_bf16 v[112:115], v[144:147], a[232:235], v[112:115]
    v_mfma_f32_16x16x32_bf16 v[116:119], v[148:151], a[232:235], v[116:119]
    ds_read_b128 v[156:159], v180 offset:14336
    ds_read_b128 v[160:163], v186 offset:14336
    s_waitcnt vmcnt(17) lgkmcnt(7)
    v_mfma_f32_16x16x32_bf16 v[0:3], v[84:87], a[44:47], v[0:3]
    ds_read_b128 v[56:59], v178 offset:21504
    v_mfma_f32_16x16x32_bf16 v[4:7], v[84:87], a[116:119], v[4:7]
    v_mul_f32 v122, 0xbae38e39, v136
    v_mfma_f32_16x16x32_bf16 v[8:11], v[88:91], a[44:47], v[8:11]
    ds_read_b128 v[60:63], v178 offset:22528
    v_mfma_f32_16x16x32_bf16 v[12:15], v[88:91], a[116:119], v[12:15]
    s_waitcnt lgkmcnt(7)
    v_mfma_f32_16x16x32_bf16 v[16:19], v[92:95], a[44:47], v[16:19]
    ds_read_b128 v[64:67], v178 offset:23552
    v_mfma_f32_16x16x32_bf16 v[20:23], v[92:95], a[116:119], v[20:23]
    v_mul_f32 v137, 0x3ae38e39, v137
    v_mfma_f32_16x16x32_bf16 v[24:27], v[96:99], a[44:47], v[24:27]
    ds_read_b128 v[68:71], v178 offset:24576
    v_mfma_f32_16x16x32_bf16 v[28:31], v[96:99], a[116:119], v[28:31]
    s_waitcnt lgkmcnt(7)
    v_mfma_f32_16x16x32_bf16 v[32:35], v[100:103], a[44:47], v[32:35]
    ds_read_b128 v[72:75], v178 offset:25600
    v_mfma_f32_16x16x32_bf16 v[36:39], v[100:103], a[116:119], v[36:39]
    v_fma_f32 v137, -v122, v122, v137
    v_mfma_f32_16x16x32_bf16 v[40:43], v[104:107], a[44:47], v[40:43]
    ds_read_b128 v[76:79], v178 offset:26624
    v_mfma_f32_16x16x32_bf16 v[44:47], v[104:107], a[116:119], v[44:47]
    s_waitcnt lgkmcnt(6)
    v_mfma_f32_16x16x32_bf16 v[48:51], v[108:111], a[44:47], v[48:51]
    ds_read_b128 v[80:83], v178 offset:27648
    v_mfma_f32_16x16x32_bf16 v[52:55], v[108:111], a[116:119], v[52:55]
    v_max_f32 v137, 0, v137
    v_mfma_f32_16x16x32_bf16 v[112:115], v[156:159], a[232:235], v[112:115]
    v_mfma_f32_16x16x32_bf16 v[116:119], v[160:163], a[232:235], v[116:119]
    ds_read_b128 v[144:147], v180 offset:21504
    ds_read_b128 v[148:151], v186 offset:21504
    s_barrier
    s_waitcnt vmcnt(15) lgkmcnt(7)
    v_mfma_f32_16x16x32_bf16 v[0:3], v[56:59], a[48:51], v[0:3]
    ds_read_b128 v[84:87], v178 offset:28672
    v_mfma_f32_16x16x32_bf16 v[4:7], v[56:59], a[120:123], v[4:7]
    v_add_f32 v137, 0x3727c5ac, v137
    v_mfma_f32_16x16x32_bf16 v[8:11], v[60:63], a[48:51], v[8:11]
    ds_read_b128 v[88:91], v178 offset:29696
    v_mfma_f32_16x16x32_bf16 v[12:15], v[60:63], a[120:123], v[12:15]
    s_add_u32 m0, s89, 0
    s_add_u32 s98, s11, 0
    buffer_load_dwordx4 v254, s[24:27], s98 offen lds
    s_waitcnt lgkmcnt(7)
    v_mfma_f32_16x16x32_bf16 v[16:19], v[64:67], a[48:51], v[16:19]
    ds_read_b128 v[92:95], v178 offset:30720
    v_mfma_f32_16x16x32_bf16 v[20:23], v[64:67], a[120:123], v[20:23]
    v_rsq_f32 v128, v137
    v_mfma_f32_16x16x32_bf16 v[24:27], v[68:71], a[48:51], v[24:27]
    ds_read_b128 v[96:99], v178 offset:31744
    v_mfma_f32_16x16x32_bf16 v[28:31], v[68:71], a[120:123], v[28:31]
    s_add_u32 m0, s89, 4096
    s_add_u32 s98, s11, 4096
    buffer_load_dwordx4 v254, s[24:27], s98 offen lds
    s_waitcnt lgkmcnt(7)
    v_mfma_f32_16x16x32_bf16 v[32:35], v[72:75], a[48:51], v[32:35]
    ds_read_b128 v[100:103], v178 offset:32768
    v_mfma_f32_16x16x32_bf16 v[36:39], v[72:75], a[120:123], v[36:39]
    v_mfma_f32_16x16x32_bf16 v[40:43], v[76:79], a[48:51], v[40:43]
    ds_read_b128 v[104:107], v178 offset:33792
    v_mfma_f32_16x16x32_bf16 v[44:47], v[76:79], a[120:123], v[44:47]
    s_add_u32 m0, s89, 8192
    s_add_u32 s98, s11, 8192
    buffer_load_dwordx4 v254, s[24:27], s98 offen lds
    s_waitcnt lgkmcnt(6)
    v_mfma_f32_16x16x32_bf16 v[48:51], v[80:83], a[48:51], v[48:51]
    ds_read_b128 v[108:111], v178 offset:34816
    v_mfma_f32_16x16x32_bf16 v[52:55], v[80:83], a[120:123], v[52:55]
    v_mfma_f32_16x16x32_bf16 v[112:115], v[144:147], a[232:235], v[112:115]
    v_mfma_f32_16x16x32_bf16 v[116:119], v[148:151], a[232:235], v[116:119]
    ds_read_b128 v[156:159], v180 offset:28672
    ds_read_b128 v[160:163], v186 offset:28672
    s_waitcnt vmcnt(16) lgkmcnt(7)
    v_mfma_f32_16x16x32_bf16 v[0:3], v[84:87], a[52:55], v[0:3]
    ds_read_b128 v[56:59], v178 offset:35840
    v_mfma_f32_16x16x32_bf16 v[4:7], v[84:87], a[124:127], v[4:7]
    v_mfma_f32_16x16x32_bf16 v[8:11], v[88:91], a[52:55], v[8:11]
    ds_read_b128 v[60:63], v178 offset:36864
    v_mfma_f32_16x16x32_bf16 v[12:15], v[88:91], a[124:127], v[12:15]
    s_add_u32 m0, s89, 12288
    s_add_u32 s98, s11, 12288
    buffer_load_dwordx4 v254, s[24:27], s98 offen lds
    s_waitcnt lgkmcnt(7)
    v_mfma_f32_16x16x32_bf16 v[16:19], v[92:95], a[52:55], v[16:19]
    ds_read_b128 v[64:67], v178 offset:37888
    v_mfma_f32_16x16x32_bf16 v[20:23], v[92:95], a[124:127], v[20:23]
    v_mfma_f32_16x16x32_bf16 v[24:27], v[96:99], a[52:55], v[24:27]
    ds_read_b128 v[68:71], v178 offset:38912
    v_mfma_f32_16x16x32_bf16 v[28:31], v[96:99], a[124:127], v[28:31]
    s_add_u32 m0, s89, 16384
    s_add_u32 s98, s11, 16384
    buffer_load_dwordx4 v254, s[24:27], s98 offen lds
    s_waitcnt lgkmcnt(7)
    v_mfma_f32_16x16x32_bf16 v[32:35], v[100:103], a[52:55], v[32:35]
    ds_read_b128 v[72:75], v178 offset:39936
    v_mfma_f32_16x16x32_bf16 v[36:39], v[100:103], a[124:127], v[36:39]
    v_mfma_f32_16x16x32_bf16 v[40:43], v[104:107], a[52:55], v[40:43]
    ds_read_b128 v[76:79], v178 offset:40960
    v_mfma_f32_16x16x32_bf16 v[44:47], v[104:107], a[124:127], v[44:47]
    s_add_u32 m0, s89, 20480
    s_add_u32 s98, s11, 20480
    buffer_load_dwordx4 v254, s[24:27], s98 offen lds
    s_waitcnt lgkmcnt(6)
    v_mfma_f32_16x16x32_bf16 v[48:51], v[108:111], a[52:55], v[48:51]
    ds_read_b128 v[80:83], v178 offset:41984
    v_mfma_f32_16x16x32_bf16 v[52:55], v[108:111], a[124:127], v[52:55]
    v_mfma_f32_16x16x32_bf16 v[112:115], v[156:159], a[232:235], v[112:115]
    v_mfma_f32_16x16x32_bf16 v[116:119], v[160:163], a[232:235], v[116:119]
    ds_read_b128 v[144:147], v180 offset:35840
    ds_read_b128 v[148:151], v186 offset:35840
    s_waitcnt vmcnt(17) lgkmcnt(7)
    v_mfma_f32_16x16x32_bf16 v[0:3], v[56:59], a[56:59], v[0:3]
    ds_read_b128 v[84:87], v178 offset:43008
    v_mfma_f32_16x16x32_bf16 v[4:7], v[56:59], a[128:131], v[4:7]
    v_mfma_f32_16x16x32_bf16 v[8:11], v[60:63], a[56:59], v[8:11]
    ds_read_b128 v[88:91], v178 offset:44032
    v_mfma_f32_16x16x32_bf16 v[12:15], v[60:63], a[128:131], v[12:15]
    s_add_u32 m0, s89, 24576
    s_add_u32 s98, s11, 24576
    buffer_load_dwordx4 v254, s[24:27], s98 offen lds
    s_waitcnt lgkmcnt(7)
    v_mfma_f32_16x16x32_bf16 v[16:19], v[64:67], a[56:59], v[16:19]
    ds_read_b128 v[92:95], v178 offset:45056
    v_mfma_f32_16x16x32_bf16 v[20:23], v[64:67], a[128:131], v[20:23]
    v_mfma_f32_16x16x32_bf16 v[24:27], v[68:71], a[56:59], v[24:27]
    ds_read_b128 v[96:99], v178 offset:46080
    v_mfma_f32_16x16x32_bf16 v[28:31], v[68:71], a[128:131], v[28:31]
    s_add_u32 m0, s89, 28672
    s_add_u32 s98, s11, 28672
    buffer_load_dwordx4 v254, s[24:27], s98 offen lds
    s_waitcnt lgkmcnt(7)
    v_mfma_f32_16x16x32_bf16 v[32:35], v[72:75], a[56:59], v[32:35]
    ds_read_b128 v[100:103], v178 offset:47104
    v_mfma_f32_16x16x32_bf16 v[36:39], v[72:75], a[128:131], v[36:39]
    v_mfma_f32_16x16x32_bf16 v[40:43], v[76:79], a[56:59], v[40:43]
    ds_read_b128 v[104:107], v178 offset:48128
    v_mfma_f32_16x16x32_bf16 v[44:47], v[76:79], a[128:131], v[44:47]
    s_add_u32 m0, s89, 32768
    s_add_u32 s98, s11, 32768
    buffer_load_dwordx4 v254, s[24:27], s98 offen lds
    s_waitcnt lgkmcnt(6)
    v_mfma_f32_16x16x32_bf16 v[48:51], v[80:83], a[56:59], v[48:51]
    ds_read_b128 v[108:111], v178 offset:49152
    v_mfma_f32_16x16x32_bf16 v[52:55], v[80:83], a[128:131], v[52:55]
    v_mfma_f32_16x16x32_bf16 v[112:115], v[144:147], a[232:235], v[112:115]
    v_mfma_f32_16x16x32_bf16 v[116:119], v[148:151], a[232:235], v[116:119]
    ds_read_b128 v[156:159], v180 offset:43008
    ds_read_b128 v[160:163], v186 offset:43008
    s_waitcnt vmcnt(18) lgkmcnt(7)
    v_mfma_f32_16x16x32_bf16 v[0:3], v[84:87], a[60:63], v[0:3]
    ds_read_b128 v[56:59], v178 offset:50176
    v_mfma_f32_16x16x32_bf16 v[4:7], v[84:87], a[132:135], v[4:7]
    v_mfma_f32_16x16x32_bf16 v[8:11], v[88:91], a[60:63], v[8:11]
    ds_read_b128 v[60:63], v178 offset:51200
    v_mfma_f32_16x16x32_bf16 v[12:15], v[88:91], a[132:135], v[12:15]
    s_add_u32 m0, s89, 36864
    s_add_u32 s98, s11, 36864
    buffer_load_dwordx4 v254, s[24:27], s98 offen lds
    s_waitcnt lgkmcnt(7)
    v_mfma_f32_16x16x32_bf16 v[16:19], v[92:95], a[60:63], v[16:19]
    ds_read_b128 v[64:67], v178 offset:52224
    v_mfma_f32_16x16x32_bf16 v[20:23], v[92:95], a[132:135], v[20:23]
    v_mfma_f32_16x16x32_bf16 v[24:27], v[96:99], a[60:63], v[24:27]
    ds_read_b128 v[68:71], v178 offset:53248
    v_mfma_f32_16x16x32_bf16 v[28:31], v[96:99], a[132:135], v[28:31]
    s_add_u32 m0, s89, 40960
    s_add_u32 s98, s11, 40960
    buffer_load_dwordx4 v254, s[24:27], s98 offen lds
    s_waitcnt lgkmcnt(7)
    v_mfma_f32_16x16x32_bf16 v[32:35], v[100:103], a[60:63], v[32:35]
    ds_read_b128 v[72:75], v178 offset:54272
    v_mfma_f32_16x16x32_bf16 v[36:39], v[100:103], a[132:135], v[36:39]
    v_mfma_f32_16x16x32_bf16 v[40:43], v[104:107], a[60:63], v[40:43]
    ds_read_b128 v[76:79], v178 offset:55296
    v_mfma_f32_16x16x32_bf16 v[44:47], v[104:107], a[132:135], v[44:47]
    s_add_u32 m0, s89, 45056
    s_add_u32 s98, s11, 45056
    buffer_load_dwordx4 v254, s[24:27], s98 offen lds
    s_waitcnt lgkmcnt(6)
    v_mfma_f32_16x16x32_bf16 v[48:51], v[108:111], a[60:63], v[48:51]
    ds_read_b128 v[80:83], v178 offset:56320
    v_mfma_f32_16x16x32_bf16 v[52:55], v[108:111], a[132:135], v[52:55]
    v_mfma_f32_16x16x32_bf16 v[112:115], v[156:159], a[232:235], v[112:115]
    v_mfma_f32_16x16x32_bf16 v[116:119], v[160:163], a[232:235], v[116:119]
    ds_read_b128 v[144:147], v180 offset:50176
    ds_read_b128 v[148:151], v186 offset:50176
    s_waitcnt vmcnt(19) lgkmcnt(7)
    v_mfma_f32_16x16x32_bf16 v[0:3], v[56:59], a[64:67], v[0:3]
    ds_read_b128 v[84:87], v178 offset:57344
    v_mfma_f32_16x16x32_bf16 v[4:7], v[56:59], a[136:139], v[4:7]
    v_mfma_f32_16x16x32_bf16 v[8:11], v[60:63], a[64:67], v[8:11]
    ds_read_b128 v[88:91], v178 offset:58368
    v_mfma_f32_16x16x32_bf16 v[12:15], v[60:63], a[136:139], v[12:15]
    s_add_u32 m0, s89, 49152
    s_add_u32 s98, s11, 49152
    buffer_load_dwordx4 v254, s[24:27], s98 offen lds
    s_waitcnt lgkmcnt(7)
    v_mfma_f32_16x16x32_bf16 v[16:19], v[64:67], a[64:67], v[16:19]
    ds_read_b128 v[92:95], v178 offset:59392
    v_mfma_f32_16x16x32_bf16 v[20:23], v[64:67], a[136:139], v[20:23]
    v_mfma_f32_16x16x32_bf16 v[24:27], v[68:71], a[64:67], v[24:27]
    ds_read_b128 v[96:99], v178 offset:60416
    v_mfma_f32_16x16x32_bf16 v[28:31], v[68:71], a[136:139], v[28:31]
    s_add_u32 m0, s89, 53248
    s_add_u32 s98, s11, 53248
    buffer_load_dwordx4 v254, s[24:27], s98 offen lds
    s_waitcnt lgkmcnt(7)
    v_mfma_f32_16x16x32_bf16 v[32:35], v[72:75], a[64:67], v[32:35]
    ds_read_b128 v[100:103], v178 offset:61440
    v_mfma_f32_16x16x32_bf16 v[36:39], v[72:75], a[136:139], v[36:39]
    v_mfma_f32_16x16x32_bf16 v[40:43], v[76:79], a[64:67], v[40:43]
    ds_read_b128 v[104:107], v178 offset:62464
    v_mfma_f32_16x16x32_bf16 v[44:47], v[76:79], a[136:139], v[44:47]
    s_add_u32 m0, s89, 57344
    s_add_u32 s98, s11, 57344
    buffer_load_dwordx4 v254, s[24:27], s98 offen lds
    s_waitcnt lgkmcnt(6)
    v_mfma_f32_16x16x32_bf16 v[48:51], v[80:83], a[64:67], v[48:51]
    ds_read_b128 v[108:111], v178 offset:63488
    v_mfma_f32_16x16x32_bf16 v[52:55], v[80:83], a[136:139], v[52:55]
    v_mfma_f32_16x16x32_bf16 v[112:115], v[144:147], a[232:235], v[112:115]
    v_mfma_f32_16x16x32_bf16 v[116:119], v[148:151], a[232:235], v[116:119]
    ds_read_b128 v[156:159], v180 offset:57344
    ds_read_b128 v[160:163], v186 offset:57344
    s_waitcnt vmcnt(20) lgkmcnt(7)
    v_mfma_f32_16x16x32_bf16 v[0:3], v[84:87], a[68:71], v[0:3]
    v_mfma_f32_16x16x32_bf16 v[4:7], v[84:87], a[140:143], v[4:7]
    v_mfma_f32_16x16x32_bf16 v[8:11], v[88:91], a[68:71], v[8:11]
    v_mfma_f32_16x16x32_bf16 v[12:15], v[88:91], a[140:143], v[12:15]
    s_add_u32 m0, s89, 61440
    s_add_u32 s98, s11, 61440
    buffer_load_dwordx4 v254, s[24:27], s98 offen lds
    s_waitcnt lgkmcnt(5)
    v_mfma_f32_16x16x32_bf16 v[16:19], v[92:95], a[68:71], v[16:19]
    v_mfma_f32_16x16x32_bf16 v[20:23], v[92:95], a[140:143], v[20:23]
    v_mfma_f32_16x16x32_bf16 v[24:27], v[96:99], a[68:71], v[24:27]
    v_mfma_f32_16x16x32_bf16 v[28:31], v[96:99], a[140:143], v[28:31]
    s_add_u32 m0, s89, 65536
    s_add_u32 s98, s11, 65536
    buffer_load_dwordx4 v254, s[24:27], s98 offen lds
    s_waitcnt lgkmcnt(3)
    v_mfma_f32_16x16x32_bf16 v[32:35], v[100:103], a[68:71], v[32:35]
    v_mfma_f32_16x16x32_bf16 v[36:39], v[100:103], a[140:143], v[36:39]
    v_mfma_f32_16x16x32_bf16 v[40:43], v[104:107], a[68:71], v[40:43]
    v_mfma_f32_16x16x32_bf16 v[44:47], v[104:107], a[140:143], v[44:47]
    s_add_u32 m0, s89, 69632
    s_add_u32 s98, s11, 69632
    buffer_load_dwordx4 v254, s[24:27], s98 offen lds
    s_waitcnt lgkmcnt(0)
    v_mfma_f32_16x16x32_bf16 v[48:51], v[108:111], a[68:71], v[48:51]
    v_mfma_f32_16x16x32_bf16 v[52:55], v[108:111], a[140:143], v[52:55]
    v_mfma_f32_16x16x32_bf16 v[112:115], v[156:159], a[232:235], v[112:115]
    v_mfma_f32_16x16x32_bf16 v[116:119], v[160:163], a[232:235], v[116:119]
    s_add_u32 s56, s44, 2
    s_lshl_b32 s56, s56, 6
    s_add_u32 s56, s56, 162944
    s_add_u32 s57, s44, 4
    s_cmp_ge_u32 s44, 2
    s_cselect_b32 s57, s57, s44
    s_lshl_b32 s57, s57, 6
    s_add_u32 s57, s57, 162944
    v_lshlrev_b32 v148, 4, v199
    v_add_u32 v149, s57, v148
    v_add_u32 v148, s56, v148
    s_not_b64 exec, s[66:67]
    ds_write_b128 v148, v[112:115]
    ds_write_b128 v149, v[116:119]
    s_mov_b64 exec, -1
    s_branch Lnoxj_47
Lnox_46:
    s_nop 0
    s_waitcnt vmcnt(8)
    s_waitcnt lgkmcnt(0)
    s_barrier
    ds_read_b128 v[56:59], v177 offset:0
    ds_read_b128 v[60:63], v177 offset:1024
    ds_read_b128 v[64:67], v177 offset:2048
    ds_read_b128 v[68:71], v177 offset:3072
    ds_read_b128 v[72:75], v177 offset:4096
    ds_read_b128 v[76:79], v177 offset:5120
    ds_read_b128 v[80:83], v177 offset:6144
    s_waitcnt lgkmcnt(5)
    v_mfma_f32_16x16x32_bf16 v[0:3], v[56:59], a[0:3], 0
    ds_read_b128 v[84:87], v177 offset:7168
    v_mfma_f32_16x16x32_bf16 v[4:7], v[56:59], a[72:75], 0
    v_mfma_f32_16x16x32_bf16 v[8:11], v[60:63], a[0:3], 0
    ds_read_b128 v[88:91], v177 offset:8192
    v_mfma_f32_16x16x32_bf16 v[12:15], v[60:63], a[72:75], 0
    s_add_u32 s96, s96, 4096
    s_add_u32 s97, s97, 4096
    buffer_load_dwordx4 a[16:19], v176, s[24:27], s96 offen offset:0 sc1
    s_waitcnt lgkmcnt(5)
    v_mfma_f32_16x16x32_bf16 v[16:19], v[64:67], a[0:3], 0
    ds_read_b128 v[92:95], v177 offset:9216
    v_mfma_f32_16x16x32_bf16 v[20:23], v[64:67], a[72:75], 0
    v_mfma_f32_16x16x32_bf16 v[24:27], v[68:71], a[0:3], 0
    ds_read_b128 v[96:99], v177 offset:10240
    v_mfma_f32_16x16x32_bf16 v[28:31], v[68:71], a[72:75], 0
    buffer_load_dwordx4 a[88:91], v176, s[24:27], s97 offen offset:0 sc1
    s_waitcnt lgkmcnt(5)
    v_mfma_f32_16x16x32_bf16 v[32:35], v[72:75], a[0:3], 0
    ds_read_b128 v[100:103], v177 offset:11264
    v_mfma_f32_16x16x32_bf16 v[36:39], v[72:75], a[72:75], 0
    v_mfma_f32_16x16x32_bf16 v[40:43], v[76:79], a[0:3], 0
    ds_read_b128 v[104:107], v177 offset:12288
    v_mfma_f32_16x16x32_bf16 v[44:47], v[76:79], a[72:75], 0
    buffer_load_dwordx4 a[20:23], v176, s[24:27], s96 offen offset:1024 sc1
    s_waitcnt lgkmcnt(6)
    v_mfma_f32_16x16x32_bf16 v[48:51], v[80:83], a[0:3], 0
    ds_read_b128 v[108:111], v177 offset:13312
    v_mfma_f32_16x16x32_bf16 v[52:55], v[80:83], a[72:75], 0
    s_waitcnt vmcnt(9) lgkmcnt(5)
    v_mfma_f32_16x16x32_bf16 v[0:3], v[84:87], a[4:7], v[0:3]
    ds_read_b128 v[56:59], v177 offset:14336
    v_mfma_f32_16x16x32_bf16 v[4:7], v[84:87], a[76:79], v[4:7]
    v_mfma_f32_16x16x32_bf16 v[8:11], v[88:91], a[4:7], v[8:11]
    ds_read_b128 v[60:63], v177 offset:15360
    v_mfma_f32_16x16x32_bf16 v[12:15], v[88:91], a[76:79], v[12:15]
    buffer_load_dwordx4 a[92:95], v176, s[24:27], s97 offen offset:1024 sc1
    s_waitcnt lgkmcnt(5)
    v_mfma_f32_16x16x32_bf16 v[16:19], v[92:95], a[4:7], v[16:19]
    ds_read_b128 v[64:67], v177 offset:16384
    v_mfma_f32_16x16x32_bf16 v[20:23], v[92:95], a[76:79], v[20:23]
    v_mfma_f32_16x16x32_bf16 v[24:27], v[96:99], a[4:7], v[24:27]
    ds_read_b128 v[68:71], v177 offset:17408
    v_mfma_f32_16x16x32_bf16 v[28:31], v[96:99], a[76:79], v[28:31]
    buffer_load_dwordx4 a[24:27], v176, s[24:27], s96 offen offset:2048 sc1
    s_waitcnt lgkmcnt(5)
    v_mfma_f32_16x16x32_bf16 v[32:35], v[100:103], a[4:7], v[32:35]
    ds_read_b128 v[72:75], v177 offset:18432
    v_mfma_f32_16x16x32_bf16 v[36:39], v[100:103], a[76:79], v[36:39]
    v_mfma_f32_16x16x32_bf16 v[40:43], v[104:107], a[4:7], v[40:43]
    ds_read_b128 v[76:79], v177 offset:19456
    v_mfma_f32_16x16x32_bf16 v[44:47], v[104:107], a[76:79], v[44:47]
    buffer_load_dwordx4 a[96:99], v176, s[24:27], s97 offen offset:2048 sc1
    s_waitcnt lgkmcnt(6)
    v_mfma_f32_16x16x32_bf16 v[48:51], v[108:111], a[4:7], v[48:51]
    ds_read_b128 v[80:83], v177 offset:20480
    v_mfma_f32_16x16x32_bf16 v[52:55], v[108:111], a[76:79], v[52:55]
    s_waitcnt vmcnt(10) lgkmcnt(5)
    v_mfma_f32_16x16x32_bf16 v[0:3], v[56:59], a[8:11], v[0:3]
    ds_read_b128 v[84:87], v177 offset:21504
    v_mfma_f32_16x16x32_bf16 v[4:7], v[56:59], a[80:83], v[4:7]
    v_mfma_f32_16x16x32_bf16 v[8:11], v[60:63], a[8:11], v[8:11]
    ds_read_b128 v[88:91], v177 offset:22528
    v_mfma_f32_16x16x32_bf16 v[12:15], v[60:63], a[80:83], v[12:15]
    buffer_load_dwordx4 a[28:31], v176, s[24:27], s96 offen offset:3072 sc1
    s_waitcnt lgkmcnt(5)
    v_mfma_f32_16x16x32_bf16 v[16:19], v[64:67], a[8:11], v[16:19]
    ds_read_b128 v[92:95], v177 offset:23552
    v_mfma_f32_16x16x32_bf16 v[20:23], v[64:67], a[80:83], v[20:23]
    v_mfma_f32_16x16x32_bf16 v[24:27], v[68:71], a[8:11], v[24:27]
    ds_read_b128 v[96:99], v177 offset:24576
    v_mfma_f32_16x16x32_bf16 v[28:31], v[68:71], a[80:83], v[28:31]
    buffer_load_dwordx4 a[100:103], v176, s[24:27], s97 offen offset:3072 sc1
    s_waitcnt lgkmcnt(5)
    v_mfma_f32_16x16x32_bf16 v[32:35], v[72:75], a[8:11], v[32:35]
    ds_read_b128 v[100:103], v177 offset:25600
    v_mfma_f32_16x16x32_bf16 v[36:39], v[72:75], a[80:83], v[36:39]
    v_mfma_f32_16x16x32_bf16 v[40:43], v[76:79], a[8:11], v[40:43]
    ds_read_b128 v[104:107], v177 offset:26624
    v_mfma_f32_16x16x32_bf16 v[44:47], v[76:79], a[80:83], v[44:47]
    s_add_u32 s96, s96, 4096
    s_add_u32 s97, s97, 4096
    buffer_load_dwordx4 a[32:35], v176, s[24:27], s96 offen offset:0 sc1
    s_waitcnt lgkmcnt(6)
    v_mfma_f32_16x16x32_bf16 v[48:51], v[80:83], a[8:11], v[48:51]
    ds_read_b128 v[108:111], v177 offset:27648
    v_mfma_f32_16x16x32_bf16 v[52:55], v[80:83], a[80:83], v[52:55]
    s_waitcnt vmcnt(9) lgkmcnt(5)
    v_mfma_f32_16x16x32_bf16 v[0:3], v[84:87], a[12:15], v[0:3]
    ds_read_b128 v[56:59], v177 offset:28672
    v_mfma_f32_16x16x32_bf16 v[4:7], v[84:87], a[84:87], v[4:7]
    v_mfma_f32_16x16x32_bf16 v[8:11], v[88:91], a[12:15], v[8:11]
    ds_read_b128 v[60:63], v177 offset:29696
    v_mfma_f32_16x16x32_bf16 v[12:15], v[88:91], a[84:87], v[12:15]
    buffer_load_dwordx4 a[104:107], v176, s[24:27], s97 offen offset:0 sc1
    s_waitcnt lgkmcnt(5)
    v_mfma_f32_16x16x32_bf16 v[16:19], v[92:95], a[12:15], v[16:19]
    ds_read_b128 v[64:67], v177 offset:30720
    v_mfma_f32_16x16x32_bf16 v[20:23], v[92:95], a[84:87], v[20:23]
    v_mfma_f32_16x16x32_bf16 v[24:27], v[96:99], a[12:15], v[24:27]
    ds_read_b128 v[68:71], v177 offset:31744
    v_mfma_f32_16x16x32_bf16 v[28:31], v[96:99], a[84:87], v[28:31]
    buffer_load_dwordx4 a[36:39], v176, s[24:27], s96 offen offset:1024 sc1
    s_waitcnt lgkmcnt(5)
    v_mfma_f32_16x16x32_bf16 v[32:35], v[100:103], a[12:15], v[32:35]
    ds_read_b128 v[72:75], v177 offset:32768
    v_mfma_f32_16x16x32_bf16 v[36:39], v[100:103], a[84:87], v[36:39]
    v_mfma_f32_16x16x32_bf16 v[40:43], v[104:107], a[12:15], v[40:43]
    ds_read_b128 v[76:79], v177 offset:33792
    v_mfma_f32_16x16x32_bf16 v[44:47], v[104:107], a[84:87], v[44:47]
    buffer_load_dwordx4 a[108:111], v176, s[24:27], s97 offen offset:1024 sc1
    s_waitcnt lgkmcnt(6)
    v_mfma_f32_16x16x32_bf16 v[48:51], v[108:111], a[12:15], v[48:51]
    ds_read_b128 v[80:83], v177 offset:34816
    v_mfma_f32_16x16x32_bf16 v[52:55], v[108:111], a[84:87], v[52:55]
    s_waitcnt vmcnt(10) lgkmcnt(5)
    v_mfma_f32_16x16x32_bf16 v[0:3], v[56:59], a[16:19], v[0:3]
    ds_read_b128 v[84:87], v177 offset:35840
    v_mfma_f32_16x16x32_bf16 v[4:7], v[56:59], a[88:91], v[4:7]
    v_mfma_f32_16x16x32_bf16 v[8:11], v[60:63], a[16:19], v[8:11]
    ds_read_b128 v[88:91], v177 offset:36864
    v_mfma_f32_16x16x32_bf16 v[12:15], v[60:63], a[88:91], v[12:15]
    buffer_load_dwordx4 a[40:43], v176, s[24:27], s96 offen offset:2048 sc1
    s_waitcnt lgkmcnt(5)
    v_mfma_f32_16x16x32_bf16 v[16:19], v[64:67], a[16:19], v[16:19]
    ds_read_b128 v[92:95], v177 offset:37888
    v_mfma_f32_16x16x32_bf16 v[20:23], v[64:67], a[88:91], v[20:23]
    v_mfma_f32_16x16x32_bf16 v[24:27], v[68:71], a[16:19], v[24:27]
    ds_read_b128 v[96:99], v177 offset:38912
    v_mfma_f32_16x16x32_bf16 v[28:31], v[68:71], a[88:91], v[28:31]
    buffer_load_dwordx4 a[112:115], v176, s[24:27], s97 offen offset:2048 sc1
    s_waitcnt lgkmcnt(5)
    v_mfma_f32_16x16x32_bf16 v[32:35], v[72:75], a[16:19], v[32:35]
    ds_read_b128 v[100:103], v177 offset:39936
    v_mfma_f32_16x16x32_bf16 v[36:39], v[72:75], a[88:91], v[36:39]
    v_mfma_f32_16x16x32_bf16 v[40:43], v[76:79], a[16:19], v[40:43]
    ds_read_b128 v[104:107], v177 offset:40960
    v_mfma_f32_16x16x32_bf16 v[44:47], v[76:79], a[88:91], v[44:47]
    buffer_load_dwordx4 a[44:47], v176, s[24:27], s96 offen offset:3072 sc1
    s_waitcnt lgkmcnt(6)
    v_mfma_f32_16x16x32_bf16 v[48:51], v[80:83], a[16:19], v[48:51]
    ds_read_b128 v[108:111], v177 offset:41984
    v_mfma_f32_16x16x32_bf16 v[52:55], v[80:83], a[88:91], v[52:55]
    s_waitcnt vmcnt(11) lgkmcnt(5)
    v_mfma_f32_16x16x32_bf16 v[0:3], v[84:87], a[20:23], v[0:3]
    ds_read_b128 v[56:59], v177 offset:43008
    v_mfma_f32_16x16x32_bf16 v[4:7], v[84:87], a[92:95], v[4:7]
    v_add_f32 v132, v132, v134
    v_mfma_f32_16x16x32_bf16 v[8:11], v[88:91], a[20:23], v[8:11]
    ds_read_b128 v[60:63], v177 offset:44032
    v_mfma_f32_16x16x32_bf16 v[12:15], v[88:91], a[92:95], v[12:15]
    buffer_load_dwordx4 a[116:119], v176, s[24:27], s97 offen offset:3072 sc1
    s_waitcnt lgkmcnt(5)
    v_mfma_f32_16x16x32_bf16 v[16:19], v[92:95], a[20:23], v[16:19]
    ds_read_b128 v[64:67], v177 offset:45056
    v_mfma_f32_16x16x32_bf16 v[20:23], v[92:95], a[92:95], v[20:23]
    v_add_f32 v133, v133, v135
    v_mfma_f32_16x16x32_bf16 v[24:27], v[96:99], a[20:23], v[24:27]
    ds_read_b128 v[68:71], v177 offset:46080
    v_mfma_f32_16x16x32_bf16 v[28:31], v[96:99], a[92:95], v[28:31]
    s_add_u32 s96, s96, 4096
    s_add_u32 s97, s97, 4096
    buffer_load_dwordx4 a[48:51], v176, s[24:27], s96 offen offset:0 sc1
    s_waitcnt lgkmcnt(5)
    v_mfma_f32_16x16x32_bf16 v[32:35], v[100:103], a[20:23], v[32:35]
    ds_read_b128 v[72:75], v177 offset:47104
    v_mfma_f32_16x16x32_bf16 v[36:39], v[100:103], a[92:95], v[36:39]
    v_permlane16_swap_b32 v132, v133
    v_mfma_f32_16x16x32_bf16 v[40:43], v[104:107], a[20:23], v[40:43]
    ds_read_b128 v[76:79], v177 offset:48128
    v_mfma_f32_16x16x32_bf16 v[44:47], v[104:107], a[92:95], v[44:47]
    buffer_load_dwordx4 a[120:123], v176, s[24:27], s97 offen offset:0 sc1
    s_waitcnt lgkmcnt(6)
    v_mfma_f32_16x16x32_bf16 v[48:51], v[108:111], a[20:23], v[48:51]
    ds_read_b128 v[80:83], v177 offset:49152
    v_mfma_f32_16x16x32_bf16 v[52:55], v[108:111], a[92:95], v[52:55]
    v_add_f32 v132, v132, v133
    s_waitcnt vmcnt(12) lgkmcnt(5)
    v_mfma_f32_16x16x32_bf16 v[0:3], v[56:59], a[24:27], v[0:3]
    ds_read_b128 v[84:87], v177 offset:50176
    v_mfma_f32_16x16x32_bf16 v[4:7], v[56:59], a[96:99], v[4:7]
    v_mov_b32 v134, v132
    v_mfma_f32_16x16x32_bf16 v[8:11], v[60:63], a[24:27], v[8:11]
    ds_read_b128 v[88:91], v177 offset:51200
    v_mfma_f32_16x16x32_bf16 v[12:15], v[60:63], a[96:99], v[12:15]
    buffer_load_dwordx4 a[52:55], v176, s[24:27], s96 offen offset:1024 sc1
    s_waitcnt lgkmcnt(5)
    v_mfma_f32_16x16x32_bf16 v[16:19], v[64:67], a[24:27], v[16:19]
    ds_read_b128 v[92:95], v177 offset:52224
    v_mfma_f32_16x16x32_bf16 v[20:23], v[64:67], a[96:99], v[20:23]
    v_permlane32_swap_b32 v132, v134
    v_mfma_f32_16x16x32_bf16 v[24:27], v[68:71], a[24:27], v[24:27]
    ds_read_b128 v[96:99], v177 offset:53248
    v_mfma_f32_16x16x32_bf16 v[28:31], v[68:71], a[96:99], v[28:31]
    buffer_load_dwordx4 a[124:127], v176, s[24:27], s97 offen offset:1024 sc1
    s_waitcnt lgkmcnt(5)
    v_mfma_f32_16x16x32_bf16 v[32:35], v[72:75], a[24:27], v[32:35]
    ds_read_b128 v[100:103], v177 offset:54272
    v_mfma_f32_16x16x32_bf16 v[36:39], v[72:75], a[96:99], v[36:39]
    v_add_f32 v132, v132, v134
    v_mfma_f32_16x16x32_bf16 v[40:43], v[76:79], a[24:27], v[40:43]
    ds_read_b128 v[104:107], v177 offset:55296
    v_mfma_f32_16x16x32_bf16 v[44:47], v[76:79], a[96:99], v[44:47]
    buffer_load_dwordx4 a[56:59], v176, s[24:27], s96 offen offset:2048 sc1
    s_waitcnt lgkmcnt(6)
    v_mfma_f32_16x16x32_bf16 v[48:51], v[80:83], a[24:27], v[48:51]
    ds_read_b128 v[108:111], v177 offset:56320
    v_mfma_f32_16x16x32_bf16 v[52:55], v[80:83], a[96:99], v[52:55]
    v_mov_b32 v133, v132
    s_waitcnt vmcnt(13) lgkmcnt(5)
    v_mfma_f32_16x16x32_bf16 v[0:3], v[84:87], a[28:31], v[0:3]
    ds_read_b128 v[56:59], v177 offset:57344
    v_mfma_f32_16x16x32_bf16 v[4:7], v[84:87], a[100:103], v[4:7]
    v_permlane16_swap_b32 v132, v133
    v_mfma_f32_16x16x32_bf16 v[8:11], v[88:91], a[28:31], v[8:11]
    ds_read_b128 v[60:63], v177 offset:58368
    v_mfma_f32_16x16x32_bf16 v[12:15], v[88:91], a[100:103], v[12:15]
    buffer_load_dwordx4 a[128:131], v176, s[24:27], s97 offen offset:2048 sc1
    s_waitcnt lgkmcnt(5)
    v_mfma_f32_16x16x32_bf16 v[16:19], v[92:95], a[28:31], v[16:19]
    ds_read_b128 v[64:67], v177 offset:59392
    v_mfma_f32_16x16x32_bf16 v[20:23], v[92:95], a[100:103], v[20:23]
    v_mul_f32 v120, 0xbae38e39, v132
    v_mfma_f32_16x16x32_bf16 v[24:27], v[96:99], a[28:31], v[24:27]
    ds_read_b128 v[68:71], v177 offset:60416
    v_mfma_f32_16x16x32_bf16 v[28:31], v[96:99], a[100:103], v[28:31]
    buffer_load_dwordx4 a[60:63], v176, s[24:27], s96 offen offset:3072 sc1
    s_waitcnt lgkmcnt(5)
    v_mfma_f32_16x16x32_bf16 v[32:35], v[100:103], a[28:31], v[32:35]
    ds_read_b128 v[72:75], v177 offset:61440
    v_mfma_f32_16x16x32_bf16 v[36:39], v[100:103], a[100:103], v[36:39]
    v_mul_f32 v133, 0x3ae38e39, v133
    v_mfma_f32_16x16x32_bf16 v[40:43], v[104:107], a[28:31], v[40:43]
    ds_read_b128 v[76:79], v177 offset:62464
    v_mfma_f32_16x16x32_bf16 v[44:47], v[104:107], a[100:103], v[44:47]
    buffer_load_dwordx4 a[132:135], v176, s[24:27], s97 offen offset:3072 sc1
    s_waitcnt lgkmcnt(6)
    v_mfma_f32_16x16x32_bf16 v[48:51], v[108:111], a[28:31], v[48:51]
    ds_read_b128 v[80:83], v177 offset:63488
    v_mfma_f32_16x16x32_bf16 v[52:55], v[108:111], a[100:103], v[52:55]
    v_fma_f32 v133, -v120, v120, v133
    s_waitcnt vmcnt(14) lgkmcnt(5)
    v_mfma_f32_16x16x32_bf16 v[0:3], v[56:59], a[32:35], v[0:3]
    ds_read_b128 v[84:87], v178 offset:0
    v_mfma_f32_16x16x32_bf16 v[4:7], v[56:59], a[104:107], v[4:7]
    v_max_f32 v133, 0, v133
    v_mfma_f32_16x16x32_bf16 v[8:11], v[60:63], a[32:35], v[8:11]
    ds_read_b128 v[88:91], v178 offset:1024
    v_mfma_f32_16x16x32_bf16 v[12:15], v[60:63], a[104:107], v[12:15]
    s_add_u32 s96, s96, 4096
    s_add_u32 s97, s97, 4096
    buffer_load_dwordx4 a[64:67], v176, s[24:27], s96 offen offset:0 sc1
    s_waitcnt lgkmcnt(5)
    v_mfma_f32_16x16x32_bf16 v[16:19], v[64:67], a[32:35], v[16:19]
    ds_read_b128 v[92:95], v178 offset:2048
    v_mfma_f32_16x16x32_bf16 v[20:23], v[64:67], a[104:107], v[20:23]
    v_add_f32 v133, 0x3727c5ac, v133
    v_mfma_f32_16x16x32_bf16 v[24:27], v[68:71], a[32:35], v[24:27]
    ds_read_b128 v[96:99], v178 offset:3072
    v_mfma_f32_16x16x32_bf16 v[28:31], v[68:71], a[104:107], v[28:31]
    buffer_load_dwordx4 a[136:139], v176, s[24:27], s97 offen offset:0 sc1
    s_waitcnt lgkmcnt(5)
    v_mfma_f32_16x16x32_bf16 v[32:35], v[72:75], a[32:35], v[32:35]
    ds_read_b128 v[100:103], v178 offset:4096
    v_mfma_f32_16x16x32_bf16 v[36:39], v[72:75], a[104:107], v[36:39]
    v_rsq_f32 v126, v133
    v_mfma_f32_16x16x32_bf16 v[40:43], v[76:79], a[32:35], v[40:43]
    ds_read_b128 v[104:107], v178 offset:5120
    v_mfma_f32_16x16x32_bf16 v[44:47], v[76:79], a[104:107], v[44:47]
    buffer_load_dwordx4 a[68:71], v176, s[24:27], s96 offen offset:1024 sc1
    s_waitcnt lgkmcnt(6)
    v_mfma_f32_16x16x32_bf16 v[48:51], v[80:83], a[32:35], v[48:51]
    ds_read_b128 v[108:111], v178 offset:6144
    v_mfma_f32_16x16x32_bf16 v[52:55], v[80:83], a[104:107], v[52:55]
    v_add_f32 v136, v136, v138
    s_waitcnt vmcnt(15) lgkmcnt(5)
    v_mfma_f32_16x16x32_bf16 v[0:3], v[84:87], a[36:39], v[0:3]
    ds_read_b128 v[56:59], v178 offset:7168
    v_mfma_f32_16x16x32_bf16 v[4:7], v[84:87], a[108:111], v[4:7]
    v_add_f32 v137, v137, v139
    v_mfma_f32_16x16x32_bf16 v[8:11], v[88:91], a[36:39], v[8:11]
    ds_read_b128 v[60:63], v178 offset:8192
    v_mfma_f32_16x16x32_bf16 v[12:15], v[88:91], a[108:111], v[12:15]
    buffer_load_dwordx4 a[140:143], v176, s[24:27], s97 offen offset:1024 sc1
    s_waitcnt lgkmcnt(5)
    v_mfma_f32_16x16x32_bf16 v[16:19], v[92:95], a[36:39], v[16:19]
    ds_read_b128 v[64:67], v178 offset:9216
    v_mfma_f32_16x16x32_bf16 v[20:23], v[92:95], a[108:111], v[20:23]
    v_permlane16_swap_b32 v136, v137
    v_mfma_f32_16x16x32_bf16 v[24:27], v[96:99], a[36:39], v[24:27]
    ds_read_b128 v[68:71], v178 offset:10240
    v_mfma_f32_16x16x32_bf16 v[28:31], v[96:99], a[108:111], v[28:31]
    s_add_u32 s84, s8, 0
    buffer_load_dwordx4 a[144:147], v254, s[4:7], s84 offen
    s_waitcnt lgkmcnt(5)
    v_mfma_f32_16x16x32_bf16 v[32:35], v[100:103], a[36:39], v[32:35]
    ds_read_b128 v[72:75], v178 offset:11264
    v_mfma_f32_16x16x32_bf16 v[36:39], v[100:103], a[108:111], v[36:39]
    v_add_f32 v136, v136, v137
    v_mfma_f32_16x16x32_bf16 v[40:43], v[104:107], a[36:39], v[40:43]
    ds_read_b128 v[76:79], v178 offset:12288
    v_mfma_f32_16x16x32_bf16 v[44:47], v[104:107], a[108:111], v[44:47]
    s_add_u32 s84, s8, 4096
    buffer_load_dwordx4 a[148:151], v254, s[4:7], s84 offen
    s_waitcnt lgkmcnt(6)
    v_mfma_f32_16x16x32_bf16 v[48:51], v[108:111], a[36:39], v[48:51]
    ds_read_b128 v[80:83], v178 offset:13312
    v_mfma_f32_16x16x32_bf16 v[52:55], v[108:111], a[108:111], v[52:55]
    v_mov_b32 v138, v136
    s_waitcnt vmcnt(16) lgkmcnt(5)
    v_mfma_f32_16x16x32_bf16 v[0:3], v[56:59], a[40:43], v[0:3]
    ds_read_b128 v[84:87], v178 offset:14336
    v_mfma_f32_16x16x32_bf16 v[4:7], v[56:59], a[112:115], v[4:7]
    v_permlane32_swap_b32 v136, v138
    v_mfma_f32_16x16x32_bf16 v[8:11], v[60:63], a[40:43], v[8:11]
    ds_read_b128 v[88:91], v178 offset:15360
    v_mfma_f32_16x16x32_bf16 v[12:15], v[60:63], a[112:115], v[12:15]
    s_add_u32 s84, s8, 8192
    buffer_load_dwordx4 a[152:155], v254, s[4:7], s84 offen
    s_waitcnt lgkmcnt(5)
    v_mfma_f32_16x16x32_bf16 v[16:19], v[64:67], a[40:43], v[16:19]
    ds_read_b128 v[92:95], v178 offset:16384
    v_mfma_f32_16x16x32_bf16 v[20:23], v[64:67], a[112:115], v[20:23]
    v_add_f32 v136, v136, v138
    v_mfma_f32_16x16x32_bf16 v[24:27], v[68:71], a[40:43], v[24:27]
    ds_read_b128 v[96:99], v178 offset:17408
    v_mfma_f32_16x16x32_bf16 v[28:31], v[68:71], a[112:115], v[28:31]
    s_add_u32 s84, s8, 12288
    buffer_load_dwordx4 a[156:159], v254, s[4:7], s84 offen
    s_waitcnt lgkmcnt(5)
    v_mfma_f32_16x16x32_bf16 v[32:35], v[72:75], a[40:43], v[32:35]
    ds_read_b128 v[100:103], v178 offset:18432
    v_mfma_f32_16x16x32_bf16 v[36:39], v[72:75], a[112:115], v[36:39]
    v_mov_b32 v137, v136
    v_mfma_f32_16x16x32_bf16 v[40:43], v[76:79], a[40:43], v[40:43]
    ds_read_b128 v[104:107], v178 offset:19456
    v_mfma_f32_16x16x32_bf16 v[44:47], v[76:79], a[112:115], v[44:47]
    s_add_u32 s84, s8, 16384
    buffer_load_dwordx4 a[160:163], v254, s[4:7], s84 offen
    s_waitcnt lgkmcnt(6)
    v_mfma_f32_16x16x32_bf16 v[48:51], v[80:83], a[40:43], v[48:51]
    ds_read_b128 v[108:111], v178 offset:20480
    v_mfma_f32_16x16x32_bf16 v[52:55], v[80:83], a[112:115], v[52:55]
    v_permlane16_swap_b32 v136, v137
    s_waitcnt vmcnt(17) lgkmcnt(5)
    v_mfma_f32_16x16x32_bf16 v[0:3], v[84:87], a[44:47], v[0:3]
    ds_read_b128 v[56:59], v178 offset:21504
    v_mfma_f32_16x16x32_bf16 v[4:7], v[84:87], a[116:119], v[4:7]
    v_mul_f32 v122, 0xbae38e39, v136
    v_mfma_f32_16x16x32_bf16 v[8:11], v[88:91], a[44:47], v[8:11]
    ds_read_b128 v[60:63], v178 offset:22528
    v_mfma_f32_16x16x32_bf16 v[12:15], v[88:91], a[116:119], v[12:15]
    s_waitcnt lgkmcnt(5)
    v_mfma_f32_16x16x32_bf16 v[16:19], v[92:95], a[44:47], v[16:19]
    ds_read_b128 v[64:67], v178 offset:23552
    v_mfma_f32_16x16x32_bf16 v[20:23], v[92:95], a[116:119], v[20:23]
    v_mul_f32 v137, 0x3ae38e39, v137
    v_mfma_f32_16x16x32_bf16 v[24:27], v[96:99], a[44:47], v[24:27]
    ds_read_b128 v[68:71], v178 offset:24576
    v_mfma_f32_16x16x32_bf16 v[28:31], v[96:99], a[116:119], v[28:31]
    s_waitcnt lgkmcnt(5)
    v_mfma_f32_16x16x32_bf16 v[32:35], v[100:103], a[44:47], v[32:35]
    ds_read_b128 v[72:75], v178 offset:25600
    v_mfma_f32_16x16x32_bf16 v[36:39], v[100:103], a[116:119], v[36:39]
    v_fma_f32 v137, -v122, v122, v137
    v_mfma_f32_16x16x32_bf16 v[40:43], v[104:107], a[44:47], v[40:43]
    ds_read_b128 v[76:79], v178 offset:26624
    v_mfma_f32_16x16x32_bf16 v[44:47], v[104:107], a[116:119], v[44:47]
    s_waitcnt lgkmcnt(6)
    v_mfma_f32_16x16x32_bf16 v[48:51], v[108:111], a[44:47], v[48:51]
    ds_read_b128 v[80:83], v178 offset:27648
    v_mfma_f32_16x16x32_bf16 v[52:55], v[108:111], a[116:119], v[52:55]
    v_max_f32 v137, 0, v137
    s_barrier
    s_waitcnt vmcnt(15) lgkmcnt(5)
    v_mfma_f32_16x16x32_bf16 v[0:3], v[56:59], a[48:51], v[0:3]
    ds_read_b128 v[84:87], v178 offset:28672
    v_mfma_f32_16x16x32_bf16 v[4:7], v[56:59], a[120:123], v[4:7]
    v_add_f32 v137, 0x3727c5ac, v137
    v_mfma_f32_16x16x32_bf16 v[8:11], v[60:63], a[48:51], v[8:11]
    ds_read_b128 v[88:91], v178 offset:29696
    v_mfma_f32_16x16x32_bf16 v[12:15], v[60:63], a[120:123], v[12:15]
    s_add_u32 m0, s89, 0
    s_add_u32 s98, s11, 0
    buffer_load_dwordx4 v254, s[24:27], s98 offen lds
    s_waitcnt lgkmcnt(5)
    v_mfma_f32_16x16x32_bf16 v[16:19], v[64:67], a[48:51], v[16:19]
    ds_read_b128 v[92:95], v178 offset:30720
    v_mfma_f32_16x16x32_bf16 v[20:23], v[64:67], a[120:123], v[20:23]
    v_rsq_f32 v128, v137
    v_mfma_f32_16x16x32_bf16 v[24:27], v[68:71], a[48:51], v[24:27]
    ds_read_b128 v[96:99], v178 offset:31744
    v_mfma_f32_16x16x32_bf16 v[28:31], v[68:71], a[120:123], v[28:31]
    s_add_u32 m0, s89, 4096
    s_add_u32 s98, s11, 4096
    buffer_load_dwordx4 v254, s[24:27], s98 offen lds
    s_waitcnt lgkmcnt(5)
    v_mfma_f32_16x16x32_bf16 v[32:35], v[72:75], a[48:51], v[32:35]
    ds_read_b128 v[100:103], v178 offset:32768
    v_mfma_f32_16x16x32_bf16 v[36:39], v[72:75], a[120:123], v[36:39]
    v_mfma_f32_16x16x32_bf16 v[40:43], v[76:79], a[48:51], v[40:43]
    ds_read_b128 v[104:107], v178 offset:33792
    v_mfma_f32_16x16x32_bf16 v[44:47], v[76:79], a[120:123], v[44:47]
    s_add_u32 m0, s89, 8192
    s_add_u32 s98, s11, 8192
    buffer_load_dwordx4 v254, s[24:27], s98 offen lds
    s_waitcnt lgkmcnt(6)
    v_mfma_f32_16x16x32_bf16 v[48:51], v[80:83], a[48:51], v[48:51]
    ds_read_b128 v[108:111], v178 offset:34816
    v_mfma_f32_16x16x32_bf16 v[52:55], v[80:83], a[120:123], v[52:55]
    s_waitcnt vmcnt(16) lgkmcnt(5)
    v_mfma_f32_16x16x32_bf16 v[0:3], v[84:87], a[52:55], v[0:3]
    ds_read_b128 v[56:59], v178 offset:35840
    v_mfma_f32_16x16x32_bf16 v[4:7], v[84:87], a[124:127], v[4:7]
    v_mfma_f32_16x16x32_bf16 v[8:11], v[88:91], a[52:55], v[8:11]
    ds_read_b128 v[60:63], v178 offset:36864
    v_mfma_f32_16x16x32_bf16 v[12:15], v[88:91], a[124:127], v[12:15]
    s_add_u32 m0, s89, 12288
    s_add_u32 s98, s11, 12288
    buffer_load_dwordx4 v254, s[24:27], s98 offen lds
    s_waitcnt lgkmcnt(5)
    v_mfma_f32_16x16x32_bf16 v[16:19], v[92:95], a[52:55], v[16:19]
    ds_read_b128 v[64:67], v178 offset:37888
    v_mfma_f32_16x16x32_bf16 v[20:23], v[92:95], a[124:127], v[20:23]
    v_mfma_f32_16x16x32_bf16 v[24:27], v[96:99], a[52:55], v[24:27]
    ds_read_b128 v[68:71], v178 offset:38912
    v_mfma_f32_16x16x32_bf16 v[28:31], v[96:99], a[124:127], v[28:31]
    s_add_u32 m0, s89, 16384
    s_add_u32 s98, s11, 16384
    buffer_load_dwordx4 v254, s[24:27], s98 offen lds
    s_waitcnt lgkmcnt(5)
    v_mfma_f32_16x16x32_bf16 v[32:35], v[100:103], a[52:55], v[32:35]
    ds_read_b128 v[72:75], v178 offset:39936
    v_mfma_f32_16x16x32_bf16 v[36:39], v[100:103], a[124:127], v[36:39]
    v_mfma_f32_16x16x32_bf16 v[40:43], v[104:107], a[52:55], v[40:43]
    ds_read_b128 v[76:79], v178 offset:40960
    v_mfma_f32_16x16x32_bf16 v[44:47], v[104:107], a[124:127], v[44:47]
    s_add_u32 m0, s89, 20480
    s_add_u32 s98, s11, 20480
    buffer_load_dwordx4 v254, s[24:27], s98 offen lds
    s_waitcnt lgkmcnt(6)
    v_mfma_f32_16x16x32_bf16 v[48:51], v[108:111], a[52:55], v[48:51]
    ds_read_b128 v[80:83], v178 offset:41984
    v_mfma_f32_16x16x32_bf16 v[52:55], v[108:111], a[124:127], v[52:55]
    s_waitcnt vmcnt(17) lgkmcnt(5)
    v_mfma_f32_16x16x32_bf16 v[0:3], v[56:59], a[56:59], v[0:3]
    ds_read_b128 v[84:87], v178 offset:43008
    v_mfma_f32_16x16x32_bf16 v[4:7], v[56:59], a[128:131], v[4:7]
    v_mfma_f32_16x16x32_bf16 v[8:11], v[60:63], a[56:59], v[8:11]
    ds_read_b128 v[88:91], v178 offset:44032
    v_mfma_f32_16x16x32_bf16 v[12:15], v[60:63], a[128:131], v[12:15]
    s_add_u32 m0, s89, 24576
    s_add_u32 s98, s11, 24576
    buffer_load_dwordx4 v254, s[24:27], s98 offen lds
    s_waitcnt lgkmcnt(5)
    v_mfma_f32_16x16x32_bf16 v[16:19], v[64:67], a[56:59], v[16:19]
    ds_read_b128 v[92:95], v178 offset:45056
    v_mfma_f32_16x16x32_bf16 v[20:23], v[64:67], a[128:131], v[20:23]
    v_mfma_f32_16x16x32_bf16 v[24:27], v[68:71], a[56:59], v[24:27]
    ds_read_b128 v[96:99], v178 offset:46080
    v_mfma_f32_16x16x32_bf16 v[28:31], v[68:71], a[128:131], v[28:31]
    s_add_u32 m0, s89, 28672
    s_add_u32 s98, s11, 28672
    buffer_load_dwordx4 v254, s[24:27], s98 offen lds
    s_waitcnt lgkmcnt(5)
    v_mfma_f32_16x16x32_bf16 v[32:35], v[72:75], a[56:59], v[32:35]
    ds_read_b128 v[100:103], v178 offset:47104
    v_mfma_f32_16x16x32_bf16 v[36:39], v[72:75], a[128:131], v[36:39]
    v_mfma_f32_16x16x32_bf16 v[40:43], v[76:79], a[56:59], v[40:43]
    ds_read_b128 v[104:107], v178 offset:48128
    v_mfma_f32_16x16x32_bf16 v[44:47], v[76:79], a[128:131], v[44:47]
    s_add_u32 m0, s89, 32768
    s_add_u32 s98, s11, 32768
    buffer_load_dwordx4 v254, s[24:27], s98 offen lds
    s_waitcnt lgkmcnt(6)
    v_mfma_f32_16x16x32_bf16 v[48:51], v[80:83], a[56:59], v[48:51]
    ds_read_b128 v[108:111], v178 offset:49152
    v_mfma_f32_16x16x32_bf16 v[52:55], v[80:83], a[128:131], v[52:55]
    s_waitcnt vmcnt(18) lgkmcnt(5)
    v_mfma_f32_16x16x32_bf16 v[0:3], v[84:87], a[60:63], v[0:3]
    ds_read_b128 v[56:59], v178 offset:50176
    v_mfma_f32_16x16x32_bf16 v[4:7], v[84:87], a[132:135], v[4:7]
    v_mfma_f32_16x16x32_bf16 v[8:11], v[88:91], a[60:63], v[8:11]
    ds_read_b128 v[60:63], v178 offset:51200
    v_mfma_f32_16x16x32_bf16 v[12:15], v[88:91], a[132:135], v[12:15]
    s_add_u32 m0, s89, 36864
    s_add_u32 s98, s11, 36864
    buffer_load_dwordx4 v254, s[24:27], s98 offen lds
    s_waitcnt lgkmcnt(5)
    v_mfma_f32_16x16x32_bf16 v[16:19], v[92:95], a[60:63], v[16:19]
    ds_read_b128 v[64:67], v178 offset:52224
    v_mfma_f32_16x16x32_bf16 v[20:23], v[92:95], a[132:135], v[20:23]
    v_mfma_f32_16x16x32_bf16 v[24:27], v[96:99], a[60:63], v[24:27]
    ds_read_b128 v[68:71], v178 offset:53248
    v_mfma_f32_16x16x32_bf16 v[28:31], v[96:99], a[132:135], v[28:31]
    s_add_u32 m0, s89, 40960
    s_add_u32 s98, s11, 40960
    buffer_load_dwordx4 v254, s[24:27], s98 offen lds
    s_waitcnt lgkmcnt(5)
    v_mfma_f32_16x16x32_bf16 v[32:35], v[100:103], a[60:63], v[32:35]
    ds_read_b128 v[72:75], v178 offset:54272
    v_mfma_f32_16x16x32_bf16 v[36:39], v[100:103], a[132:135], v[36:39]
    v_mfma_f32_16x16x32_bf16 v[40:43], v[104:107], a[60:63], v[40:43]
    ds_read_b128 v[76:79], v178 offset:55296
    v_mfma_f32_16x16x32_bf16 v[44:47], v[104:107], a[132:135], v[44:47]
    s_add_u32 m0, s89, 45056
    s_add_u32 s98, s11, 45056
    buffer_load_dwordx4 v254, s[24:27], s98 offen lds
    s_waitcnt lgkmcnt(6)
    v_mfma_f32_16x16x32_bf16 v[48:51], v[108:111], a[60:63], v[48:51]
    ds_read_b128 v[80:83], v178 offset:56320
    v_mfma_f32_16x16x32_bf16 v[52:55], v[108:111], a[132:135], v[52:55]
    s_waitcnt vmcnt(19) lgkmcnt(5)
    v_mfma_f32_16x16x32_bf16 v[0:3], v[56:59], a[64:67], v[0:3]
    ds_read_b128 v[84:87], v178 offset:57344
    v_mfma_f32_16x16x32_bf16 v[4:7], v[56:59], a[136:139], v[4:7]
    v_mfma_f32_16x16x32_bf16 v[8:11], v[60:63], a[64:67], v[8:11]
    ds_read_b128 v[88:91], v178 offset:58368
    v_mfma_f32_16x16x32_bf16 v[12:15], v[60:63], a[136:139], v[12:15]
    s_add_u32 m0, s89, 49152
    s_add_u32 s98, s11, 49152
    buffer_load_dwordx4 v254, s[24:27], s98 offen lds
    s_waitcnt lgkmcnt(5)
    v_mfma_f32_16x16x32_bf16 v[16:19], v[64:67], a[64:67], v[16:19]
    ds_read_b128 v[92:95], v178 offset:59392
    v_mfma_f32_16x16x32_bf16 v[20:23], v[64:67], a[136:139], v[20:23]
    v_mfma_f32_16x16x32_bf16 v[24:27], v[68:71], a[64:67], v[24:27]
    ds_read_b128 v[96:99], v178 offset:60416
    v_mfma_f32_16x16x32_bf16 v[28:31], v[68:71], a[136:139], v[28:31]
    s_add_u32 m0, s89, 53248
    s_add_u32 s98, s11, 53248
    buffer_load_dwordx4 v254, s[24:27], s98 offen lds
    s_waitcnt lgkmcnt(5)
    v_mfma_f32_16x16x32_bf16 v[32:35], v[72:75], a[64:67], v[32:35]
    ds_read_b128 v[100:103], v178 offset:61440
    v_mfma_f32_16x16x32_bf16 v[36:39], v[72:75], a[136:139], v[36:39]
    v_mfma_f32_16x16x32_bf16 v[40:43], v[76:79], a[64:67], v[40:43]
    ds_read_b128 v[104:107], v178 offset:62464
    v_mfma_f32_16x16x32_bf16 v[44:47], v[76:79], a[136:139], v[44:47]
    s_add_u32 m0, s89, 57344
    s_add_u32 s98, s11, 57344
    buffer_load_dwordx4 v254, s[24:27], s98 offen lds
    s_waitcnt lgkmcnt(6)
    v_mfma_f32_16x16x32_bf16 v[48:51], v[80:83], a[64:67], v[48:51]
    ds_read_b128 v[108:111], v178 offset:63488
    v_mfma_f32_16x16x32_bf16 v[52:55], v[80:83], a[136:139], v[52:55]
    s_waitcnt vmcnt(20) lgkmcnt(5)
    v_mfma_f32_16x16x32_bf16 v[0:3], v[84:87], a[68:71], v[0:3]
    v_mfma_f32_16x16x32_bf16 v[4:7], v[84:87], a[140:143], v[4:7]
    v_mfma_f32_16x16x32_bf16 v[8:11], v[88:91], a[68:71], v[8:11]
    v_mfma_f32_16x16x32_bf16 v[12:15], v[88:91], a[140:143], v[12:15]
    s_add_u32 m0, s89, 61440
    s_add_u32 s98, s11, 61440
    buffer_load_dwordx4 v254, s[24:27], s98 offen lds
    s_waitcnt lgkmcnt(3)
    v_mfma_f32_16x16x32_bf16 v[16:19], v[92:95], a[68:71], v[16:19]
    v_mfma_f32_16x16x32_bf16 v[20:23], v[92:95], a[140:143], v[20:23]
    v_mfma_f32_16x16x32_bf16 v[24:27], v[96:99], a[68:71], v[24:27]
    v_mfma_f32_16x16x32_bf16 v[28:31], v[96:99], a[140:143], v[28:31]
    s_add_u32 m0, s89, 65536
    s_add_u32 s98, s11, 65536
    buffer_load_dwordx4 v254, s[24:27], s98 offen lds
    s_waitcnt lgkmcnt(1)
    v_mfma_f32_16x16x32_bf16 v[32:35], v[100:103], a[68:71], v[32:35]
    v_mfma_f32_16x16x32_bf16 v[36:39], v[100:103], a[140:143], v[36:39]
    v_mfma_f32_16x16x32_bf16 v[40:43], v[104:107], a[68:71], v[40:43]
    v_mfma_f32_16x16x32_bf16 v[44:47], v[104:107], a[140:143], v[44:47]
    s_add_u32 m0, s89, 69632
    s_add_u32 s98, s11, 69632
    buffer_load_dwordx4 v254, s[24:27], s98 offen lds
    s_waitcnt lgkmcnt(0)
    v_mfma_f32_16x16x32_bf16 v[48:51], v[108:111], a[68:71], v[48:51]
    v_mfma_f32_16x16x32_bf16 v[52:55], v[108:111], a[140:143], v[52:55]
Lnoxj_47:
    s_nop 0
    s_waitcnt lgkmcnt(0)
    s_barrier
    v_lshlrev_b32 v148, 4, v199
    v_add_u32 v148, 162944, v148
    ds_read_b128 v[64:67], v148 offset:128
    ds_read_b128 v[68:71], v148 offset:192
    ds_read_b128 v[72:75], v148 offset:256
    ds_read_b128 v[76:79], v148 offset:320
    ds_read_b128 v[80:83], v148 offset:384
    s_waitcnt lgkmcnt(4)
    v_pk_fma_f32 v[16:17], v[64:65], v[120:121], v[16:17] op_sel_hi:[1,0,1]
    v_pk_mul_f32 v[16:17], v[16:17], v[126:127] op_sel_hi:[1,0]
    v_pk_fma_f32 v[18:19], v[66:67], v[120:121], v[18:19] op_sel_hi:[1,0,1]
    v_pk_mul_f32 v[18:19], v[18:19], v[126:127] op_sel_hi:[1,0]
    v_pk_fma_f32 v[20:21], v[64:65], v[122:123], v[20:21] op_sel_hi:[1,0,1]
    v_pk_mul_f32 v[20:21], v[20:21], v[128:129] op_sel_hi:[1,0]
    v_pk_fma_f32 v[22:23], v[66:67], v[122:123], v[22:23] op_sel_hi:[1,0,1]
    v_pk_mul_f32 v[22:23], v[22:23], v[128:129] op_sel_hi:[1,0]
    s_waitcnt lgkmcnt(3)
    v_pk_fma_f32 v[24:25], v[68:69], v[120:121], v[24:25] op_sel_hi:[1,0,1]
    v_pk_mul_f32 v[24:25], v[24:25], v[126:127] op_sel_hi:[1,0]
    v_pk_fma_f32 v[26:27], v[70:71], v[120:121], v[26:27] op_sel_hi:[1,0,1]
    v_pk_mul_f32 v[26:27], v[26:27], v[126:127] op_sel_hi:[1,0]
    v_pk_fma_f32 v[28:29], v[68:69], v[122:123], v[28:29] op_sel_hi:[1,0,1]
    v_pk_mul_f32 v[28:29], v[28:29], v[128:129] op_sel_hi:[1,0]
    v_pk_fma_f32 v[30:31], v[70:71], v[122:123], v[30:31] op_sel_hi:[1,0,1]
    v_pk_mul_f32 v[30:31], v[30:31], v[128:129] op_sel_hi:[1,0]
    s_cmp_eq_u32 s44, 3
    s_cbranch_scc0 Lpf_48
    s_getpc_b64 s[84:85]
Lpf_48_pc:
    s_sub_u32 s84, s84, Lpf_48_pc-interleave_layers__sliding_local_dilated__linear_kernel_hedgehog__prompt_kernel
    s_subb_u32 s85, s85, 0
    s_lshr_b32 s86, s2, 3
    s_and_b32 s86, s86, 31
    s_lshl_b32 s86, s86, 10
    v_add_u32 v140, s86, v254
    v_min_u32 v140, L_EXIT-(L_PF2)-16, v140
    v_add_u32 v140, L_PF2-interleave_layers__sliding_local_dilated__linear_kernel_hedgehog__prompt_kernel, v140
    v_mov_b32 v141, s85
    v_add_co_u32 v140, vcc, s84, v140
    s_nop 1
    v_addc_co_u32 v141, vcc, 0, v141, vcc
    global_load_dwordx4 a[252:255], v[140:141], off
Lpf_48:
    s_waitcnt lgkmcnt(2)
    v_pk_fma_f32 v[32:33], v[72:73], v[120:121], v[32:33] op_sel_hi:[1,0,1]
    v_pk_mul_f32 v[32:33], v[32:33], v[126:127] op_sel_hi:[1,0]
    v_pk_fma_f32 v[34:35], v[74:75], v[120:121], v[34:35] op_sel_hi:[1,0,1]
    v_pk_mul_f32 v[34:35], v[34:35], v[126:127] op_sel_hi:[1,0]
    v_pk_fma_f32 v[36:37], v[72:73], v[122:123], v[36:37] op_sel_hi:[1,0,1]
    v_pk_mul_f32 v[36:37], v[36:37], v[128:129] op_sel_hi:[1,0]
    v_pk_fma_f32 v[38:39], v[74:75], v[122:123], v[38:39] op_sel_hi:[1,0,1]
    v_pk_mul_f32 v[38:39], v[38:39], v[128:129] op_sel_hi:[1,0]
    s_waitcnt lgkmcnt(1)
    v_pk_fma_f32 v[40:41], v[76:77], v[120:121], v[40:41] op_sel_hi:[1,0,1]
    v_pk_mul_f32 v[40:41], v[40:41], v[126:127] op_sel_hi:[1,0]
    v_pk_fma_f32 v[42:43], v[78:79], v[120:121], v[42:43] op_sel_hi:[1,0,1]
    v_pk_mul_f32 v[42:43], v[42:43], v[126:127] op_sel_hi:[1,0]
    v_pk_fma_f32 v[44:45], v[76:77], v[122:123], v[44:45] op_sel_hi:[1,0,1]
    v_pk_mul_f32 v[44:45], v[44:45], v[128:129] op_sel_hi:[1,0]
    v_pk_fma_f32 v[46:47], v[78:79], v[122:123], v[46:47] op_sel_hi:[1,0,1]
    v_pk_mul_f32 v[46:47], v[46:47], v[128:129] op_sel_hi:[1,0]
    s_add_u32 m0, s89, 73728
    s_add_u32 s98, s11, 73728
    buffer_load_dwordx4 v254, s[24:27], s98 offen lds
    s_waitcnt lgkmcnt(0)
    v_pk_fma_f32 v[48:49], v[80:81], v[120:121], v[48:49] op_sel_hi:[1,0,1]
    v_pk_mul_f32 v[48:49], v[48:49], v[126:127] op_sel_hi:[1,0]
    v_pk_fma_f32 v[50:51], v[82:83], v[120:121], v[50:51] op_sel_hi:[1,0,1]
    v_pk_mul_f32 v[50:51], v[50:51], v[126:127] op_sel_hi:[1,0]
    v_pk_fma_f32 v[52:53], v[80:81], v[122:123], v[52:53] op_sel_hi:[1,0,1]
    v_pk_mul_f32 v[52:53], v[52:53], v[128:129] op_sel_hi:[1,0]
    v_pk_fma_f32 v[54:55], v[82:83], v[122:123], v[54:55] op_sel_hi:[1,0,1]
    v_pk_mul_f32 v[54:55], v[54:55], v[128:129] op_sel_hi:[1,0]
L_PF2:
    v_cvt_pk_bf16_f32 v62, v16, v17
    v_cvt_pk_bf16_f32 v63, v18, v19
    v_cvt_pk_bf16_f32 v66, v24, v25
    v_cvt_pk_bf16_f32 v67, v26, v27
    v_cvt_pk_bf16_f32 v68, v32, v33
    v_cvt_pk_bf16_f32 v69, v34, v35
    v_cvt_pk_bf16_f32 v70, v40, v41
    v_cvt_pk_bf16_f32 v71, v42, v43
    v_cvt_pk_bf16_f32 v64, v48, v49
    v_cvt_pk_bf16_f32 v65, v50, v51
    v_mov_b32 v72, s76
    v_mov_b32 v73, s76
    s_not_b64 s[60:61], s[74:75]
    v_cndmask_b32 v72, v72, v64, s[60:61]
    v_cndmask_b32 v73, v73, v65, s[60:61]
    ds_write_b64 v229, v[68:69] offset:144
    ds_write_b64 v229, v[70:71] offset:176
    ds_write_b64 v229, v[72:73] offset:208
    s_add_u32 m0, s89, 77824
    s_add_u32 s98, s11, 77824
    buffer_load_dwordx4 v254, s[24:27], s98 offen lds
    v_cvt_pk_bf16_f32 v80, v20, v21
    v_cvt_pk_bf16_f32 v81, v22, v23
    v_cvt_pk_bf16_f32 v84, v28, v29
    v_cvt_pk_bf16_f32 v85, v30, v31
    v_cvt_pk_bf16_f32 v86, v36, v37
    v_cvt_pk_bf16_f32 v87, v38, v39
    v_cvt_pk_bf16_f32 v88, v44, v45
    v_cvt_pk_bf16_f32 v89, v46, v47
    v_cvt_pk_bf16_f32 v82, v52, v53
    v_cvt_pk_bf16_f32 v83, v54, v55
    v_mov_b32 v90, s76
    v_mov_b32 v91, s76
    s_not_b64 s[60:61], s[74:75]
    v_cndmask_b32 v90, v90, v82, s[60:61]
    v_cndmask_b32 v91, v91, v83, s[60:61]
    ds_write_b64 v229, v[86:87] offset:4112
    ds_write_b64 v229, v[88:89] offset:4144
    ds_write_b64 v229, v[90:91] offset:4176
    s_mov_b32 m0, s93
    s_add_u32 s98, s11, s14
    buffer_load_dwordx4 v254, s[24:27], s98 offen lds
    v_mov_b32 v16, v64
    v_mov_b32 v17, v65
    v_mov_b32 v18, v82
    v_mov_b32 v19, v83
    v_mfma_f32_16x16x32_bf16 v[20:23], a[224:227], v[62:65], 0
    v_mfma_f32_16x16x32_bf16 v[36:39], a[236:239], v[62:65], 0
    v_mfma_f32_16x16x32_bf16 v[24:27], a[228:231], v[64:67], 0
    v_mfma_f32_16x16x32_bf16 v[36:39], a[240:243], v[64:67], v[36:39]
    v_mfma_f32_16x16x32_bf16 v[28:31], a[224:227], v[80:83], 0
    v_mfma_f32_16x16x32_bf16 v[36:39], a[244:247], v[80:83], v[36:39]
    v_mfma_f32_16x16x32_bf16 v[32:35], a[228:231], v[82:85], 0
    v_mfma_f32_16x16x32_bf16 v[36:39], a[248:251], v[82:85], v[36:39]
    s_nop 0
    v_max3_f32 v132, v20, v21, v22
    v_max_f32 v132, v132, v23
    v_min3_f32 v136, v20, v21, v22
    v_min_f32 v136, v136, v23
    v_max3_f32 v133, v24, v25, v26
    v_max_f32 v133, v133, v27
    v_min3_f32 v137, v24, v25, v26
    v_min_f32 v137, v137, v27
    v_max3_f32 v134, v28, v29, v30
    v_max_f32 v134, v134, v31
    v_min3_f32 v138, v28, v29, v30
    v_min_f32 v138, v138, v31
    v_max3_f32 v135, v32, v33, v34
    v_max_f32 v135, v135, v35
    v_min3_f32 v139, v32, v33, v34
    v_min_f32 v139, v139, v35
    v_permlane16_swap_b32 v132, v133
    v_permlane16_swap_b32 v134, v135
    v_max_f32 v132, v132, v133
    v_max_f32 v134, v134, v135
    s_nop 1
    v_permlane32_swap_b32 v132, v134
    v_max_f32 v132, v132, v134
    v_permlane16_swap_b32 v136, v137
    v_permlane16_swap_b32 v138, v139
    v_min_f32 v136, v136, v137
    v_min_f32 v138, v138, v139
    s_nop 1
    v_permlane32_swap_b32 v136, v138
    v_min_f32 v136, v136, v138
    v_max3_f32 v132, v132, v36, v37
    v_min3_f32 v136, v136, v36, v37
    v_mul_f32 v132, s78, v132
    v_mul_f32 v136, s78, v136
    v_sub_f32 v132, 0, v132
    s_add_u32 s84, s8, 20480
    buffer_load_dwordx4 a[164:167], v254, s[4:7], s84 offen
    v_mov_b32 v140, v132
    v_mov_b32 v142, v132
    s_nop 1
    v_permlane16_swap_b32 v140, v142
    v_mov_b32 v144, v140
    v_mov_b32 v146, v142
    s_nop 0
    v_permlane32_swap_b32 v140, v144
    v_permlane32_swap_b32 v142, v146
    v_mov_b32 v148, v136
    v_mov_b32 v150, v136
    s_nop 1
    v_permlane16_swap_b32 v148, v150
    v_mov_b32 v152, v148
    v_mov_b32 v154, v150
    s_nop 0
    v_permlane32_swap_b32 v148, v152
    v_permlane32_swap_b32 v150, v154
    v_pk_fma_f32 v[156:157], v[20:21], s[78:79], v[148:149] op_sel_hi:[1,1,0] neg_lo:[1,0,0] neg_hi:[1,0,0]
    v_pk_fma_f32 v[20:21], v[20:21], s[78:79], v[140:141] op_sel_hi:[1,1,0]
    v_pk_fma_f32 v[158:159], v[22:23], s[78:79], v[148:149] op_sel_hi:[1,1,0] neg_lo:[1,0,0] neg_hi:[1,0,0]
    v_pk_fma_f32 v[22:23], v[22:23], s[78:79], v[140:141] op_sel_hi:[1,1,0]
    v_pk_fma_f32 v[160:161], v[24:25], s[78:79], v[150:151] op_sel_hi:[1,1,0] neg_lo:[1,0,0] neg_hi:[1,0,0]
    v_pk_fma_f32 v[24:25], v[24:25], s[78:79], v[142:143] op_sel_hi:[1,1,0]
    v_pk_fma_f32 v[162:163], v[26:27], s[78:79], v[150:151] op_sel_hi:[1,1,0] neg_lo:[1,0,0] neg_hi:[1,0,0]
    v_pk_fma_f32 v[26:27], v[26:27], s[78:79], v[142:143] op_sel_hi:[1,1,0]
    v_pk_fma_f32 v[164:165], v[28:29], s[78:79], v[152:153] op_sel_hi:[1,1,0] neg_lo:[1,0,0] neg_hi:[1,0,0]
    v_pk_fma_f32 v[28:29], v[28:29], s[78:79], v[144:145] op_sel_hi:[1,1,0]
    v_pk_fma_f32 v[166:167], v[30:31], s[78:79], v[152:153] op_sel_hi:[1,1,0] neg_lo:[1,0,0] neg_hi:[1,0,0]
    v_pk_fma_f32 v[30:31], v[30:31], s[78:79], v[144:145] op_sel_hi:[1,1,0]
    v_pk_fma_f32 v[168:169], v[32:33], s[78:79], v[154:155] op_sel_hi:[1,1,0] neg_lo:[1,0,0] neg_hi:[1,0,0]
    v_pk_fma_f32 v[32:33], v[32:33], s[78:79], v[146:147] op_sel_hi:[1,1,0]
    v_pk_fma_f32 v[170:171], v[34:35], s[78:79], v[154:155] op_sel_hi:[1,1,0] neg_lo:[1,0,0] neg_hi:[1,0,0]
    v_pk_fma_f32 v[34:35], v[34:35], s[78:79], v[146:147] op_sel_hi:[1,1,0]
    v_fma_f32 v38, -v36, s78, v136
    v_fma_f32 v39, -v37, s78, v136
    v_fma_f32 v36, v36, s78, v132
    v_fma_f32 v37, v37, s78, v132
    v_exp_f32 v20, v20
    v_exp_f32 v156, v156
    v_exp_f32 v21, v21
    v_exp_f32 v157, v157
    s_add_u32 s84, s8, 24576
    buffer_load_dwordx4 a[168:171], v254, s[4:7], s84 offen
    v_exp_f32 v22, v22
    v_exp_f32 v158, v158
    v_exp_f32 v23, v23
    v_exp_f32 v159, v159
    s_add_u32 s84, s8, 28672
    buffer_load_dwordx4 a[172:175], v254, s[4:7], s84 offen
    v_exp_f32 v24, v24
    v_exp_f32 v160, v160
    v_exp_f32 v25, v25
    v_exp_f32 v161, v161
    s_add_u32 s84, s8, 32768
    buffer_load_dwordx4 a[176:179], v254, s[4:7], s84 offen
    v_exp_f32 v26, v26
    v_exp_f32 v162, v162
    v_exp_f32 v27, v27
    v_exp_f32 v163, v163
    s_add_u32 s84, s8, 36864
    buffer_load_dwordx4 a[180:183], v254, s[4:7], s84 offen
    v_exp_f32 v28, v28
    v_exp_f32 v164, v164
    v_exp_f32 v29, v29
    v_exp_f32 v165, v165
    s_add_u32 s84, s8, 40960
    buffer_load_dwordx4 a[184:187], v254, s[4:7], s84 offen
    v_exp_f32 v30, v30
    v_exp_f32 v166, v166
    v_exp_f32 v31, v31
    v_exp_f32 v167, v167
    s_add_u32 s84, s8, 45056
    buffer_load_dwordx4 a[188:191], v254, s[4:7], s84 offen
    v_exp_f32 v32, v32
    v_exp_f32 v168, v168
    v_exp_f32 v33, v33
    v_exp_f32 v169, v169
    s_add_u32 s84, s8, 49152
    buffer_load_dwordx4 a[192:195], v254, s[4:7], s84 offen
    v_exp_f32 v34, v34
    v_exp_f32 v170, v170
    v_exp_f32 v35, v35
    v_exp_f32 v171, v171
    s_add_u32 s84, s8, 53248
    buffer_load_dwordx4 a[196:199], v254, s[4:7], s84 offen
    v_exp_f32 v36, v36
    v_exp_f32 v37, v37
    v_exp_f32 v38, v38
    v_exp_f32 v39, v39
    v_pk_add_f32 v[140:141], v[20:21], v[22:23]
    v_pk_add_f32 v[148:149], v[156:157], v[158:159]
    v_pk_add_f32 v[142:143], v[24:25], v[26:27]
    v_pk_add_f32 v[150:151], v[160:161], v[162:163]
    v_pk_add_f32 v[144:145], v[28:29], v[30:31]
    v_pk_add_f32 v[152:153], v[164:165], v[166:167]
    v_pk_add_f32 v[146:147], v[32:33], v[34:35]
    v_pk_add_f32 v[154:155], v[168:169], v[170:171]
    v_add_f32 v132, v140, v141
    v_add_f32 v136, v148, v149
    v_add_f32 v133, v142, v143
    v_add_f32 v137, v150, v151
    v_add_f32 v134, v144, v145
    v_add_f32 v138, v152, v153
    v_add_f32 v135, v146, v147
    v_add_f32 v139, v154, v155
    v_permlane16_swap_b32 v132, v133
    v_permlane16_swap_b32 v134, v135
    v_add_f32 v132, v132, v133
    v_add_f32 v134, v134, v135
    s_nop 1
    v_permlane32_swap_b32 v132, v134
    v_add_f32 v132, v132, v134
    v_permlane16_swap_b32 v136, v137
    v_permlane16_swap_b32 v138, v139
    v_add_f32 v136, v136, v137
    v_add_f32 v138, v138, v139
    s_nop 1
    v_permlane32_swap_b32 v136, v138
    v_add_f32 v136, v136, v138
    v_add_f32 v132, v132, v36
    v_add_f32 v136, v136, v38
    v_add_f32 v132, v132, v37
    v_add_f32 v136, v136, v39
    v_rcp_f32 v132, v132
    v_rcp_f32 v136, v136
    v_mov_b32 v140, v132
    v_mov_b32 v142, v132
    s_nop 1
    v_permlane16_swap_b32 v140, v142
    v_mov_b32 v144, v140
    v_mov_b32 v146, v142
    s_nop 0
    v_permlane32_swap_b32 v140, v144
    v_permlane32_swap_b32 v142, v146
    v_mov_b32 v148, v136
    v_mov_b32 v150, v136
    s_nop 1
    v_permlane16_swap_b32 v148, v150
    v_mov_b32 v152, v148
    v_mov_b32 v154, v150
    s_nop 0
    v_permlane32_swap_b32 v148, v152
    v_permlane32_swap_b32 v150, v154
    v_mul_f32 v36, v36, v132
    v_mul_f32 v37, v37, v132
    v_mul_f32 v38, v38, v136
    v_mul_f32 v39, v39, v136
    v_cvt_pk_bf16_f32 v72, v36, v37
    v_cvt_pk_bf16_f32 v73, v38, v39
    v_pk_mul_f32 v[20:21], v[20:21], v[140:141] op_sel_hi:[1,0]
    v_pk_mul_f32 v[22:23], v[22:23], v[140:141] op_sel_hi:[1,0]
    v_pk_mul_f32 v[156:157], v[156:157], v[148:149] op_sel_hi:[1,0]
    v_pk_mul_f32 v[158:159], v[158:159], v[148:149] op_sel_hi:[1,0]
    v_cvt_pk_bf16_f32 v56, v20, v21
    v_cvt_pk_bf16_f32 v57, v22, v23
    v_cvt_pk_bf16_f32 v58, v156, v157
    v_cvt_pk_bf16_f32 v59, v158, v159
    v_pk_mul_f32 v[24:25], v[24:25], v[142:143] op_sel_hi:[1,0]
    v_pk_mul_f32 v[26:27], v[26:27], v[142:143] op_sel_hi:[1,0]
    v_pk_mul_f32 v[160:161], v[160:161], v[150:151] op_sel_hi:[1,0]
    v_pk_mul_f32 v[162:163], v[162:163], v[150:151] op_sel_hi:[1,0]
    v_cvt_pk_bf16_f32 v60, v24, v25
    v_cvt_pk_bf16_f32 v61, v26, v27
    v_cvt_pk_bf16_f32 v62, v160, v161
    v_cvt_pk_bf16_f32 v63, v162, v163
    v_pk_mul_f32 v[28:29], v[28:29], v[144:145] op_sel_hi:[1,0]
    v_pk_mul_f32 v[30:31], v[30:31], v[144:145] op_sel_hi:[1,0]
    v_pk_mul_f32 v[164:165], v[164:165], v[152:153] op_sel_hi:[1,0]
    v_pk_mul_f32 v[166:167], v[166:167], v[152:153] op_sel_hi:[1,0]
    v_cvt_pk_bf16_f32 v64, v28, v29
    v_cvt_pk_bf16_f32 v65, v30, v31
    v_cvt_pk_bf16_f32 v66, v164, v165
    v_cvt_pk_bf16_f32 v67, v166, v167
    v_pk_mul_f32 v[32:33], v[32:33], v[146:147] op_sel_hi:[1,0]
    v_pk_mul_f32 v[34:35], v[34:35], v[146:147] op_sel_hi:[1,0]
    v_pk_mul_f32 v[168:169], v[168:169], v[154:155] op_sel_hi:[1,0]
    v_pk_mul_f32 v[170:171], v[170:171], v[154:155] op_sel_hi:[1,0]
    v_cvt_pk_bf16_f32 v68, v32, v33
    v_cvt_pk_bf16_f32 v69, v34, v35
    v_cvt_pk_bf16_f32 v70, v168, v169
    v_cvt_pk_bf16_f32 v71, v170, v171
    ds_write_b64 v229, v[56:57] offset:0
    ds_write_b64 v229, v[58:59] offset:32
    ds_write_b64 v229, v[60:61] offset:64
    ds_write_b64 v229, v[62:63] offset:96
    ds_write_b64 v229, v[64:65] offset:3968
    ds_write_b64 v229, v[66:67] offset:4000
    ds_write_b64 v229, v[68:69] offset:4032
    ds_write_b64 v229, v[70:71] offset:4064
    ds_write_b64 v230, v[72:73]
    s_waitcnt lgkmcnt(0)
    s_barrier
    ds_read_b64_tr_b16 v[20:21], v248 offset:0
    ds_read_b64_tr_b16 v[24:25], v248 offset:32
    ds_read_b64_tr_b16 v[28:29], v249 offset:0
    ds_read_b64_tr_b16 v[32:33], v250 offset:0
    ds_read_b64_tr_b16 v[22:23], v248 offset:248
    ds_read_b64_tr_b16 v[26:27], v248 offset:280
    ds_read_b64_tr_b16 v[30:31], v249 offset:248
    ds_read_b64_tr_b16 v[34:35], v250 offset:248
    ds_read_b64_tr_b16 v[40:41], v248 offset:7936
    ds_read_b64_tr_b16 v[44:45], v248 offset:7968
    ds_read_b64_tr_b16 v[48:49], v249 offset:7936
    ds_read_b64_tr_b16 v[52:53], v250 offset:7936
    ds_read_b64_tr_b16 v[42:43], v248 offset:8184
    ds_read_b64_tr_b16 v[46:47], v248 offset:8216
    ds_read_b64_tr_b16 v[50:51], v249 offset:8184
    ds_read_b64_tr_b16 v[54:55], v250 offset:8184
    s_waitcnt lgkmcnt(8)
    v_mfma_f32_16x16x32_bf16 v[64:67], v[20:23], v[32:35], 0
    v_mfma_f32_16x16x32_bf16 v[68:71], v[24:27], v[32:35], 0
    v_mfma_f32_16x16x32_bf16 v[72:75], v[28:31], v[32:35], 0
    ds_read_b64_tr_b16 v[20:21], v248 offset:15872
    ds_read_b64_tr_b16 v[24:25], v248 offset:15904
    ds_read_b64_tr_b16 v[28:29], v249 offset:15872
    ds_read_b64_tr_b16 v[32:33], v250 offset:15872
    ds_read_b64_tr_b16 v[22:23], v248 offset:16120
    ds_read_b64_tr_b16 v[26:27], v248 offset:16152
    ds_read_b64_tr_b16 v[30:31], v249 offset:16120
    ds_read_b64_tr_b16 v[34:35], v250 offset:16120
    s_waitcnt lgkmcnt(8)
    v_mfma_f32_16x16x32_bf16 v[64:67], v[40:43], v[52:55], v[64:67]
    v_mfma_f32_16x16x32_bf16 v[68:71], v[44:47], v[52:55], v[68:71]
    v_mfma_f32_16x16x32_bf16 v[72:75], v[48:51], v[52:55], v[72:75]
    ds_read_b64_tr_b16 v[40:41], v248 offset:23808
    ds_read_b64_tr_b16 v[44:45], v248 offset:23840
    ds_read_b64_tr_b16 v[48:49], v249 offset:23808
    ds_read_b64_tr_b16 v[52:53], v250 offset:23808
    ds_read_b64_tr_b16 v[42:43], v248 offset:24056
    ds_read_b64_tr_b16 v[46:47], v248 offset:24088
    ds_read_b64_tr_b16 v[50:51], v249 offset:24056
    ds_read_b64_tr_b16 v[54:55], v250 offset:24056
    s_waitcnt lgkmcnt(8)
    v_mfma_f32_16x16x32_bf16 v[64:67], v[20:23], v[32:35], v[64:67]
    v_mfma_f32_16x16x32_bf16 v[68:71], v[24:27], v[32:35], v[68:71]
    v_mfma_f32_16x16x32_bf16 v[72:75], v[28:31], v[32:35], v[72:75]
    s_waitcnt lgkmcnt(0)
    v_mfma_f32_16x16x32_bf16 v[64:67], v[40:43], v[52:55], v[64:67]
    v_mfma_f32_16x16x32_bf16 v[68:71], v[44:47], v[52:55], v[68:71]
    v_mfma_f32_16x16x32_bf16 v[72:75], v[48:51], v[52:55], v[72:75]
    s_nop 5
    v_cvt_pk_bf16_f32 v148, v64, v65
    v_cvt_pk_bf16_f32 v149, v66, v67
    v_cvt_pk_bf16_f32 v150, v68, v69
    v_cvt_pk_bf16_f32 v151, v70, v71
    v_cvt_pk_bf16_f32 v152, v72, v73
    v_cvt_pk_bf16_f32 v153, v74, v75
    s_mul_i32 s56, s45, 3072
    s_add_u32 s56, s56, s83
    buffer_store_dwordx4 v[148:151], v251, s[24:27], s56 offen sc1
    buffer_store_dwordx2 v[152:153], v253, s[24:27], s56 offen sc1
    s_waitcnt vmcnt(0)
    s_barrier
    s_cmp_eq_u32 s44, 0
    s_cbranch_scc0 Lw0_49
    s_lshl_b32 s58, s47, 3
    s_add_u32 s58, s58, s48
    s_add_u32 s58, s58, 3
    s_not_b32 s59, s58
    s_xor_b32 s59, s59, s42
    v_mov_b32 v172, s58
    v_mov_b32 v173, s59
    s_mov_b64 exec, 1
    buffer_store_dwordx2 v[172:173], v255, s[24:27], s53 offen sc1
    s_mov_b64 exec, -1
Lw0_49:
    s_nop 0
    v_lshlrev_b32 v148, 4, v199
    v_add_u32 v148, 162944, v148
    ds_read_b128 v[56:59], v148 offset:0
    ds_read_b128 v[60:63], v148 offset:64
    s_waitcnt lgkmcnt(1)
    v_pk_fma_f32 v[0:1], v[56:57], v[120:121], v[0:1] op_sel_hi:[1,0,1]
    v_pk_mul_f32 v[0:1], v[0:1], v[126:127] op_sel_hi:[1,0]
    v_pk_fma_f32 v[2:3], v[58:59], v[120:121], v[2:3] op_sel_hi:[1,0,1]
    v_pk_mul_f32 v[2:3], v[2:3], v[126:127] op_sel_hi:[1,0]
    v_pk_fma_f32 v[4:5], v[56:57], v[122:123], v[4:5] op_sel_hi:[1,0,1]
    v_pk_mul_f32 v[4:5], v[4:5], v[128:129] op_sel_hi:[1,0]
    v_pk_fma_f32 v[6:7], v[58:59], v[122:123], v[6:7] op_sel_hi:[1,0,1]
    v_pk_mul_f32 v[6:7], v[6:7], v[128:129] op_sel_hi:[1,0]
    s_waitcnt lgkmcnt(0)
    v_pk_fma_f32 v[8:9], v[60:61], v[120:121], v[8:9] op_sel_hi:[1,0,1]
    v_pk_mul_f32 v[8:9], v[8:9], v[126:127] op_sel_hi:[1,0]
    v_pk_fma_f32 v[10:11], v[62:63], v[120:121], v[10:11] op_sel_hi:[1,0,1]
    v_pk_mul_f32 v[10:11], v[10:11], v[126:127] op_sel_hi:[1,0]
    v_pk_fma_f32 v[12:13], v[60:61], v[122:123], v[12:13] op_sel_hi:[1,0,1]
    v_pk_mul_f32 v[12:13], v[12:13], v[128:129] op_sel_hi:[1,0]
    v_pk_fma_f32 v[14:15], v[62:63], v[122:123], v[14:15] op_sel_hi:[1,0,1]
    v_pk_mul_f32 v[14:15], v[14:15], v[128:129] op_sel_hi:[1,0]
    s_add_u32 s84, s8, 57344
    buffer_load_dwordx4 a[200:203], v254, s[4:7], s84 offen
    v_cvt_pk_bf16_f32 v20, v0, v1
    v_cvt_pk_bf16_f32 v21, v2, v3
    v_cvt_pk_bf16_f32 v24, v8, v9
    v_cvt_pk_bf16_f32 v25, v10, v11
    v_mov_b32 v22, v16
    v_mov_b32 v23, v17
    v_cvt_pk_bf16_f32 v26, v4, v5
    v_cvt_pk_bf16_f32 v27, v6, v7
    v_cvt_pk_bf16_f32 v30, v12, v13
    v_cvt_pk_bf16_f32 v31, v14, v15
    v_mov_b32 v28, v18
    v_mov_b32 v29, v19
    v_mfma_f32_16x16x32_bf16 v[0:3], a[216:219], v[20:23], 0
    v_mfma_f32_16x16x32_bf16 v[32:35], v[232:235], v[20:23], 0
    v_mfma_f32_16x16x32_bf16 v[4:7], a[220:223], v[22:25], 0
    v_mfma_f32_16x16x32_bf16 v[32:35], v[236:239], v[22:25], v[32:35]
    v_mfma_f32_16x16x32_bf16 v[8:11], a[216:219], v[26:29], 0
    v_mfma_f32_16x16x32_bf16 v[32:35], v[240:243], v[26:29], v[32:35]
    v_mfma_f32_16x16x32_bf16 v[12:15], a[220:223], v[28:31], 0
    v_mfma_f32_16x16x32_bf16 v[32:35], v[244:247], v[28:31], v[32:35]
    s_nop 0
    v_max3_f32 v132, v0, v1, v2
    v_max_f32 v132, v132, v3
    v_min3_f32 v136, v0, v1, v2
    v_min_f32 v136, v136, v3
    v_max3_f32 v133, v4, v5, v6
    v_max_f32 v133, v133, v7
    v_min3_f32 v137, v4, v5, v6
    v_min_f32 v137, v137, v7
    v_max3_f32 v134, v8, v9, v10
    v_max_f32 v134, v134, v11
    v_min3_f32 v138, v8, v9, v10
    v_min_f32 v138, v138, v11
    v_max3_f32 v135, v12, v13, v14
    v_max_f32 v135, v135, v15
    v_min3_f32 v139, v12, v13, v14
    v_min_f32 v139, v139, v15
    v_permlane16_swap_b32 v132, v133
    v_permlane16_swap_b32 v134, v135
    v_max_f32 v132, v132, v133
    v_max_f32 v134, v134, v135
    s_nop 1
    v_permlane32_swap_b32 v132, v134
    v_max_f32 v132, v132, v134
    v_permlane16_swap_b32 v136, v137
    v_permlane16_swap_b32 v138, v139
    v_min_f32 v136, v136, v137
    v_min_f32 v138, v138, v139
    s_nop 1
    v_permlane32_swap_b32 v136, v138
    v_min_f32 v136, v136, v138
    v_max3_f32 v132, v132, v32, v33
    v_min3_f32 v136, v136, v32, v33
    v_mul_f32 v132, s78, v132
    v_mul_f32 v136, s78, v136
    v_sub_f32 v132, 0, v132
    s_add_u32 s84, s8, 61440
    buffer_load_dwordx4 a[204:207], v254, s[4:7], s84 offen
    v_mov_b32 v140, v132
    v_mov_b32 v142, v132
    s_nop 1
    v_permlane16_swap_b32 v140, v142
    v_mov_b32 v144, v140
    v_mov_b32 v146, v142
    s_nop 0
    v_permlane32_swap_b32 v140, v144
    v_permlane32_swap_b32 v142, v146
    v_mov_b32 v148, v136
    v_mov_b32 v150, v136
    s_nop 1
    v_permlane16_swap_b32 v148, v150
    v_mov_b32 v152, v148
    v_mov_b32 v154, v150
    s_nop 0
    v_permlane32_swap_b32 v148, v152
    v_permlane32_swap_b32 v150, v154
    v_pk_fma_f32 v[156:157], v[0:1], s[78:79], v[148:149] op_sel_hi:[1,1,0] neg_lo:[1,0,0] neg_hi:[1,0,0]
    v_pk_fma_f32 v[0:1], v[0:1], s[78:79], v[140:141] op_sel_hi:[1,1,0]
    v_pk_fma_f32 v[158:159], v[2:3], s[78:79], v[148:149] op_sel_hi:[1,1,0] neg_lo:[1,0,0] neg_hi:[1,0,0]
    v_pk_fma_f32 v[2:3], v[2:3], s[78:79], v[140:141] op_sel_hi:[1,1,0]
    v_pk_fma_f32 v[160:161], v[4:5], s[78:79], v[150:151] op_sel_hi:[1,1,0] neg_lo:[1,0,0] neg_hi:[1,0,0]
    v_pk_fma_f32 v[4:5], v[4:5], s[78:79], v[142:143] op_sel_hi:[1,1,0]
    v_pk_fma_f32 v[162:163], v[6:7], s[78:79], v[150:151] op_sel_hi:[1,1,0] neg_lo:[1,0,0] neg_hi:[1,0,0]
    v_pk_fma_f32 v[6:7], v[6:7], s[78:79], v[142:143] op_sel_hi:[1,1,0]
    v_pk_fma_f32 v[164:165], v[8:9], s[78:79], v[152:153] op_sel_hi:[1,1,0] neg_lo:[1,0,0] neg_hi:[1,0,0]
    v_pk_fma_f32 v[8:9], v[8:9], s[78:79], v[144:145] op_sel_hi:[1,1,0]
    v_pk_fma_f32 v[166:167], v[10:11], s[78:79], v[152:153] op_sel_hi:[1,1,0] neg_lo:[1,0,0] neg_hi:[1,0,0]
    v_pk_fma_f32 v[10:11], v[10:11], s[78:79], v[144:145] op_sel_hi:[1,1,0]
    v_pk_fma_f32 v[168:169], v[12:13], s[78:79], v[154:155] op_sel_hi:[1,1,0] neg_lo:[1,0,0] neg_hi:[1,0,0]
    v_pk_fma_f32 v[12:13], v[12:13], s[78:79], v[146:147] op_sel_hi:[1,1,0]
    v_pk_fma_f32 v[170:171], v[14:15], s[78:79], v[154:155] op_sel_hi:[1,1,0] neg_lo:[1,0,0] neg_hi:[1,0,0]
    v_pk_fma_f32 v[14:15], v[14:15], s[78:79], v[146:147] op_sel_hi:[1,1,0]
    v_fma_f32 v34, -v32, s78, v136
    v_fma_f32 v35, -v33, s78, v136
    v_fma_f32 v32, v32, s78, v132
    v_fma_f32 v33, v33, s78, v132
    v_exp_f32 v0, v0
    v_exp_f32 v156, v156
    v_exp_f32 v1, v1
    v_exp_f32 v157, v157
    s_add_u32 s84, s8, 65536
    buffer_load_dwordx4 a[208:211], v254, s[4:7], s84 offen
    v_exp_f32 v2, v2
    v_exp_f32 v158, v158
    v_exp_f32 v3, v3
    v_exp_f32 v159, v159
    s_add_u32 s84, s8, 69632
    buffer_load_dwordx4 a[212:215], v254, s[4:7], s84 offen
    v_exp_f32 v4, v4
    v_exp_f32 v160, v160
    v_exp_f32 v5, v5
    v_exp_f32 v161, v161
    s_add_u32 s84, s8, 73728
    buffer_load_dwordx4 a[132:135], v254, s[4:7], s84 offen
    v_exp_f32 v6, v6
    v_exp_f32 v162, v162
    v_exp_f32 v7, v7
    v_exp_f32 v163, v163
    s_add_u32 s84, s8, 77824
    buffer_load_dwordx4 a[136:139], v254, s[4:7], s84 offen
    v_exp_f32 v8, v8
    v_exp_f32 v164, v164
    v_exp_f32 v9, v9
    v_exp_f32 v165, v165
    s_add_u32 s84, s8, 81920
    buffer_load_dwordx4 a[140:143], v254, s[4:7], s84 offen
    v_exp_f32 v10, v10
    v_exp_f32 v166, v166
    v_exp_f32 v11, v11
    v_exp_f32 v167, v167
    v_exp_f32 v12, v12
    v_exp_f32 v168, v168
    v_exp_f32 v13, v13
    v_exp_f32 v169, v169
    v_exp_f32 v14, v14
    v_exp_f32 v170, v170
    v_exp_f32 v15, v15
    v_exp_f32 v171, v171
    v_exp_f32 v32, v32
    v_exp_f32 v33, v33
    v_exp_f32 v34, v34
    v_exp_f32 v35, v35
    v_pk_add_f32 v[140:141], v[0:1], v[2:3]
    v_pk_add_f32 v[148:149], v[156:157], v[158:159]
    v_pk_add_f32 v[142:143], v[4:5], v[6:7]
    v_pk_add_f32 v[150:151], v[160:161], v[162:163]
    v_pk_add_f32 v[144:145], v[8:9], v[10:11]
    v_pk_add_f32 v[152:153], v[164:165], v[166:167]
    v_pk_add_f32 v[146:147], v[12:13], v[14:15]
    v_pk_add_f32 v[154:155], v[168:169], v[170:171]
    v_add_f32 v132, v140, v141
    v_add_f32 v136, v148, v149
    v_add_f32 v133, v142, v143
    v_add_f32 v137, v150, v151
    v_add_f32 v134, v144, v145
    v_add_f32 v138, v152, v153
    v_add_f32 v135, v146, v147
    v_add_f32 v139, v154, v155
    v_permlane16_swap_b32 v132, v133
    v_permlane16_swap_b32 v134, v135
    v_add_f32 v132, v132, v133
    v_add_f32 v134, v134, v135
    s_nop 1
    v_permlane32_swap_b32 v132, v134
    v_add_f32 v132, v132, v134
    v_permlane16_swap_b32 v136, v137
    v_permlane16_swap_b32 v138, v139
    v_add_f32 v136, v136, v137
    v_add_f32 v138, v138, v139
    s_nop 1
    v_permlane32_swap_b32 v136, v138
    v_add_f32 v136, v136, v138
    v_add_f32 v132, v132, v32
    v_add_f32 v136, v136, v34
    v_add_f32 v132, v132, v33
    v_add_f32 v136, v136, v35
    v_rcp_f32 v132, v132
    v_rcp_f32 v136, v136
    s_cmp_eq_u32 s44, 0
    s_cbranch_scc0 Lpp_51
    s_mov_b64 exec, 0xffff
    buffer_load_dwordx2 v[40:41], v196, s[24:27], 0 offen sc1
    s_mov_b64 exec, -1
Lpp_51:
    v_mov_b32 v140, v132
    v_mov_b32 v142, v132
    s_nop 1
    v_permlane16_swap_b32 v140, v142
    v_mov_b32 v144, v140
    v_mov_b32 v146, v142
    s_nop 0
    v_permlane32_swap_b32 v140, v144
    v_permlane32_swap_b32 v142, v146
    v_mov_b32 v148, v136
    v_mov_b32 v150, v136
    s_nop 1
    v_permlane16_swap_b32 v148, v150
    v_mov_b32 v152, v148
    v_mov_b32 v154, v150
    s_nop 0
    v_permlane32_swap_b32 v148, v152
    v_permlane32_swap_b32 v150, v154
    v_mul_f32 v32, v32, v132
    v_mul_f32 v33, v33, v132
    v_mul_f32 v34, v34, v136
    v_mul_f32 v35, v35, v136
    v_cvt_pk_bf16_f32 v92, v32, v33
    v_cvt_pk_bf16_f32 v93, v34, v35
    s_cmp_eq_u32 s44, 0
    s_cbranch_scc0 Lpp_52
    s_mov_b64 exec, 0xffff
    buffer_load_dwordx2 v[42:43], v196, s[24:27], 0 offen sc1
    s_mov_b64 exec, -1
Lpp_52:
    v_pk_mul_f32 v[0:1], v[0:1], v[140:141] op_sel_hi:[1,0]
    v_pk_mul_f32 v[2:3], v[2:3], v[140:141] op_sel_hi:[1,0]
    v_pk_mul_f32 v[156:157], v[156:157], v[148:149] op_sel_hi:[1,0]
    v_pk_mul_f32 v[158:159], v[158:159], v[148:149] op_sel_hi:[1,0]
    v_cvt_pk_bf16_f32 v76, v0, v1
    v_cvt_pk_bf16_f32 v77, v2, v3
    v_cvt_pk_bf16_f32 v78, v156, v157
    v_cvt_pk_bf16_f32 v79, v158, v159
    v_pk_mul_f32 v[4:5], v[4:5], v[142:143] op_sel_hi:[1,0]
    v_pk_mul_f32 v[6:7], v[6:7], v[142:143] op_sel_hi:[1,0]
    v_pk_mul_f32 v[160:161], v[160:161], v[150:151] op_sel_hi:[1,0]
    v_pk_mul_f32 v[162:163], v[162:163], v[150:151] op_sel_hi:[1,0]
    v_cvt_pk_bf16_f32 v80, v4, v5
    v_cvt_pk_bf16_f32 v81, v6, v7
    v_cvt_pk_bf16_f32 v82, v160, v161
    v_cvt_pk_bf16_f32 v83, v162, v163
    v_pk_mul_f32 v[8:9], v[8:9], v[144:145] op_sel_hi:[1,0]
    v_pk_mul_f32 v[10:11], v[10:11], v[144:145] op_sel_hi:[1,0]
    v_pk_mul_f32 v[164:165], v[164:165], v[152:153] op_sel_hi:[1,0]
    v_pk_mul_f32 v[166:167], v[166:167], v[152:153] op_sel_hi:[1,0]
    v_cvt_pk_bf16_f32 v84, v8, v9
    v_cvt_pk_bf16_f32 v85, v10, v11
    v_cvt_pk_bf16_f32 v86, v164, v165
    v_cvt_pk_bf16_f32 v87, v166, v167
    v_pk_mul_f32 v[12:13], v[12:13], v[146:147] op_sel_hi:[1,0]
    v_pk_mul_f32 v[14:15], v[14:15], v[146:147] op_sel_hi:[1,0]
    v_pk_mul_f32 v[168:169], v[168:169], v[154:155] op_sel_hi:[1,0]
    v_pk_mul_f32 v[170:171], v[170:171], v[154:155] op_sel_hi:[1,0]
    v_cvt_pk_bf16_f32 v88, v12, v13
    v_cvt_pk_bf16_f32 v89, v14, v15
    v_cvt_pk_bf16_f32 v90, v168, v169
    v_cvt_pk_bf16_f32 v91, v170, v171
    s_cmp_eq_u32 s44, 0
    s_cbranch_scc0 Lw0_53
    s_lshl_b32 s58, s47, 3
    s_add_u32 s58, s58, s48
    s_add_u32 s58, s58, 3
    s_mov_b64 exec, 0xffff
    s_mov_b32 s59, 0
    buffer_load_dwordx2 v[44:45], v196, s[24:27], 0 offen sc1
Lpoll_55:
    s_waitcnt vmcnt(2)
    v_subrev_u32 v174, s58, v40
    v_xor_b32 v175, v40, v41
    v_cmp_gt_u32 vcc, 32, v174
    v_or_b32 v174, 7, v175
    v_cmp_eq_u32 s[60:61], -1, v174
    s_nop 1
    s_and_b64 vcc, vcc, s[60:61]
    s_cmp_eq_u64 vcc, exec
    s_cbranch_scc1 Lgot_56
    buffer_load_dwordx2 v[40:41], v196, s[24:27], 0 offen sc1
    s_waitcnt vmcnt(2)
    v_subrev_u32 v174, s58, v42
    v_xor_b32 v175, v42, v43
    v_cmp_gt_u32 vcc, 32, v174
    v_or_b32 v174, 7, v175
    v_cmp_eq_u32 s[60:61], -1, v174
    s_nop 1
    s_and_b64 vcc, vcc, s[60:61]
    s_cmp_eq_u64 vcc, exec
    s_cbranch_scc1 Lgot_56
    buffer_load_dwordx2 v[42:43], v196, s[24:27], 0 offen sc1
    s_waitcnt vmcnt(2)
    v_subrev_u32 v174, s58, v44
    v_xor_b32 v175, v44, v45
    v_cmp_gt_u32 vcc, 32, v174
    v_or_b32 v174, 7, v175
    v_cmp_eq_u32 s[60:61], -1, v174
    s_nop 1
    s_and_b64 vcc, vcc, s[60:61]
    s_cmp_eq_u64 vcc, exec
    s_cbranch_scc1 Lgot_56
    buffer_load_dwordx2 v[44:45], v196, s[24:27], 0 offen sc1
    s_add_u32 s59, s59, 1
    s_cmp_lt_u32 s59, 20000
    s_cbranch_scc1 Lpoll_55
    s_add_u32 s51, s51, 1
Lgot_56:
    s_mov_b64 exec, -1
Lw0_53:
    s_nop 0
    s_barrier
    s_add_u32 s56, s45, 1
    s_and_b32 s56, s56, 15
    s_mul_i32 s56, s56, 3072
    s_add_u32 s56, s56, s83
    buffer_load_dwordx4 v[0:3], v251, s[24:27], s56 offen sc1
    buffer_load_dwordx2 v[132:133], v253, s[24:27], s56 offen sc1
    s_add_u32 s56, s45, 2
    s_and_b32 s56, s56, 15
    s_mul_i32 s56, s56, 3072
    s_add_u32 s56, s56, s83
    buffer_load_dwordx4 v[4:7], v251, s[24:27], s56 offen sc1
    buffer_load_dwordx2 v[134:135], v253, s[24:27], s56 offen sc1
    s_add_u32 s56, s45, 3
    s_and_b32 s56, s56, 15
    s_mul_i32 s56, s56, 3072
    s_add_u32 s56, s56, s83
    buffer_load_dwordx4 v[8:11], v251, s[24:27], s56 offen sc1
    buffer_load_dwordx2 v[136:137], v253, s[24:27], s56 offen sc1
    s_add_u32 s56, s45, 4
    s_and_b32 s56, s56, 15
    s_mul_i32 s56, s56, 3072
    s_add_u32 s56, s56, s83
    buffer_load_dwordx4 v[12:15], v251, s[24:27], s56 offen sc1
    buffer_load_dwordx2 v[138:139], v253, s[24:27], s56 offen sc1
    s_add_u32 s56, s45, 5
    s_and_b32 s56, s56, 15
    s_mul_i32 s56, s56, 3072
    s_add_u32 s56, s56, s83
    buffer_load_dwordx4 v[16:19], v251, s[24:27], s56 offen sc1
    buffer_load_dwordx2 v[140:141], v253, s[24:27], s56 offen sc1
    s_add_u32 s56, s45, 6
    s_and_b32 s56, s56, 15
    s_mul_i32 s56, s56, 3072
    s_add_u32 s56, s56, s83
    buffer_load_dwordx4 v[20:23], v251, s[24:27], s56 offen sc1
    buffer_load_dwordx2 v[142:143], v253, s[24:27], s56 offen sc1
    s_add_u32 s56, s45, 7
    s_and_b32 s56, s56, 15
    s_mul_i32 s56, s56, 3072
    s_add_u32 s56, s56, s83
    buffer_load_dwordx4 v[24:27], v251, s[24:27], s56 offen sc1
    buffer_load_dwordx2 v[144:145], v253, s[24:27], s56 offen sc1
    s_add_u32 s56, s45, 8
    s_and_b32 s56, s56, 15
    s_mul_i32 s56, s56, 3072
    s_add_u32 s56, s56, s83
    buffer_load_dwordx4 v[28:31], v251, s[24:27], s56 offen sc1
    buffer_load_dwordx2 v[146:147], v253, s[24:27], s56 offen sc1
    s_add_u32 s56, s45, 9
    s_and_b32 s56, s56, 15
    s_mul_i32 s56, s56, 3072
    s_add_u32 s56, s56, s83
    buffer_load_dwordx4 v[32:35], v251, s[24:27], s56 offen sc1
    buffer_load_dwordx2 v[148:149], v253, s[24:27], s56 offen sc1
    s_add_u32 s56, s45, 10
    s_and_b32 s56, s56, 15
    s_mul_i32 s56, s56, 3072
    s_add_u32 s56, s56, s83
    buffer_load_dwordx4 v[36:39], v251, s[24:27], s56 offen sc1
    buffer_load_dwordx2 v[150:151], v253, s[24:27], s56 offen sc1
    s_add_u32 s56, s45, 11
    s_and_b32 s56, s56, 15
    s_mul_i32 s56, s56, 3072
    s_add_u32 s56, s56, s83
    buffer_load_dwordx4 v[40:43], v251, s[24:27], s56 offen sc1
    buffer_load_dwordx2 v[152:153], v253, s[24:27], s56 offen sc1
    s_add_u32 s56, s45, 12
    s_and_b32 s56, s56, 15
    s_mul_i32 s56, s56, 3072
    s_add_u32 s56, s56, s83
    buffer_load_dwordx4 v[44:47], v251, s[24:27], s56 offen sc1
    buffer_load_dwordx2 v[154:155], v253, s[24:27], s56 offen sc1
    s_add_u32 s56, s45, 13
    s_and_b32 s56, s56, 15
    s_mul_i32 s56, s56, 3072
    s_add_u32 s56, s56, s83
    buffer_load_dwordx4 v[48:51], v251, s[24:27], s56 offen sc1
    buffer_load_dwordx2 v[156:157], v253, s[24:27], s56 offen sc1
    s_add_u32 s56, s45, 14
    s_and_b32 s56, s56, 15
    s_mul_i32 s56, s56, 3072
    s_add_u32 s56, s56, s83
    buffer_load_dwordx4 v[52:55], v251, s[24:27], s56 offen sc1
    buffer_load_dwordx2 v[158:159], v253, s[24:27], s56 offen sc1
    s_add_u32 s56, s45, 15
    s_and_b32 s56, s56, 15
    s_mul_i32 s56, s56, 3072
    s_add_u32 s56, s56, s83
    buffer_load_dwordx4 v[124:127], v251, s[24:27], s56 offen sc1
    buffer_load_dwordx2 v[160:161], v253, s[24:27], s56 offen sc1
    s_lshr_b32 s56, s44, 1
    s_and_b32 s57, s44, 1
    s_cmp_eq_u32 s57, 0
    s_cselect_b32 s57, 10, 9
    s_cselect_b32 s58, 0, 2048
    s_cselect_b32 s59, 0, 256
    s_cselect_b32 s60, -1, 0x00ff00ff
    s_cselect_b32 s62, 16, 8
    s_bfm_b32 s62, s62, 0
    s_add_u32 s58, s58, 138240
    s_add_u32 s59, s59, 141312
    s_mov_b32 s61, s60
    s_mov_b32 s63, 0
    s_lshl_b32 s84, s56, s57
    s_add_u32 s58, s58, s84
    s_sub_u32 s85, s57, 3
    s_lshl_b32 s84, s56, s85
    s_add_u32 s59, s59, s84
    s_sub_u32 s57, s57, 2
    v_lshlrev_b32 v94, s57, v199
    v_lshl_add_u32 v94, v198, 4, v94
    v_add_u32 v94, s58, v94
    v_lshlrev_b32 v95, 3, v198
    v_add_u32 v95, s59, v95
    v_lshlrev_b32 v96, 4, v197
    v_add_u32 v96, 138240, v96
    v_and_b32 v97, 1, v198
    v_and_b32 v98, 2, v198
    v_cmp_eq_u32 vcc, 0, v98
    v_mov_b32 v99, 4
    s_nop 0
    v_cndmask_b32 v100, v99, v97, vcc
    v_add_u32 v97, 2, v97
    v_cndmask_b32 v101, v99, v97, vcc
    v_lshlrev_b32 v99, 3, v199
    v_add_u32 v102, v99, v100
    v_lshlrev_b32 v102, 4, v102
    v_add_u32 v102, 140288, v102
    v_lshlrev_b32 v104, 3, v100
    v_add_u32 v104, 141568, v104
    v_add_u32 v103, v99, v101
    v_lshlrev_b32 v103, 4, v103
    v_add_u32 v103, 140800, v103
    v_lshlrev_b32 v105, 3, v101
    v_add_u32 v105, 141632, v105
    v_lshlrev_b32 v106, 3, v198
    v_add_u32 v106, 141312, v106
    v_cndmask_b32 v56, 0, v92, s[68:69]
    v_cndmask_b32 v57, 0, v93, s[68:69]
    v_cndmask_b32 v58, 0, v92, s[70:71]
    v_cndmask_b32 v59, 0, v93, s[70:71]
    v_cndmask_b32 v60, 0, v92, s[72:73]
    v_cndmask_b32 v61, 0, v93, s[72:73]
    v_cndmask_b32 v62, 0, v92, s[74:75]
    v_cndmask_b32 v63, 0, v93, s[74:75]
    v_lshrrev_b32 v112, 2, v198
    v_and_b32 v113, 1, v198
    v_mov_b32 v114, 0x3f80
    v_mov_b32 v115, 0x3f800000
    v_cmp_eq_u32 vcc, 1, v113
    s_nop 1
    v_cndmask_b32 v113, v114, v115, vcc
    v_cmp_eq_u32 vcc, v199, v112
    s_nop 1
    v_cndmask_b32 v113, 0, v113, vcc
    v_and_b32 v112, 2, v198
    v_cmp_eq_u32 vcc, 0, v112
    s_nop 1
    v_cndmask_b32 v112, 0, v113, vcc
    v_sub_u32 v113, v113, v112
    v_mov_b32 v114, 0
    v_mov_b32 v115, 0
    v_mov_b32 v116, v112
    v_mov_b32 v117, v113
    v_mov_b32 v118, v112
    v_mov_b32 v119, v113
    v_mov_b32 v162, 0
    v_mov_b32 v163, 0
    s_waitcnt vmcnt(28)
    v_mfma_f32_16x16x32_bf16 v[64:67], v[112:115], v[0:3], v[64:67]
    v_mfma_f32_16x16x32_bf16 v[68:71], v[114:117], v[0:3], v[68:71]
    s_waitcnt vmcnt(26)
    v_mfma_f32_16x16x32_bf16 v[64:67], v[112:115], v[4:7], v[64:67]
    v_mfma_f32_16x16x32_bf16 v[68:71], v[114:117], v[4:7], v[68:71]
    v_mfma_f32_16x16x32_bf16 v[72:75], v[116:119], v[132:135], v[72:75]
    s_waitcnt vmcnt(24)
    v_mfma_f32_16x16x32_bf16 v[64:67], v[112:115], v[8:11], v[64:67]
    v_mfma_f32_16x16x32_bf16 v[68:71], v[114:117], v[8:11], v[68:71]
    s_waitcnt vmcnt(22)
    v_mfma_f32_16x16x32_bf16 v[64:67], v[112:115], v[12:15], v[64:67]
    v_mfma_f32_16x16x32_bf16 v[68:71], v[114:117], v[12:15], v[68:71]
    v_mfma_f32_16x16x32_bf16 v[72:75], v[116:119], v[136:139], v[72:75]
    s_waitcnt vmcnt(20)
    v_mfma_f32_16x16x32_bf16 v[64:67], v[112:115], v[16:19], v[64:67]
    v_mfma_f32_16x16x32_bf16 v[68:71], v[114:117], v[16:19], v[68:71]
    s_waitcnt vmcnt(18)
    v_mfma_f32_16x16x32_bf16 v[64:67], v[112:115], v[20:23], v[64:67]
    v_mfma_f32_16x16x32_bf16 v[68:71], v[114:117], v[20:23], v[68:71]
    v_mfma_f32_16x16x32_bf16 v[72:75], v[116:119], v[140:143], v[72:75]
    s_waitcnt vmcnt(16)
    v_mfma_f32_16x16x32_bf16 v[64:67], v[112:115], v[24:27], v[64:67]
    v_mfma_f32_16x16x32_bf16 v[68:71], v[114:117], v[24:27], v[68:71]
    s_waitcnt vmcnt(14)
    v_mfma_f32_16x16x32_bf16 v[64:67], v[112:115], v[28:31], v[64:67]
    v_mfma_f32_16x16x32_bf16 v[68:71], v[114:117], v[28:31], v[68:71]
    v_mfma_f32_16x16x32_bf16 v[72:75], v[116:119], v[144:147], v[72:75]
    s_waitcnt vmcnt(12)
    v_mfma_f32_16x16x32_bf16 v[64:67], v[112:115], v[32:35], v[64:67]
    v_mfma_f32_16x16x32_bf16 v[68:71], v[114:117], v[32:35], v[68:71]
    s_waitcnt vmcnt(10)
    v_mfma_f32_16x16x32_bf16 v[64:67], v[112:115], v[36:39], v[64:67]
    v_mfma_f32_16x16x32_bf16 v[68:71], v[114:117], v[36:39], v[68:71]
    v_mfma_f32_16x16x32_bf16 v[72:75], v[116:119], v[148:151], v[72:75]
    s_waitcnt vmcnt(8)
    v_mfma_f32_16x16x32_bf16 v[64:67], v[112:115], v[40:43], v[64:67]
    v_mfma_f32_16x16x32_bf16 v[68:71], v[114:117], v[40:43], v[68:71]
    s_waitcnt vmcnt(6)
    v_mfma_f32_16x16x32_bf16 v[64:67], v[112:115], v[44:47], v[64:67]
    v_mfma_f32_16x16x32_bf16 v[68:71], v[114:117], v[44:47], v[68:71]
    v_mfma_f32_16x16x32_bf16 v[72:75], v[116:119], v[152:155], v[72:75]
    s_waitcnt vmcnt(4)
    v_mfma_f32_16x16x32_bf16 v[64:67], v[112:115], v[48:51], v[64:67]
    v_mfma_f32_16x16x32_bf16 v[68:71], v[114:117], v[48:51], v[68:71]
    s_waitcnt vmcnt(2)
    v_mfma_f32_16x16x32_bf16 v[64:67], v[112:115], v[52:55], v[64:67]
    v_mfma_f32_16x16x32_bf16 v[68:71], v[114:117], v[52:55], v[68:71]
    v_mfma_f32_16x16x32_bf16 v[72:75], v[116:119], v[156:159], v[72:75]
    s_waitcnt vmcnt(0)
    v_mfma_f32_16x16x32_bf16 v[64:67], v[112:115], v[124:127], v[64:67]
    v_mfma_f32_16x16x32_bf16 v[68:71], v[114:117], v[124:127], v[68:71]
    v_mfma_f32_16x16x32_bf16 v[72:75], v[116:119], v[160:163], v[72:75]
    s_nop 5
    v_cvt_pk_bf16_f32 v0, v64, v65
    v_cvt_pk_bf16_f32 v1, v66, v67
    v_cvt_pk_bf16_f32 v2, v68, v69
    v_cvt_pk_bf16_f32 v3, v70, v71
    v_cvt_pk_bf16_f32 v4, v72, v73
    v_cvt_pk_bf16_f32 v5, v74, v75
    s_mov_b64 exec, s[60:61]
    ds_write_b128 v94, v[0:3]
    s_mov_b64 exec, s[62:63]
    ds_write_b64 v95, v[4:5]
    s_mov_b64 exec, -1
    s_waitcnt lgkmcnt(0)
    s_barrier
    ds_read_b128 v[0:3], v96 offset:0
    ds_read_b128 v[8:11], v102
    ds_read_b64 v[16:17], v106 offset:0
    ds_read_b64 v[20:21], v104
    ds_read_b128 v[4:7], v96 offset:1024
    ds_read_b128 v[12:15], v103
    ds_read_b64 v[18:19], v106 offset:128
    ds_read_b64 v[22:23], v105
    s_waitcnt lgkmcnt(0)
    v_mfma_f32_16x16x32_bf16 v[136:139], v[0:3], v[76:79], 0
    v_mfma_f32_16x16x32_bf16 v[152:155], v[8:11], v[76:79], 0
    v_mfma_f32_16x16x32_bf16 v[140:143], v[4:7], v[80:83], 0
    v_mfma_f32_16x16x32_bf16 v[156:159], v[12:15], v[80:83], 0
    v_mfma_f32_16x16x32_bf16 v[144:147], v[0:3], v[84:87], 0
    v_mfma_f32_16x16x32_bf16 v[160:163], v[8:11], v[84:87], 0
    v_mfma_f32_16x16x32_bf16 v[148:151], v[4:7], v[88:91], 0
    v_mfma_f32_16x16x32_bf16 v[164:167], v[12:15], v[88:91], 0
    v_mfma_f32_16x16x16_bf16 v[136:139], v[16:17], v[56:57], v[136:139]
    v_mfma_f32_16x16x16_bf16 v[152:155], v[20:21], v[56:57], v[152:155]
    v_mfma_f32_16x16x16_bf16 v[140:143], v[18:19], v[58:59], v[140:143]
    v_mfma_f32_16x16x16_bf16 v[156:159], v[22:23], v[58:59], v[156:159]
    v_mfma_f32_16x16x16_bf16 v[144:147], v[16:17], v[60:61], v[144:147]
    v_mfma_f32_16x16x16_bf16 v[160:163], v[20:21], v[60:61], v[160:163]
    v_mfma_f32_16x16x16_bf16 v[148:151], v[18:19], v[62:63], v[148:151]
    v_mfma_f32_16x16x16_bf16 v[164:167], v[22:23], v[62:63], v[164:167]
    s_nop 1
    v_add_f32 v112, s91, v154
    v_rcp_f32 v112, v112
    v_add_f32 v114, s91, v158
    v_rcp_f32 v114, v114
    v_add_f32 v116, s91, v162
    v_rcp_f32 v116, v116
    v_add_f32 v118, s91, v166
    v_rcp_f32 v118, v118
    v_pk_mul_f32 v[136:137], v[136:137], v[112:113] op_sel_hi:[1,0]
    v_pk_mul_f32 v[138:139], v[138:139], v[112:113] op_sel_hi:[1,0]
    v_pk_mul_f32 v[152:153], v[152:153], v[112:113] op_sel_hi:[1,0]
    v_cvt_pk_bf16_f32 v120, v136, v137
    v_cvt_pk_bf16_f32 v121, v138, v139
    v_cvt_pk_bf16_f32 v128, v152, v153
    v_pk_mul_f32 v[140:141], v[140:141], v[114:115] op_sel_hi:[1,0]
    v_pk_mul_f32 v[142:143], v[142:143], v[114:115] op_sel_hi:[1,0]
    v_pk_mul_f32 v[156:157], v[156:157], v[114:115] op_sel_hi:[1,0]
    v_cvt_pk_bf16_f32 v122, v140, v141
    v_cvt_pk_bf16_f32 v123, v142, v143
    v_cvt_pk_bf16_f32 v129, v156, v157
    v_pk_mul_f32 v[144:145], v[144:145], v[116:117] op_sel_hi:[1,0]
    v_pk_mul_f32 v[146:147], v[146:147], v[116:117] op_sel_hi:[1,0]
    v_pk_mul_f32 v[160:161], v[160:161], v[116:117] op_sel_hi:[1,0]
    v_cvt_pk_bf16_f32 v124, v144, v145
    v_cvt_pk_bf16_f32 v125, v146, v147
    v_cvt_pk_bf16_f32 v130, v160, v161
    v_pk_mul_f32 v[148:149], v[148:149], v[118:119] op_sel_hi:[1,0]
    v_pk_mul_f32 v[150:151], v[150:151], v[118:119] op_sel_hi:[1,0]
    v_pk_mul_f32 v[164:165], v[164:165], v[118:119] op_sel_hi:[1,0]
    v_cvt_pk_bf16_f32 v126, v148, v149
    v_cvt_pk_bf16_f32 v127, v150, v151
    v_cvt_pk_bf16_f32 v131, v164, v165
    s_cmp_eq_u32 s41, 0
    s_cbranch_scc1 Lss_57
    buffer_store_dwordx2 v[120:121], v188, s[24:27], 0 offen
    buffer_store_dwordx2 v[122:123], v189, s[24:27], 0 offen
    buffer_store_dwordx2 v[124:125], v188, s[24:27], s77 offen
    buffer_store_dwordx2 v[126:127], v189, s[24:27], s77 offen
    buffer_store_dwordx2 v[128:129], v190, s[24:27], 0 offen
    buffer_store_dwordx2 v[130:131], v190, s[24:27], s77 offen
Lsj_58:
    v_mov_b32 v100, v200
    v_mov_b32 v101, v201
    v_mov_b32 v102, v202
    v_mov_b32 v103, v203
    v_mov_b32 v104, v204
    v_mov_b32 v105, v205
    v_mov_b32 v106, v206
    v_mov_b32 v107, v207
    v_mov_b32 v108, v208
    v_mov_b32 v109, v209
    v_permlane16_swap_b32 v100, v102
    v_permlane16_swap_b32 v101, v103
    v_permlane16_swap_b32 v104, v106
    v_permlane16_swap_b32 v105, v107
    v_lshlrev_b32 v0, 16, v100
    v_and_b32 v1, 0xffff0000, v100
    v_lshlrev_b32 v2, 16, v101
    v_and_b32 v3, 0xffff0000, v101
    v_lshlrev_b32 v4, 16, v102
    v_and_b32 v5, 0xffff0000, v102
    v_lshlrev_b32 v6, 16, v103
    v_and_b32 v7, 0xffff0000, v103
    v_lshlrev_b32 v8, 16, v104
    v_and_b32 v9, 0xffff0000, v104
    v_lshlrev_b32 v10, 16, v105
    v_and_b32 v11, 0xffff0000, v105
    v_lshlrev_b32 v12, 16, v106
    v_and_b32 v13, 0xffff0000, v106
    v_lshlrev_b32 v14, 16, v107
    v_and_b32 v15, 0xffff0000, v107
    v_lshlrev_b32 v16, 16, v108
    v_and_b32 v17, 0xffff0000, v108
    v_lshlrev_b32 v18, 16, v109
    v_and_b32 v19, 0xffff0000, v109
    s_waitcnt vmcnt(0)
    s_barrier
    s_cmp_eq_u32 s44, 0
    s_cbranch_scc0 Lw0_59
    s_lshl_b32 s58, s47, 3
    s_add_u32 s58, s58, s48
    s_add_u32 s58, s58, 4
    s_not_b32 s59, s58
    s_xor_b32 s59, s59, s42
    v_mov_b32 v172, s58
    v_mov_b32 v173, s59
    s_mov_b64 exec, 1
    s_cmp_eq_u32 s41, 0
    s_cbranch_scc1 Lss_61
    buffer_store_dwordx2 v[172:173], v255, s[24:27], s52 offen
Lsj_62:
    s_mov_b64 exec, -1
    s_lshl_b32 s58, s47, 3
    s_add_u32 s58, s58, s48
    s_add_u32 s58, s58, 4
    s_mov_b64 exec, 0xffff
    s_mov_b32 s59, 0
    buffer_load_dwordx2 v[172:173], v195, s[24:27], 0 offen sc1
    s_sleep 2
    buffer_load_dwordx2 v[170:171], v195, s[24:27], 0 offen sc1
    s_sleep 2
    buffer_load_dwordx2 v[168:169], v195, s[24:27], 0 offen sc1
Lpoll_63:
    s_waitcnt vmcnt(2)
    v_subrev_u32 v174, s58, v172
    v_xor_b32 v175, v172, v173
    v_cmp_gt_u32 vcc, 32, v174
    v_or_b32 v174, 7, v175
    v_cmp_eq_u32 s[60:61], -1, v174
    s_nop 1
    s_and_b64 vcc, vcc, s[60:61]
    s_cmp_eq_u64 vcc, exec
    s_cbranch_scc1 Lgot_64
    buffer_load_dwordx2 v[172:173], v195, s[24:27], 0 offen sc1
    s_waitcnt vmcnt(2)
    v_subrev_u32 v174, s58, v170
    v_xor_b32 v175, v170, v171
    v_cmp_gt_u32 vcc, 32, v174
    v_or_b32 v174, 7, v175
    v_cmp_eq_u32 s[60:61], -1, v174
    s_nop 1
    s_and_b64 vcc, vcc, s[60:61]
    s_cmp_eq_u64 vcc, exec
    s_cbranch_scc1 Lgot_64
    buffer_load_dwordx2 v[170:171], v195, s[24:27], 0 offen sc1
    s_waitcnt vmcnt(2)
    v_subrev_u32 v174, s58, v168
    v_xor_b32 v175, v168, v169
    v_cmp_gt_u32 vcc, 32, v174
    v_or_b32 v174, 7, v175
    v_cmp_eq_u32 s[60:61], -1, v174
    s_nop 1
    s_and_b64 vcc, vcc, s[60:61]
    s_cmp_eq_u64 vcc, exec
    s_cbranch_scc1 Lgot_64
    buffer_load_dwordx2 v[168:169], v195, s[24:27], 0 offen sc1
    s_add_u32 s59, s59, 1
    s_cmp_lt_u32 s59, 20000
    s_cbranch_scc1 Lpoll_63
    s_add_u32 s51, s51, 1
Lgot_64:
    s_mov_b64 exec, -1
Lw0_59:
    s_nop 0
    s_barrier
    s_mov_b32 s96, 0
    buffer_load_dwordx4 a[0:3], v187, s[24:27], s96 offen offset:0 sc1
    buffer_load_dwordx4 a[4:7], v187, s[24:27], s96 offen offset:1024 sc1
    buffer_load_dwordx4 a[8:11], v187, s[24:27], s96 offen offset:2048 sc1
    buffer_load_dwordx4 a[12:15], v187, s[24:27], s96 offen offset:3072 sc1
    s_mov_b32 s96, 4096
    buffer_load_dwordx4 a[16:19], v187, s[24:27], s96 offen offset:0 sc1
    buffer_load_dwordx4 a[20:23], v187, s[24:27], s96 offen offset:1024 sc1
    buffer_load_dwordx4 a[24:27], v187, s[24:27], s96 offen offset:2048 sc1
    buffer_load_dwordx4 a[28:31], v187, s[24:27], s96 offen offset:3072 sc1
    s_mov_b32 s96, 8192
    buffer_load_dwordx4 a[32:35], v187, s[24:27], s96 offen offset:0 sc1
    buffer_load_dwordx4 a[36:39], v187, s[24:27], s96 offen offset:1024 sc1
    ds_read_b128 v[56:59], v181 offset:0
    ds_read_b128 v[60:63], v181 offset:1024
    ds_read_b128 v[64:67], v181 offset:2048
    ds_read_b128 v[68:71], v181 offset:3072
    ds_read_b128 v[72:75], v183 offset:0
    s_waitcnt vmcnt(9) lgkmcnt(3)
    v_mfma_f32_16x16x32_bf16 v[0:3], v[56:59], a[0:3], v[0:3]
    ds_read_b128 v[76:79], v181 offset:4608
    v_mfma_f32_16x16x32_bf16 v[4:7], v[60:63], a[0:3], v[4:7]
    ds_read_b128 v[80:83], v181 offset:5632
    buffer_load_dwordx4 a[40:43], v187, s[24:27], s96 offen offset:2048 sc1
    s_waitcnt lgkmcnt(2)
    v_mfma_f32_16x16x32_bf16 v[8:11], v[64:67], a[0:3], v[8:11]
    ds_read_b128 v[84:87], v181 offset:6656
    v_mfma_f32_16x16x32_bf16 v[12:15], v[68:71], a[0:3], v[12:15]
    ds_read_b128 v[88:91], v181 offset:7680
    v_mfma_f32_16x16x32_bf16 v[16:19], v[72:75], a[0:3], v[16:19]
    ds_read_b128 v[92:95], v183 offset:4608
    s_waitcnt vmcnt(9) lgkmcnt(3)
    v_mfma_f32_16x16x32_bf16 v[0:3], v[76:79], a[4:7], v[0:3]
    ds_read_b128 v[56:59], v181 offset:9216
    v_mfma_f32_16x16x32_bf16 v[4:7], v[80:83], a[4:7], v[4:7]
    ds_read_b128 v[60:63], v181 offset:10240
    buffer_load_dwordx4 a[44:47], v187, s[24:27], s96 offen offset:3072 sc1
    s_waitcnt lgkmcnt(2)
    v_mfma_f32_16x16x32_bf16 v[8:11], v[84:87], a[4:7], v[8:11]
    ds_read_b128 v[64:67], v181 offset:11264
    v_mfma_f32_16x16x32_bf16 v[12:15], v[88:91], a[4:7], v[12:15]
    ds_read_b128 v[68:71], v181 offset:12288
    v_mfma_f32_16x16x32_bf16 v[16:19], v[92:95], a[4:7], v[16:19]
    ds_read_b128 v[72:75], v183 offset:9216
    s_waitcnt vmcnt(9) lgkmcnt(3)
    v_mfma_f32_16x16x32_bf16 v[0:3], v[56:59], a[8:11], v[0:3]
    ds_read_b128 v[76:79], v181 offset:13824
    v_mfma_f32_16x16x32_bf16 v[4:7], v[60:63], a[8:11], v[4:7]
    ds_read_b128 v[80:83], v181 offset:14848
    s_mov_b32 s96, 12288
    buffer_load_dwordx4 a[48:51], v187, s[24:27], s96 offen offset:0 sc1
    s_waitcnt lgkmcnt(2)
    v_mfma_f32_16x16x32_bf16 v[8:11], v[64:67], a[8:11], v[8:11]
    ds_read_b128 v[84:87], v181 offset:15872
    v_mfma_f32_16x16x32_bf16 v[12:15], v[68:71], a[8:11], v[12:15]
    ds_read_b128 v[88:91], v181 offset:16896
    v_mfma_f32_16x16x32_bf16 v[16:19], v[72:75], a[8:11], v[16:19]
    ds_read_b128 v[92:95], v183 offset:13824
    s_waitcnt vmcnt(9) lgkmcnt(3)
    v_mfma_f32_16x16x32_bf16 v[0:3], v[76:79], a[12:15], v[0:3]
    ds_read_b128 v[56:59], v181 offset:18432
    v_mfma_f32_16x16x32_bf16 v[4:7], v[80:83], a[12:15], v[4:7]
    ds_read_b128 v[60:63], v181 offset:19456
    buffer_load_dwordx4 a[52:55], v187, s[24:27], s96 offen offset:1024 sc1
    s_waitcnt lgkmcnt(2)
    v_mfma_f32_16x16x32_bf16 v[8:11], v[84:87], a[12:15], v[8:11]
    ds_read_b128 v[64:67], v181 offset:20480
    v_mfma_f32_16x16x32_bf16 v[12:15], v[88:91], a[12:15], v[12:15]
    ds_read_b128 v[68:71], v181 offset:21504
    v_mfma_f32_16x16x32_bf16 v[16:19], v[92:95], a[12:15], v[16:19]
    ds_read_b128 v[72:75], v183 offset:18432
    s_waitcnt vmcnt(9) lgkmcnt(3)
    v_mfma_f32_16x16x32_bf16 v[0:3], v[56:59], a[16:19], v[0:3]
    ds_read_b128 v[76:79], v181 offset:23040
    v_mfma_f32_16x16x32_bf16 v[4:7], v[60:63], a[16:19], v[4:7]
    ds_read_b128 v[80:83], v181 offset:24064
    buffer_load_dwordx4 a[56:59], v187, s[24:27], s96 offen offset:2048 sc1
    s_waitcnt lgkmcnt(2)
    v_mfma_f32_16x16x32_bf16 v[8:11], v[64:67], a[16:19], v[8:11]
    ds_read_b128 v[84:87], v181 offset:25088
    v_mfma_f32_16x16x32_bf16 v[12:15], v[68:71], a[16:19], v[12:15]
    ds_read_b128 v[88:91], v181 offset:26112
    v_mfma_f32_16x16x32_bf16 v[16:19], v[72:75], a[16:19], v[16:19]
    ds_read_b128 v[92:95], v183 offset:23040
    s_waitcnt vmcnt(9) lgkmcnt(3)
    v_mfma_f32_16x16x32_bf16 v[0:3], v[76:79], a[20:23], v[0:3]
    ds_read_b128 v[56:59], v181 offset:27648
    v_mfma_f32_16x16x32_bf16 v[4:7], v[80:83], a[20:23], v[4:7]
    ds_read_b128 v[60:63], v181 offset:28672
    buffer_load_dwordx4 a[60:63], v187, s[24:27], s96 offen offset:3072 sc1
    s_waitcnt lgkmcnt(2)
    v_mfma_f32_16x16x32_bf16 v[8:11], v[84:87], a[20:23], v[8:11]
    ds_read_b128 v[64:67], v181 offset:29696
    v_mfma_f32_16x16x32_bf16 v[12:15], v[88:91], a[20:23], v[12:15]
    ds_read_b128 v[68:71], v181 offset:30720
    v_mfma_f32_16x16x32_bf16 v[16:19], v[92:95], a[20:23], v[16:19]
    ds_read_b128 v[72:75], v183 offset:27648
    s_waitcnt vmcnt(9) lgkmcnt(3)
    v_mfma_f32_16x16x32_bf16 v[0:3], v[56:59], a[24:27], v[0:3]
    ds_read_b128 v[76:79], v181 offset:32256
    v_mfma_f32_16x16x32_bf16 v[4:7], v[60:63], a[24:27], v[4:7]
    ds_read_b128 v[80:83], v181 offset:33280
    s_mov_b32 s96, 16384
    buffer_load_dwordx4 a[64:67], v187, s[24:27], s96 offen offset:0 sc1
    s_waitcnt lgkmcnt(2)
    v_mfma_f32_16x16x32_bf16 v[8:11], v[64:67], a[24:27], v[8:11]
    ds_read_b128 v[84:87], v181 offset:34304
    v_mfma_f32_16x16x32_bf16 v[12:15], v[68:71], a[24:27], v[12:15]
    ds_read_b128 v[88:91], v181 offset:35328
    v_mfma_f32_16x16x32_bf16 v[16:19], v[72:75], a[24:27], v[16:19]
    ds_read_b128 v[92:95], v183 offset:32256
    s_waitcnt vmcnt(9) lgkmcnt(3)
    v_mfma_f32_16x16x32_bf16 v[0:3], v[76:79], a[28:31], v[0:3]
    ds_read_b128 v[56:59], v181 offset:36864
    v_mfma_f32_16x16x32_bf16 v[4:7], v[80:83], a[28:31], v[4:7]
    ds_read_b128 v[60:63], v181 offset:37888
    buffer_load_dwordx4 a[68:71], v187, s[24:27], s96 offen offset:1024 sc1
    s_waitcnt lgkmcnt(2)
    v_mfma_f32_16x16x32_bf16 v[8:11], v[84:87], a[28:31], v[8:11]
    ds_read_b128 v[64:67], v181 offset:38912
    v_mfma_f32_16x16x32_bf16 v[12:15], v[88:91], a[28:31], v[12:15]
    ds_read_b128 v[68:71], v181 offset:39936
    s_add_u32 m0, s89, 86016
    s_add_u32 s84, s8, 86016
    buffer_load_dwordx4 v254, s[4:7], s84 offen lds
    v_mfma_f32_16x16x32_bf16 v[16:19], v[92:95], a[28:31], v[16:19]
    ds_read_b128 v[72:75], v183 offset:36864
    s_waitcnt vmcnt(10) lgkmcnt(3)
    v_mfma_f32_16x16x32_bf16 v[0:3], v[56:59], a[32:35], v[0:3]
    ds_read_b128 v[76:79], v182 offset:0
    v_mfma_f32_16x16x32_bf16 v[4:7], v[60:63], a[32:35], v[4:7]
    ds_read_b128 v[80:83], v182 offset:1024
    s_add_u32 m0, s89, 90112
    s_add_u32 s84, s8, 90112
    buffer_load_dwordx4 v254, s[4:7], s84 offen lds
    s_waitcnt lgkmcnt(2)
    v_mfma_f32_16x16x32_bf16 v[8:11], v[64:67], a[32:35], v[8:11]
    ds_read_b128 v[84:87], v182 offset:2048
    v_mfma_f32_16x16x32_bf16 v[12:15], v[68:71], a[32:35], v[12:15]
    ds_read_b128 v[88:91], v182 offset:3072
    v_mfma_f32_16x16x32_bf16 v[16:19], v[72:75], a[32:35], v[16:19]
    ds_read_b128 v[92:95], v184 offset:0
    s_waitcnt vmcnt(10) lgkmcnt(3)
    v_mfma_f32_16x16x32_bf16 v[0:3], v[76:79], a[36:39], v[0:3]
    ds_read_b128 v[56:59], v182 offset:4608
    v_mfma_f32_16x16x32_bf16 v[4:7], v[80:83], a[36:39], v[4:7]
    ds_read_b128 v[60:63], v182 offset:5632
    s_add_u32 m0, s89, 94208
    s_add_u32 s84, s8, 94208
    buffer_load_dwordx4 v254, s[4:7], s84 offen lds
    s_waitcnt lgkmcnt(2)
    v_mfma_f32_16x16x32_bf16 v[8:11], v[84:87], a[36:39], v[8:11]
    ds_read_b128 v[64:67], v182 offset:6656
    v_mfma_f32_16x16x32_bf16 v[12:15], v[88:91], a[36:39], v[12:15]
    ds_read_b128 v[68:71], v182 offset:7680
    v_mfma_f32_16x16x32_bf16 v[16:19], v[92:95], a[36:39], v[16:19]
    ds_read_b128 v[72:75], v184 offset:4608
    s_waitcnt vmcnt(10) lgkmcnt(3)
    v_mfma_f32_16x16x32_bf16 v[0:3], v[56:59], a[40:43], v[0:3]
    ds_read_b128 v[76:79], v182 offset:9216
    v_mfma_f32_16x16x32_bf16 v[4:7], v[60:63], a[40:43], v[4:7]
    ds_read_b128 v[80:83], v182 offset:10240
    s_add_u32 m0, s89, 98304
    s_add_u32 s84, s8, 98304
    buffer_load_dwordx4 v254, s[4:7], s84 offen lds
    s_waitcnt lgkmcnt(2)
    v_mfma_f32_16x16x32_bf16 v[8:11], v[64:67], a[40:43], v[8:11]
    ds_read_b128 v[84:87], v182 offset:11264
    v_mfma_f32_16x16x32_bf16 v[12:15], v[68:71], a[40:43], v[12:15]
    ds_read_b128 v[88:91], v182 offset:12288
    v_mfma_f32_16x16x32_bf16 v[16:19], v[72:75], a[40:43], v[16:19]
    ds_read_b128 v[92:95], v184 offset:9216
    s_waitcnt vmcnt(10) lgkmcnt(3)
    v_mfma_f32_16x16x32_bf16 v[0:3], v[76:79], a[44:47], v[0:3]
    ds_read_b128 v[56:59], v182 offset:13824
    v_mfma_f32_16x16x32_bf16 v[4:7], v[80:83], a[44:47], v[4:7]
    ds_read_b128 v[60:63], v182 offset:14848
    s_add_u32 m0, s89, 102400
    s_add_u32 s84, s8, 102400
    buffer_load_dwordx4 v254, s[4:7], s84 offen lds
    s_waitcnt lgkmcnt(2)
    v_mfma_f32_16x16x32_bf16 v[8:11], v[84:87], a[44:47], v[8:11]
    ds_read_b128 v[64:67], v182 offset:15872
    v_mfma_f32_16x16x32_bf16 v[12:15], v[88:91], a[44:47], v[12:15]
    ds_read_b128 v[68:71], v182 offset:16896
    v_mfma_f32_16x16x32_bf16 v[16:19], v[92:95], a[44:47], v[16:19]
    ds_read_b128 v[72:75], v184 offset:13824
    s_waitcnt vmcnt(10) lgkmcnt(3)
    v_mfma_f32_16x16x32_bf16 v[0:3], v[56:59], a[48:51], v[0:3]
    ds_read_b128 v[76:79], v182 offset:18432
    v_mfma_f32_16x16x32_bf16 v[4:7], v[60:63], a[48:51], v[4:7]
    ds_read_b128 v[80:83], v182 offset:19456
    s_add_u32 m0, s89, 106496
    s_add_u32 s84, s8, 106496
    buffer_load_dwordx4 v254, s[4:7], s84 offen lds
    s_waitcnt lgkmcnt(2)
    v_mfma_f32_16x16x32_bf16 v[8:11], v[64:67], a[48:51], v[8:11]
    ds_read_b128 v[84:87], v182 offset:20480
    v_mfma_f32_16x16x32_bf16 v[12:15], v[68:71], a[48:51], v[12:15]
    ds_read_b128 v[88:91], v182 offset:21504
    v_mfma_f32_16x16x32_bf16 v[16:19], v[72:75], a[48:51], v[16:19]
    ds_read_b128 v[92:95], v184 offset:18432
    s_waitcnt vmcnt(10) lgkmcnt(3)
    v_mfma_f32_16x16x32_bf16 v[0:3], v[76:79], a[52:55], v[0:3]
    ds_read_b128 v[56:59], v182 offset:23040
    v_mfma_f32_16x16x32_bf16 v[4:7], v[80:83], a[52:55], v[4:7]
    ds_read_b128 v[60:63], v182 offset:24064
    s_add_u32 m0, s89, 110592
    s_add_u32 s84, s8, 110592
    buffer_load_dwordx4 v254, s[4:7], s84 offen lds
    s_waitcnt lgkmcnt(2)
    v_mfma_f32_16x16x32_bf16 v[8:11], v[84:87], a[52:55], v[8:11]
    ds_read_b128 v[64:67], v182 offset:25088
    v_mfma_f32_16x16x32_bf16 v[12:15], v[88:91], a[52:55], v[12:15]
    ds_read_b128 v[68:71], v182 offset:26112
    v_mfma_f32_16x16x32_bf16 v[16:19], v[92:95], a[52:55], v[16:19]
    ds_read_b128 v[72:75], v184 offset:23040
    s_waitcnt vmcnt(10) lgkmcnt(3)
    v_mfma_f32_16x16x32_bf16 v[0:3], v[56:59], a[56:59], v[0:3]
    ds_read_b128 v[76:79], v182 offset:27648
    v_mfma_f32_16x16x32_bf16 v[4:7], v[60:63], a[56:59], v[4:7]
    ds_read_b128 v[80:83], v182 offset:28672
    s_add_u32 m0, s89, 114688
    s_add_u32 s84, s8, 114688
    buffer_load_dwordx4 v254, s[4:7], s84 offen lds
    s_waitcnt lgkmcnt(2)
    v_mfma_f32_16x16x32_bf16 v[8:11], v[64:67], a[56:59], v[8:11]
    ds_read_b128 v[84:87], v182 offset:29696
    v_mfma_f32_16x16x32_bf16 v[12:15], v[68:71], a[56:59], v[12:15]
    ds_read_b128 v[88:91], v182 offset:30720
    v_mfma_f32_16x16x32_bf16 v[16:19], v[72:75], a[56:59], v[16:19]
    ds_read_b128 v[92:95], v184 offset:27648
    s_waitcnt vmcnt(10) lgkmcnt(3)
    v_mfma_f32_16x16x32_bf16 v[0:3], v[76:79], a[60:63], v[0:3]
    ds_read_b128 v[56:59], v182 offset:32256
    v_mfma_f32_16x16x32_bf16 v[4:7], v[80:83], a[60:63], v[4:7]
    ds_read_b128 v[60:63], v182 offset:33280
    s_add_u32 m0, s89, 118784
    s_add_u32 s84, s8, 118784
    buffer_load_dwordx4 v254, s[4:7], s84 offen lds
    s_waitcnt lgkmcnt(2)
    v_mfma_f32_16x16x32_bf16 v[8:11], v[84:87], a[60:63], v[8:11]
    ds_read_b128 v[64:67], v182 offset:34304
    v_mfma_f32_16x16x32_bf16 v[12:15], v[88:91], a[60:63], v[12:15]
    ds_read_b128 v[68:71], v182 offset:35328
    v_mfma_f32_16x16x32_bf16 v[16:19], v[92:95], a[60:63], v[16:19]
    ds_read_b128 v[72:75], v184 offset:32256
    s_waitcnt vmcnt(10) lgkmcnt(3)
    v_mfma_f32_16x16x32_bf16 v[0:3], v[56:59], a[64:67], v[0:3]
    ds_read_b128 v[76:79], v182 offset:36864
    v_mfma_f32_16x16x32_bf16 v[4:7], v[60:63], a[64:67], v[4:7]
    ds_read_b128 v[80:83], v182 offset:37888
    s_add_u32 m0, s89, 122880
    s_add_u32 s84, s8, 122880
    buffer_load_dwordx4 v254, s[4:7], s84 offen lds
    s_waitcnt lgkmcnt(2)
    v_mfma_f32_16x16x32_bf16 v[8:11], v[64:67], a[64:67], v[8:11]
    ds_read_b128 v[84:87], v182 offset:38912
    v_mfma_f32_16x16x32_bf16 v[12:15], v[68:71], a[64:67], v[12:15]
    ds_read_b128 v[88:91], v182 offset:39936
    v_mfma_f32_16x16x32_bf16 v[16:19], v[72:75], a[64:67], v[16:19]
    ds_read_b128 v[92:95], v184 offset:36864
    s_waitcnt vmcnt(10) lgkmcnt(3)
    v_mfma_f32_16x16x32_bf16 v[0:3], v[76:79], a[68:71], v[0:3]
    v_mfma_f32_16x16x32_bf16 v[4:7], v[80:83], a[68:71], v[4:7]
    s_mov_b32 m0, s12
    s_add_u32 s84, s8, s13
    buffer_load_dwordx4 v254, s[4:7], s84 offen lds
    s_waitcnt lgkmcnt(0)
    v_mfma_f32_16x16x32_bf16 v[8:11], v[84:87], a[68:71], v[8:11]
    v_mfma_f32_16x16x32_bf16 v[12:15], v[88:91], a[68:71], v[12:15]
    v_mfma_f32_16x16x32_bf16 v[16:19], v[92:95], a[68:71], v[16:19]
    s_cmp_eq_u32 s47, 1
    s_cbranch_scc1 Lfin_65
    v_cvt_pk_bf16_f32 v200, v0, v1
    v_cvt_pk_bf16_f32 v201, v2, v3
    v_cvt_pk_bf16_f32 v202, v4, v5
    v_cvt_pk_bf16_f32 v203, v6, v7
    v_cvt_pk_bf16_f32 v204, v8, v9
    v_cvt_pk_bf16_f32 v205, v10, v11
    v_cvt_pk_bf16_f32 v206, v12, v13
    v_cvt_pk_bf16_f32 v207, v14, v15
    v_cvt_pk_bf16_f32 v208, v16, v17
    v_cvt_pk_bf16_f32 v209, v18, v19
    v_permlane16_swap_b32 v200, v202
    v_permlane16_swap_b32 v201, v203
    v_permlane16_swap_b32 v204, v206
    v_permlane16_swap_b32 v205, v207
    s_cmp_eq_u32 s41, 0
    s_cbranch_scc1 Lss_66
    buffer_store_dwordx4 v[200:203], v191, s[24:27], 0 offen
    buffer_store_dwordx4 v[204:207], v191, s[24:27], 0 offen offset:1024
    buffer_store_dwordx2 v[208:209], v192, s[24:27], 0 offen
Lsj_67:
    v_pk_add_f32 v[56:57], v[0:1], v[2:3]
    v_pk_mul_f32 v[58:59], v[0:1], v[0:1]
    v_pk_fma_f32 v[58:59], v[2:3], v[2:3], v[58:59]
    v_pk_add_f32 v[56:57], v[56:57], v[4:5]
    v_pk_fma_f32 v[58:59], v[4:5], v[4:5], v[58:59]
    v_pk_add_f32 v[56:57], v[56:57], v[6:7]
    v_pk_fma_f32 v[58:59], v[6:7], v[6:7], v[58:59]
    v_pk_add_f32 v[56:57], v[56:57], v[8:9]
    v_pk_fma_f32 v[58:59], v[8:9], v[8:9], v[58:59]
    v_pk_add_f32 v[56:57], v[56:57], v[10:11]
    v_pk_fma_f32 v[58:59], v[10:11], v[10:11], v[58:59]
    v_pk_add_f32 v[56:57], v[56:57], v[12:13]
    v_pk_fma_f32 v[58:59], v[12:13], v[12:13], v[58:59]
    v_pk_add_f32 v[56:57], v[56:57], v[14:15]
    v_pk_fma_f32 v[58:59], v[14:15], v[14:15], v[58:59]
    s_mov_b32 exec_hi, 0
    v_pk_add_f32 v[56:57], v[56:57], v[16:17]
    v_pk_fma_f32 v[58:59], v[16:17], v[16:17], v[58:59]
    v_pk_add_f32 v[56:57], v[56:57], v[18:19]
    v_pk_fma_f32 v[58:59], v[18:19], v[18:19], v[58:59]
    s_mov_b32 exec_hi, -1
    v_add_f32 v56, v56, v57
    v_add_f32 v57, v58, v59
    s_nop 1
    v_permlane16_swap_b32 v56, v57
    v_add_f32 v56, v56, v57
    v_mov_b32 v58, v56
    s_nop 1
    v_permlane32_swap_b32 v56, v58
    v_add_f32 v56, v56, v58
    s_cmp_eq_u32 s41, 0
    s_cbranch_scc1 Lss_68
    buffer_store_dword v56, v193, s[24:27], 0 offen
Lsj_69:
    s_cmp_eq_u32 s44, 3
    s_cselect_b32 s56, s87, 0
    s_cmp_eq_u32 s56, 0
    s_cbranch_scc1 Lhx_70
    v_add_u32 v60, s38, v191
    v_add_u32 v61, s38, v192
    v_add_u32 v62, s39, v193
    buffer_store_dwordx4 v[200:203], v60, s[24:27], 0 offen sc1
    buffer_store_dwordx4 v[204:207], v60, s[24:27], 0 offen offset:1024 sc1
    buffer_store_dwordx2 v[208:209], v61, s[24:27], 0 offen sc1
    buffer_store_dword v56, v62, s[24:27], 0 offen sc1
Lhx_70:
    s_add_u32 s56, s36, 294912
    s_add_u32 s57, s37, 16384
    s_cmp_eq_u32 s45, 0
    s_cselect_b32 s36, s36, s56
    s_cselect_b32 s37, s37, s57
    s_waitcnt vmcnt(0)
    s_barrier
    s_cmp_eq_u32 s44, 0
    s_cbranch_scc0 Lw0_71
    s_lshl_b32 s58, s47, 3
    s_add_u32 s58, s58, s48
    s_add_u32 s58, s58, 5
    s_not_b32 s59, s58
    s_xor_b32 s59, s59, s42
    v_mov_b32 v172, s58
    v_mov_b32 v173, s59
    s_mov_b64 exec, 1
    s_cmp_eq_u32 s41, 0
    s_cbranch_scc1 Lss_73
    buffer_store_dwordx2 v[172:173], v255, s[24:27], s52 offen
Lsj_74:
    s_cmp_eq_u32 s87, 0
    s_cbranch_scc1 Lhp_75
    buffer_store_dwordx2 v[172:173], v255, s[24:27], s40 offen sc1
Lhp_75:
    s_mov_b64 exec, -1
    v_add_u32 v152, s89, v254
    v_add_u32 v153, 65536, v152
    ds_write_b128 v152, a[144:147] offset:0
    ds_write_b128 v152, a[148:151] offset:4096
    ds_write_b128 v152, a[152:155] offset:8192
    ds_write_b128 v152, a[156:159] offset:12288
    ds_write_b128 v152, a[160:163] offset:16384
    ds_write_b128 v152, a[164:167] offset:20480
    ds_write_b128 v152, a[168:171] offset:24576
    ds_write_b128 v152, a[172:175] offset:28672
    ds_write_b128 v152, a[176:179] offset:32768
    ds_write_b128 v152, a[180:183] offset:36864
    ds_write_b128 v152, a[184:187] offset:40960
    ds_write_b128 v152, a[188:191] offset:45056
    ds_write_b128 v152, a[192:195] offset:49152
    ds_write_b128 v152, a[196:199] offset:53248
    ds_write_b128 v152, a[200:203] offset:57344
    ds_write_b128 v152, a[204:207] offset:61440
    ds_write_b128 v153, a[208:211] offset:0
    ds_write_b128 v153, a[212:215] offset:4096
    ds_write_b128 v153, a[132:135] offset:8192
    ds_write_b128 v153, a[136:139] offset:12288
    ds_write_b128 v153, a[140:143] offset:16384
    s_lshl_b32 s58, s47, 3
    s_add_u32 s58, s58, s48
    s_add_u32 s58, s58, 5
    s_mov_b64 exec, s[54:55]
    s_mov_b32 s59, 0
    buffer_load_dwordx2 v[172:173], v195, s[24:27], 0 offen sc1
    s_sleep 2
    buffer_load_dwordx2 v[170:171], v195, s[24:27], 0 offen sc1
    s_sleep 2
    buffer_load_dwordx2 v[168:169], v195, s[24:27], 0 offen sc1
Lpoll_76:
    s_waitcnt vmcnt(2)
    v_subrev_u32 v174, s58, v172
    v_xor_b32 v175, v172, v173
    v_cmp_gt_u32 vcc, 32, v174
    v_or_b32 v174, 7, v175
    v_cmp_eq_u32 s[60:61], -1, v174
    s_nop 1
    s_and_b64 vcc, vcc, s[60:61]
    s_cmp_eq_u64 vcc, exec
    s_cbranch_scc1 Lgot_77
    buffer_load_dwordx2 v[172:173], v195, s[24:27], 0 offen sc1
    s_waitcnt vmcnt(2)
    v_subrev_u32 v174, s58, v170
    v_xor_b32 v175, v170, v171
    v_cmp_gt_u32 vcc, 32, v174
    v_or_b32 v174, 7, v175
    v_cmp_eq_u32 s[60:61], -1, v174
    s_nop 1
    s_and_b64 vcc, vcc, s[60:61]
    s_cmp_eq_u64 vcc, exec
    s_cbranch_scc1 Lgot_77
    buffer_load_dwordx2 v[170:171], v195, s[24:27], 0 offen sc1
    s_waitcnt vmcnt(2)
    v_subrev_u32 v174, s58, v168
    v_xor_b32 v175, v168, v169
    v_cmp_gt_u32 vcc, 32, v174
    v_or_b32 v174, 7, v175
    v_cmp_eq_u32 s[60:61], -1, v174
    s_nop 1
    s_and_b64 vcc, vcc, s[60:61]
    s_cmp_eq_u64 vcc, exec
    s_cbranch_scc1 Lgot_77
    buffer_load_dwordx2 v[168:169], v195, s[24:27], 0 offen sc1
    s_add_u32 s59, s59, 1
    s_cmp_lt_u32 s59, 20000
    s_cbranch_scc1 Lpoll_76
    s_add_u32 s51, s51, 1
Lgot_77:
    s_mov_b64 exec, -1
    s_branch Lw0j_72
Lw0_71:
    v_add_u32 v152, s89, v254
    v_add_u32 v153, 65536, v152
    ds_write_b128 v152, a[144:147] offset:0
    ds_write_b128 v152, a[148:151] offset:4096
    ds_write_b128 v152, a[152:155] offset:8192
    ds_write_b128 v152, a[156:159] offset:12288
    ds_write_b128 v152, a[160:163] offset:16384
    ds_write_b128 v152, a[164:167] offset:20480
    ds_write_b128 v152, a[168:171] offset:24576
    ds_write_b128 v152, a[172:175] offset:28672
    ds_write_b128 v152, a[176:179] offset:32768
    ds_write_b128 v152, a[180:183] offset:36864
    ds_write_b128 v152, a[184:187] offset:40960
    ds_write_b128 v152, a[188:191] offset:45056
    ds_write_b128 v152, a[192:195] offset:49152
    ds_write_b128 v152, a[196:199] offset:53248
    ds_write_b128 v152, a[200:203] offset:57344
    ds_write_b128 v152, a[204:207] offset:61440
    ds_write_b128 v153, a[208:211] offset:0
    ds_write_b128 v153, a[212:215] offset:4096
    ds_write_b128 v153, a[132:135] offset:8192
    ds_write_b128 v153, a[136:139] offset:12288
    ds_write_b128 v153, a[140:143] offset:16384
Lw0j_72:
    s_nop 0
    s_barrier
    s_mov_b32 s96, 0
    s_mov_b32 s97, 18432
    buffer_load_dwordx4 a[0:3], v176, s[24:27], s96 offen offset:0 sc1
    buffer_load_dwordx4 a[72:75], v176, s[24:27], s97 offen offset:0 sc1
    v_mov_b32 v156, s76
    v_mov_b32 v157, s76
    v_mov_b32 v158, s76
    v_mov_b32 v159, s76
    s_add_u32 s58, s89, 138240
    v_add_u32 v153, s58, v254
    s_not_b64 exec, s[66:67]
    ds_write_b128 v153, v[156:159] offset:0
    ds_write_b128 v153, v[156:159] offset:4096
    ds_write_b128 v153, v[156:159] offset:8192
    ds_write_b128 v153, v[156:159] offset:12288
    ds_write_b128 v153, v[156:159] offset:16384
    s_mov_b64 exec, s[66:67]
    s_add_u32 s57, s89, s36
    s_add_u32 m0, s58, 0
    s_add_u32 s59, s57, 0
    buffer_load_dwordx4 v254, s[24:27], s59 offen sc1 lds
    s_add_u32 m0, s58, 4096
    s_add_u32 s59, s57, 4096
    buffer_load_dwordx4 v254, s[24:27], s59 offen sc1 lds
    s_add_u32 m0, s58, 8192
    s_add_u32 s59, s57, 8192
    buffer_load_dwordx4 v254, s[24:27], s59 offen sc1 lds
    s_add_u32 m0, s58, 12288
    s_add_u32 s59, s57, 12288
    buffer_load_dwordx4 v254, s[24:27], s59 offen sc1 lds
    s_add_u32 m0, s58, 16384
    s_add_u32 s59, s57, 16384
    buffer_load_dwordx4 v254, s[24:27], s59 offen sc1 lds
    s_mov_b64 exec, -1
    buffer_load_dwordx4 a[4:7], v176, s[24:27], s96 offen offset:1024 sc1
    buffer_load_dwordx4 a[76:79], v176, s[24:27], s97 offen offset:1024 sc1
    buffer_load_dwordx4 a[8:11], v176, s[24:27], s96 offen offset:2048 sc1
    buffer_load_dwordx4 a[80:83], v176, s[24:27], s97 offen offset:2048 sc1
    buffer_load_dwordx4 v[132:135], v194, s[24:27], 0 offen offset:0 sc1
    buffer_load_dwordx4 v[136:139], v194, s[24:27], 0 offen offset:1024 sc1
    buffer_load_dwordx4 v[140:143], v254, s[24:27], s37 offen sc1
    buffer_load_dwordx4 a[12:15], v176, s[24:27], s96 offen offset:3072 sc1
    buffer_load_dwordx4 a[84:87], v176, s[24:27], s97 offen offset:3072 sc1
    s_add_u32 s83, s83, 786432
    s_mov_b32 s47, 1
    s_mov_b32 s6, 0
    v_add_u32 v175, 138240, v254
    s_waitcnt vmcnt(9)
    s_waitcnt lgkmcnt(0)
    s_barrier
    ds_read_b128 v[56:59], v177 offset:0
    ds_read_b128 v[60:63], v177 offset:1024
    ds_read_b128 v[64:67], v177 offset:2048
    ds_read_b128 v[68:71], v177 offset:3072
    ds_read_b128 v[72:75], v177 offset:4096
    ds_read_b128 v[76:79], v177 offset:5120
    ds_read_b128 v[80:83], v177 offset:6144
    ds_read_b128 v[144:147], v179 offset:0
    ds_read_b128 v[148:151], v185 offset:0
    ds_read_b128 v[152:155], v175 offset:0
    s_waitcnt lgkmcnt(8)
    v_mfma_f32_16x16x32_bf16 v[0:3], v[56:59], a[0:3], 0
    ds_read_b128 v[84:87], v177 offset:7168
    v_mfma_f32_16x16x32_bf16 v[4:7], v[56:59], a[72:75], 0
    v_mfma_f32_16x16x32_bf16 v[8:11], v[60:63], a[0:3], 0
    ds_read_b128 v[88:91], v177 offset:8192
    v_mfma_f32_16x16x32_bf16 v[12:15], v[60:63], a[72:75], 0
    s_add_u32 s96, s96, 4096
    s_add_u32 s97, s97, 4096
    buffer_load_dwordx4 a[16:19], v176, s[24:27], s96 offen offset:0 sc1
    s_waitcnt lgkmcnt(8)
    v_mfma_f32_16x16x32_bf16 v[16:19], v[64:67], a[0:3], 0
    ds_read_b128 v[92:95], v177 offset:9216
    v_mfma_f32_16x16x32_bf16 v[20:23], v[64:67], a[72:75], 0
    v_mfma_f32_16x16x32_bf16 v[24:27], v[68:71], a[0:3], 0
    ds_read_b128 v[96:99], v177 offset:10240
    v_mfma_f32_16x16x32_bf16 v[28:31], v[68:71], a[72:75], 0
    buffer_load_dwordx4 a[88:91], v176, s[24:27], s97 offen offset:0 sc1
    s_waitcnt lgkmcnt(8)
    v_mfma_f32_16x16x32_bf16 v[32:35], v[72:75], a[0:3], 0
    ds_read_b128 v[100:103], v177 offset:11264
    v_mfma_f32_16x16x32_bf16 v[36:39], v[72:75], a[72:75], 0
    v_mfma_f32_16x16x32_bf16 v[40:43], v[76:79], a[0:3], 0
    ds_read_b128 v[104:107], v177 offset:12288
    v_mfma_f32_16x16x32_bf16 v[44:47], v[76:79], a[72:75], 0
    buffer_load_dwordx4 a[20:23], v176, s[24:27], s96 offen offset:1024 sc1
    s_waitcnt lgkmcnt(6)
    v_mfma_f32_16x16x32_bf16 v[48:51], v[80:83], a[0:3], 0
    ds_read_b128 v[108:111], v177 offset:13312
    v_mfma_f32_16x16x32_bf16 v[52:55], v[80:83], a[72:75], 0
    v_mfma_f32_16x16x32_bf16 v[112:115], v[144:147], v[152:155], 0
    v_mfma_f32_16x16x32_bf16 v[116:119], v[148:151], v[152:155], 0
    ds_read_b128 v[156:159], v179 offset:7168
    ds_read_b128 v[160:163], v185 offset:7168
    ds_read_b128 v[164:167], v175 offset:1024
    s_waitcnt vmcnt(10) lgkmcnt(8)
    v_mfma_f32_16x16x32_bf16 v[0:3], v[84:87], a[4:7], v[0:3]
    ds_read_b128 v[56:59], v177 offset:14336
    v_mfma_f32_16x16x32_bf16 v[4:7], v[84:87], a[76:79], v[4:7]
    v_mfma_f32_16x16x32_bf16 v[8:11], v[88:91], a[4:7], v[8:11]
    ds_read_b128 v[60:63], v177 offset:15360
    v_mfma_f32_16x16x32_bf16 v[12:15], v[88:91], a[76:79], v[12:15]
    buffer_load_dwordx4 a[92:95], v176, s[24:27], s97 offen offset:1024 sc1
    s_waitcnt lgkmcnt(8)
    v_mfma_f32_16x16x32_bf16 v[16:19], v[92:95], a[4:7], v[16:19]
    ds_read_b128 v[64:67], v177 offset:16384
    v_mfma_f32_16x16x32_bf16 v[20:23], v[92:95], a[76:79], v[20:23]
    v_mfma_f32_16x16x32_bf16 v[24:27], v[96:99], a[4:7], v[24:27]
    ds_read_b128 v[68:71], v177 offset:17408
    v_mfma_f32_16x16x32_bf16 v[28:31], v[96:99], a[76:79], v[28:31]
    buffer_load_dwordx4 a[24:27], v176, s[24:27], s96 offen offset:2048 sc1
    s_waitcnt lgkmcnt(8)
    v_mfma_f32_16x16x32_bf16 v[32:35], v[100:103], a[4:7], v[32:35]
    ds_read_b128 v[72:75], v177 offset:18432
    v_mfma_f32_16x16x32_bf16 v[36:39], v[100:103], a[76:79], v[36:39]
    v_mfma_f32_16x16x32_bf16 v[40:43], v[104:107], a[4:7], v[40:43]
    ds_read_b128 v[76:79], v177 offset:19456
    v_mfma_f32_16x16x32_bf16 v[44:47], v[104:107], a[76:79], v[44:47]
    buffer_load_dwordx4 a[96:99], v176, s[24:27], s97 offen offset:2048 sc1
    s_waitcnt lgkmcnt(6)
    v_mfma_f32_16x16x32_bf16 v[48:51], v[108:111], a[4:7], v[48:51]
    ds_read_b128 v[80:83], v177 offset:20480
    v_mfma_f32_16x16x32_bf16 v[52:55], v[108:111], a[76:79], v[52:55]
    v_mfma_f32_16x16x32_bf16 v[112:115], v[156:159], v[164:167], v[112:115]
    v_mfma_f32_16x16x32_bf16 v[116:119], v[160:163], v[164:167], v[116:119]
    ds_read_b128 v[144:147], v179 offset:14336
    ds_read_b128 v[148:151], v185 offset:14336
    ds_read_b128 v[152:155], v175 offset:2048
    s_waitcnt vmcnt(11) lgkmcnt(8)
    v_mfma_f32_16x16x32_bf16 v[0:3], v[56:59], a[8:11], v[0:3]
    ds_read_b128 v[84:87], v177 offset:21504
    v_mfma_f32_16x16x32_bf16 v[4:7], v[56:59], a[80:83], v[4:7]
    v_mfma_f32_16x16x32_bf16 v[8:11], v[60:63], a[8:11], v[8:11]
    ds_read_b128 v[88:91], v177 offset:22528
    v_mfma_f32_16x16x32_bf16 v[12:15], v[60:63], a[80:83], v[12:15]
    buffer_load_dwordx4 a[28:31], v176, s[24:27], s96 offen offset:3072 sc1
    s_waitcnt lgkmcnt(8)
    v_mfma_f32_16x16x32_bf16 v[16:19], v[64:67], a[8:11], v[16:19]
    ds_read_b128 v[92:95], v177 offset:23552
    v_mfma_f32_16x16x32_bf16 v[20:23], v[64:67], a[80:83], v[20:23]
    v_mfma_f32_16x16x32_bf16 v[24:27], v[68:71], a[8:11], v[24:27]
    ds_read_b128 v[96:99], v177 offset:24576
    v_mfma_f32_16x16x32_bf16 v[28:31], v[68:71], a[80:83], v[28:31]
    buffer_load_dwordx4 a[100:103], v176, s[24:27], s97 offen offset:3072 sc1
    s_waitcnt lgkmcnt(8)
    v_mfma_f32_16x16x32_bf16 v[32:35], v[72:75], a[8:11], v[32:35]
    ds_read_b128 v[100:103], v177 offset:25600
    v_mfma_f32_16x16x32_bf16 v[36:39], v[72:75], a[80:83], v[36:39]
    v_mfma_f32_16x16x32_bf16 v[40:43], v[76:79], a[8:11], v[40:43]
    ds_read_b128 v[104:107], v177 offset:26624
    v_mfma_f32_16x16x32_bf16 v[44:47], v[76:79], a[80:83], v[44:47]
    s_add_u32 s96, s96, 4096
    s_add_u32 s97, s97, 4096
    buffer_load_dwordx4 a[32:35], v176, s[24:27], s96 offen offset:0 sc1
    s_waitcnt lgkmcnt(6)
    v_mfma_f32_16x16x32_bf16 v[48:51], v[80:83], a[8:11], v[48:51]
    ds_read_b128 v[108:111], v177 offset:27648
    v_mfma_f32_16x16x32_bf16 v[52:55], v[80:83], a[80:83], v[52:55]
    v_mfma_f32_16x16x32_bf16 v[112:115], v[144:147], v[152:155], v[112:115]
    v_mfma_f32_16x16x32_bf16 v[116:119], v[148:151], v[152:155], v[116:119]
    ds_read_b128 v[156:159], v179 offset:21504
    ds_read_b128 v[160:163], v185 offset:21504
    ds_read_b128 v[164:167], v175 offset:3072
    s_waitcnt vmcnt(9) lgkmcnt(8)
    v_mfma_f32_16x16x32_bf16 v[0:3], v[84:87], a[12:15], v[0:3]
    ds_read_b128 v[56:59], v177 offset:28672
    v_mfma_f32_16x16x32_bf16 v[4:7], v[84:87], a[84:87], v[4:7]
    v_mfma_f32_16x16x32_bf16 v[8:11], v[88:91], a[12:15], v[8:11]
    ds_read_b128 v[60:63], v177 offset:29696
    v_mfma_f32_16x16x32_bf16 v[12:15], v[88:91], a[84:87], v[12:15]
    buffer_load_dwordx4 a[104:107], v176, s[24:27], s97 offen offset:0 sc1
    s_waitcnt lgkmcnt(8)
    v_mfma_f32_16x16x32_bf16 v[16:19], v[92:95], a[12:15], v[16:19]
    ds_read_b128 v[64:67], v177 offset:30720
    v_mfma_f32_16x16x32_bf16 v[20:23], v[92:95], a[84:87], v[20:23]
    v_mfma_f32_16x16x32_bf16 v[24:27], v[96:99], a[12:15], v[24:27]
    ds_read_b128 v[68:71], v177 offset:31744
    v_mfma_f32_16x16x32_bf16 v[28:31], v[96:99], a[84:87], v[28:31]
    buffer_load_dwordx4 a[36:39], v176, s[24:27], s96 offen offset:1024 sc1
    s_waitcnt lgkmcnt(8)
    v_mfma_f32_16x16x32_bf16 v[32:35], v[100:103], a[12:15], v[32:35]
    ds_read_b128 v[72:75], v177 offset:32768
    v_mfma_f32_16x16x32_bf16 v[36:39], v[100:103], a[84:87], v[36:39]
    v_mfma_f32_16x16x32_bf16 v[40:43], v[104:107], a[12:15], v[40:43]
    ds_read_b128 v[76:79], v177 offset:33792
    v_mfma_f32_16x16x32_bf16 v[44:47], v[104:107], a[84:87], v[44:47]
    buffer_load_dwordx4 a[108:111], v176, s[24:27], s97 offen offset:1024 sc1
    s_waitcnt lgkmcnt(6)
    v_mfma_f32_16x16x32_bf16 v[48:51], v[108:111], a[12:15], v[48:51]
    ds_read_b128 v[80:83], v177 offset:34816
    v_mfma_f32_16x16x32_bf16 v[52:55], v[108:111], a[84:87], v[52:55]
    v_mfma_f32_16x16x32_bf16 v[112:115], v[156:159], v[164:167], v[112:115]
    v_mfma_f32_16x16x32_bf16 v[116:119], v[160:163], v[164:167], v[116:119]
    ds_read_b128 v[144:147], v179 offset:28672
    ds_read_b128 v[148:151], v185 offset:28672
    ds_read_b128 v[152:155], v175 offset:4096
    s_waitcnt vmcnt(10) lgkmcnt(8)
    v_mfma_f32_16x16x32_bf16 v[0:3], v[56:59], a[16:19], v[0:3]
    ds_read_b128 v[84:87], v177 offset:35840
    v_mfma_f32_16x16x32_bf16 v[4:7], v[56:59], a[88:91], v[4:7]
    v_mfma_f32_16x16x32_bf16 v[8:11], v[60:63], a[16:19], v[8:11]
    ds_read_b128 v[88:91], v177 offset:36864
    v_mfma_f32_16x16x32_bf16 v[12:15], v[60:63], a[88:91], v[12:15]
    buffer_load_dwordx4 a[40:43], v176, s[24:27], s96 offen offset:2048 sc1
    s_waitcnt lgkmcnt(8)
    v_mfma_f32_16x16x32_bf16 v[16:19], v[64:67], a[16:19], v[16:19]
    ds_read_b128 v[92:95], v177 offset:37888
    v_mfma_f32_16x16x32_bf16 v[20:23], v[64:67], a[88:91], v[20:23]
    v_mfma_f32_16x16x32_bf16 v[24:27], v[68:71], a[16:19], v[24:27]
    ds_read_b128 v[96:99], v177 offset:38912
    v_mfma_f32_16x16x32_bf16 v[28:31], v[68:71], a[88:91], v[28:31]
    buffer_load_dwordx4 a[112:115], v176, s[24:27], s97 offen offset:2048 sc1
    s_waitcnt lgkmcnt(8)
    v_mfma_f32_16x16x32_bf16 v[32:35], v[72:75], a[16:19], v[32:35]
    ds_read_b128 v[100:103], v177 offset:39936
    v_mfma_f32_16x16x32_bf16 v[36:39], v[72:75], a[88:91], v[36:39]
    v_mfma_f32_16x16x32_bf16 v[40:43], v[76:79], a[16:19], v[40:43]
    ds_read_b128 v[104:107], v177 offset:40960
    v_mfma_f32_16x16x32_bf16 v[44:47], v[76:79], a[88:91], v[44:47]
    buffer_load_dwordx4 a[44:47], v176, s[24:27], s96 offen offset:3072 sc1
    s_waitcnt lgkmcnt(6)
    v_mfma_f32_16x16x32_bf16 v[48:51], v[80:83], a[16:19], v[48:51]
    ds_read_b128 v[108:111], v177 offset:41984
    v_mfma_f32_16x16x32_bf16 v[52:55], v[80:83], a[88:91], v[52:55]
    v_mfma_f32_16x16x32_bf16 v[112:115], v[144:147], v[152:155], v[112:115]
    v_mfma_f32_16x16x32_bf16 v[116:119], v[148:151], v[152:155], v[116:119]
    ds_read_b128 v[156:159], v179 offset:35840
    ds_read_b128 v[160:163], v185 offset:35840
    ds_read_b128 v[164:167], v175 offset:5120
    s_waitcnt vmcnt(11) lgkmcnt(8)
    v_mfma_f32_16x16x32_bf16 v[0:3], v[84:87], a[20:23], v[0:3]
    ds_read_b128 v[56:59], v177 offset:43008
    v_mfma_f32_16x16x32_bf16 v[4:7], v[84:87], a[92:95], v[4:7]
    v_add_f32 v132, v132, v134
    v_mfma_f32_16x16x32_bf16 v[8:11], v[88:91], a[20:23], v[8:11]
    ds_read_b128 v[60:63], v177 offset:44032
    v_mfma_f32_16x16x32_bf16 v[12:15], v[88:91], a[92:95], v[12:15]
    buffer_load_dwordx4 a[116:119], v176, s[24:27], s97 offen offset:3072 sc1
    s_waitcnt lgkmcnt(8)
    v_mfma_f32_16x16x32_bf16 v[16:19], v[92:95], a[20:23], v[16:19]
    ds_read_b128 v[64:67], v177 offset:45056
    v_mfma_f32_16x16x32_bf16 v[20:23], v[92:95], a[92:95], v[20:23]
    v_add_f32 v133, v133, v135
    v_mfma_f32_16x16x32_bf16 v[24:27], v[96:99], a[20:23], v[24:27]
    ds_read_b128 v[68:71], v177 offset:46080
    v_mfma_f32_16x16x32_bf16 v[28:31], v[96:99], a[92:95], v[28:31]
    s_add_u32 s96, s96, 4096
    s_add_u32 s97, s97, 4096
    buffer_load_dwordx4 a[48:51], v176, s[24:27], s96 offen offset:0 sc1
    s_waitcnt lgkmcnt(8)
    v_mfma_f32_16x16x32_bf16 v[32:35], v[100:103], a[20:23], v[32:35]
    ds_read_b128 v[72:75], v177 offset:47104
    v_mfma_f32_16x16x32_bf16 v[36:39], v[100:103], a[92:95], v[36:39]
    v_permlane16_swap_b32 v132, v133
    v_mfma_f32_16x16x32_bf16 v[40:43], v[104:107], a[20:23], v[40:43]
    ds_read_b128 v[76:79], v177 offset:48128
    v_mfma_f32_16x16x32_bf16 v[44:47], v[104:107], a[92:95], v[44:47]
    buffer_load_dwordx4 a[120:123], v176, s[24:27], s97 offen offset:0 sc1
    s_waitcnt lgkmcnt(6)
    v_mfma_f32_16x16x32_bf16 v[48:51], v[108:111], a[20:23], v[48:51]
    ds_read_b128 v[80:83], v177 offset:49152
    v_mfma_f32_16x16x32_bf16 v[52:55], v[108:111], a[92:95], v[52:55]
    v_add_f32 v132, v132, v133
    v_mfma_f32_16x16x32_bf16 v[112:115], v[156:159], v[164:167], v[112:115]
    v_mfma_f32_16x16x32_bf16 v[116:119], v[160:163], v[164:167], v[116:119]
    ds_read_b128 v[144:147], v179 offset:43008
    ds_read_b128 v[148:151], v185 offset:43008
    ds_read_b128 v[152:155], v175 offset:6144
    s_waitcnt vmcnt(12) lgkmcnt(8)
    v_mfma_f32_16x16x32_bf16 v[0:3], v[56:59], a[24:27], v[0:3]
    ds_read_b128 v[84:87], v177 offset:50176
    v_mfma_f32_16x16x32_bf16 v[4:7], v[56:59], a[96:99], v[4:7]
    v_mov_b32 v134, v132
    v_mfma_f32_16x16x32_bf16 v[8:11], v[60:63], a[24:27], v[8:11]
    ds_read_b128 v[88:91], v177 offset:51200
    v_mfma_f32_16x16x32_bf16 v[12:15], v[60:63], a[96:99], v[12:15]
    buffer_load_dwordx4 a[52:55], v176, s[24:27], s96 offen offset:1024 sc1
    s_waitcnt lgkmcnt(8)
    v_mfma_f32_16x16x32_bf16 v[16:19], v[64:67], a[24:27], v[16:19]
    ds_read_b128 v[92:95], v177 offset:52224
    v_mfma_f32_16x16x32_bf16 v[20:23], v[64:67], a[96:99], v[20:23]
    v_permlane32_swap_b32 v132, v134
    v_mfma_f32_16x16x32_bf16 v[24:27], v[68:71], a[24:27], v[24:27]
    ds_read_b128 v[96:99], v177 offset:53248
    v_mfma_f32_16x16x32_bf16 v[28:31], v[68:71], a[96:99], v[28:31]
    buffer_load_dwordx4 a[124:127], v176, s[24:27], s97 offen offset:1024 sc1
    s_waitcnt lgkmcnt(8)
    v_mfma_f32_16x16x32_bf16 v[32:35], v[72:75], a[24:27], v[32:35]
    ds_read_b128 v[100:103], v177 offset:54272
    v_mfma_f32_16x16x32_bf16 v[36:39], v[72:75], a[96:99], v[36:39]
    v_add_f32 v132, v132, v134
    v_mfma_f32_16x16x32_bf16 v[40:43], v[76:79], a[24:27], v[40:43]
    ds_read_b128 v[104:107], v177 offset:55296
    v_mfma_f32_16x16x32_bf16 v[44:47], v[76:79], a[96:99], v[44:47]
    buffer_load_dwordx4 a[56:59], v176, s[24:27], s96 offen offset:2048 sc1
    s_waitcnt lgkmcnt(6)
    v_mfma_f32_16x16x32_bf16 v[48:51], v[80:83], a[24:27], v[48:51]
    ds_read_b128 v[108:111], v177 offset:56320
    v_mfma_f32_16x16x32_bf16 v[52:55], v[80:83], a[96:99], v[52:55]
    v_mov_b32 v133, v132
    v_mfma_f32_16x16x32_bf16 v[112:115], v[144:147], v[152:155], v[112:115]
    v_mfma_f32_16x16x32_bf16 v[116:119], v[148:151], v[152:155], v[116:119]
    ds_read_b128 v[156:159], v179 offset:50176
    ds_read_b128 v[160:163], v185 offset:50176
    ds_read_b128 v[164:167], v175 offset:7168
    s_waitcnt vmcnt(13) lgkmcnt(8)
    v_mfma_f32_16x16x32_bf16 v[0:3], v[84:87], a[28:31], v[0:3]
    ds_read_b128 v[56:59], v177 offset:57344
    v_mfma_f32_16x16x32_bf16 v[4:7], v[84:87], a[100:103], v[4:7]
    v_permlane16_swap_b32 v132, v133
    v_mfma_f32_16x16x32_bf16 v[8:11], v[88:91], a[28:31], v[8:11]
    ds_read_b128 v[60:63], v177 offset:58368
    v_mfma_f32_16x16x32_bf16 v[12:15], v[88:91], a[100:103], v[12:15]
    buffer_load_dwordx4 a[128:131], v176, s[24:27], s97 offen offset:2048 sc1
    s_waitcnt lgkmcnt(8)
    v_mfma_f32_16x16x32_bf16 v[16:19], v[92:95], a[28:31], v[16:19]
    ds_read_b128 v[64:67], v177 offset:59392
    v_mfma_f32_16x16x32_bf16 v[20:23], v[92:95], a[100:103], v[20:23]
    v_mul_f32 v120, 0xbae38e39, v132
    v_mfma_f32_16x16x32_bf16 v[24:27], v[96:99], a[28:31], v[24:27]
    ds_read_b128 v[68:71], v177 offset:60416
    v_mfma_f32_16x16x32_bf16 v[28:31], v[96:99], a[100:103], v[28:31]
    buffer_load_dwordx4 a[60:63], v176, s[24:27], s96 offen offset:3072 sc1
    s_waitcnt lgkmcnt(8)
    v_mfma_f32_16x16x32_bf16 v[32:35], v[100:103], a[28:31], v[32:35]
    ds_read_b128 v[72:75], v177 offset:61440
    v_mfma_f32_16x16x32_bf16 v[36:39], v[100:103], a[100:103], v[36:39]
    v_mul_f32 v133, 0x3ae38e39, v133
    v_mfma_f32_16x16x32_bf16 v[40:43], v[104:107], a[28:31], v[40:43]
    ds_read_b128 v[76:79], v177 offset:62464
    v_mfma_f32_16x16x32_bf16 v[44:47], v[104:107], a[100:103], v[44:47]
    buffer_load_dwordx4 a[132:135], v176, s[24:27], s97 offen offset:3072 sc1
    s_waitcnt lgkmcnt(6)
    v_mfma_f32_16x16x32_bf16 v[48:51], v[108:111], a[28:31], v[48:51]
    ds_read_b128 v[80:83], v177 offset:63488
    v_mfma_f32_16x16x32_bf16 v[52:55], v[108:111], a[100:103], v[52:55]
    v_fma_f32 v133, -v120, v120, v133
    v_mfma_f32_16x16x32_bf16 v[112:115], v[156:159], v[164:167], v[112:115]
    v_mfma_f32_16x16x32_bf16 v[116:119], v[160:163], v[164:167], v[116:119]
    ds_read_b128 v[144:147], v179 offset:57344
    ds_read_b128 v[148:151], v185 offset:57344
    ds_read_b128 v[152:155], v175 offset:8192
    s_waitcnt vmcnt(14) lgkmcnt(8)
    v_mfma_f32_16x16x32_bf16 v[0:3], v[56:59], a[32:35], v[0:3]
    ds_read_b128 v[84:87], v178 offset:0
    v_mfma_f32_16x16x32_bf16 v[4:7], v[56:59], a[104:107], v[4:7]
    v_max_f32 v133, 0, v133
    v_mfma_f32_16x16x32_bf16 v[8:11], v[60:63], a[32:35], v[8:11]
    ds_read_b128 v[88:91], v178 offset:1024
    v_mfma_f32_16x16x32_bf16 v[12:15], v[60:63], a[104:107], v[12:15]
    s_add_u32 s96, s96, 4096
    s_add_u32 s97, s97, 4096
    buffer_load_dwordx4 a[64:67], v176, s[24:27], s96 offen offset:0 sc1
    s_waitcnt lgkmcnt(8)
    v_mfma_f32_16x16x32_bf16 v[16:19], v[64:67], a[32:35], v[16:19]
    ds_read_b128 v[92:95], v178 offset:2048
    v_mfma_f32_16x16x32_bf16 v[20:23], v[64:67], a[104:107], v[20:23]
    v_add_f32 v133, 0x3727c5ac, v133
    v_mfma_f32_16x16x32_bf16 v[24:27], v[68:71], a[32:35], v[24:27]
    ds_read_b128 v[96:99], v178 offset:3072
    v_mfma_f32_16x16x32_bf16 v[28:31], v[68:71], a[104:107], v[28:31]
    buffer_load_dwordx4 a[136:139], v176, s[24:27], s97 offen offset:0 sc1
    s_waitcnt lgkmcnt(8)
    v_mfma_f32_16x16x32_bf16 v[32:35], v[72:75], a[32:35], v[32:35]
    ds_read_b128 v[100:103], v178 offset:4096
    v_mfma_f32_16x16x32_bf16 v[36:39], v[72:75], a[104:107], v[36:39]
    v_rsq_f32 v126, v133
    v_mfma_f32_16x16x32_bf16 v[40:43], v[76:79], a[32:35], v[40:43]
    ds_read_b128 v[104:107], v178 offset:5120
    v_mfma_f32_16x16x32_bf16 v[44:47], v[76:79], a[104:107], v[44:47]
    buffer_load_dwordx4 a[68:71], v176, s[24:27], s96 offen offset:1024 sc1
    s_waitcnt lgkmcnt(6)
    v_mfma_f32_16x16x32_bf16 v[48:51], v[80:83], a[32:35], v[48:51]
    ds_read_b128 v[108:111], v178 offset:6144
    v_mfma_f32_16x16x32_bf16 v[52:55], v[80:83], a[104:107], v[52:55]
    v_add_f32 v136, v136, v138
    v_mfma_f32_16x16x32_bf16 v[112:115], v[144:147], v[152:155], v[112:115]
    v_mfma_f32_16x16x32_bf16 v[116:119], v[148:151], v[152:155], v[116:119]
    ds_read_b128 v[156:159], v180 offset:0
    ds_read_b128 v[160:163], v186 offset:0
    ds_read_b128 v[164:167], v175 offset:9216
    s_waitcnt vmcnt(15) lgkmcnt(8)
    v_mfma_f32_16x16x32_bf16 v[0:3], v[84:87], a[36:39], v[0:3]
    ds_read_b128 v[56:59], v178 offset:7168
    v_mfma_f32_16x16x32_bf16 v[4:7], v[84:87], a[108:111], v[4:7]
    v_add_f32 v137, v137, v139
    v_mfma_f32_16x16x32_bf16 v[8:11], v[88:91], a[36:39], v[8:11]
    ds_read_b128 v[60:63], v178 offset:8192
    v_mfma_f32_16x16x32_bf16 v[12:15], v[88:91], a[108:111], v[12:15]
    buffer_load_dwordx4 a[140:143], v176, s[24:27], s97 offen offset:1024 sc1
    s_waitcnt lgkmcnt(8)
    v_mfma_f32_16x16x32_bf16 v[16:19], v[92:95], a[36:39], v[16:19]
    ds_read_b128 v[64:67], v178 offset:9216
    v_mfma_f32_16x16x32_bf16 v[20:23], v[92:95], a[108:111], v[20:23]
    v_permlane16_swap_b32 v136, v137
    v_mfma_f32_16x16x32_bf16 v[24:27], v[96:99], a[36:39], v[24:27]
    ds_read_b128 v[68:71], v178 offset:10240
    v_mfma_f32_16x16x32_bf16 v[28:31], v[96:99], a[108:111], v[28:31]
    s_add_u32 s84, s9, 0
    buffer_load_dwordx4 a[144:147], v254, s[24:27], s84 offen
    s_waitcnt lgkmcnt(8)
    v_mfma_f32_16x16x32_bf16 v[32:35], v[100:103], a[36:39], v[32:35]
    ds_read_b128 v[72:75], v178 offset:11264
    v_mfma_f32_16x16x32_bf16 v[36:39], v[100:103], a[108:111], v[36:39]
    v_add_f32 v136, v136, v137
    v_mfma_f32_16x16x32_bf16 v[40:43], v[104:107], a[36:39], v[40:43]
    ds_read_b128 v[76:79], v178 offset:12288
    v_mfma_f32_16x16x32_bf16 v[44:47], v[104:107], a[108:111], v[44:47]
    s_add_u32 s84, s9, 4096
    buffer_load_dwordx4 a[148:151], v254, s[24:27], s84 offen
    s_waitcnt lgkmcnt(6)
    v_mfma_f32_16x16x32_bf16 v[48:51], v[108:111], a[36:39], v[48:51]
    ds_read_b128 v[80:83], v178 offset:13312
    v_mfma_f32_16x16x32_bf16 v[52:55], v[108:111], a[108:111], v[52:55]
    v_mov_b32 v138, v136
    v_mfma_f32_16x16x32_bf16 v[112:115], v[156:159], v[164:167], v[112:115]
    v_mfma_f32_16x16x32_bf16 v[116:119], v[160:163], v[164:167], v[116:119]
    ds_read_b128 v[144:147], v180 offset:7168
    ds_read_b128 v[148:151], v186 offset:7168
    ds_read_b128 v[152:155], v175 offset:10240
    s_waitcnt vmcnt(16) lgkmcnt(8)
    v_mfma_f32_16x16x32_bf16 v[0:3], v[56:59], a[40:43], v[0:3]
    ds_read_b128 v[84:87], v178 offset:14336
    v_mfma_f32_16x16x32_bf16 v[4:7], v[56:59], a[112:115], v[4:7]
    v_permlane32_swap_b32 v136, v138
    v_mfma_f32_16x16x32_bf16 v[8:11], v[60:63], a[40:43], v[8:11]
    ds_read_b128 v[88:91], v178 offset:15360
    v_mfma_f32_16x16x32_bf16 v[12:15], v[60:63], a[112:115], v[12:15]
    s_add_u32 s84, s9, 8192
    buffer_load_dwordx4 a[152:155], v254, s[24:27], s84 offen
    s_waitcnt lgkmcnt(8)
    v_mfma_f32_16x16x32_bf16 v[16:19], v[64:67], a[40:43], v[16:19]
    ds_read_b128 v[92:95], v178 offset:16384
    v_mfma_f32_16x16x32_bf16 v[20:23], v[64:67], a[112:115], v[20:23]
    v_add_f32 v136, v136, v138
    v_mfma_f32_16x16x32_bf16 v[24:27], v[68:71], a[40:43], v[24:27]
    ds_read_b128 v[96:99], v178 offset:17408
    v_mfma_f32_16x16x32_bf16 v[28:31], v[68:71], a[112:115], v[28:31]
    s_add_u32 s84, s9, 12288
    buffer_load_dwordx4 a[156:159], v254, s[24:27], s84 offen
    s_waitcnt lgkmcnt(8)
    v_mfma_f32_16x16x32_bf16 v[32:35], v[72:75], a[40:43], v[32:35]
    ds_read_b128 v[100:103], v178 offset:18432
    v_mfma_f32_16x16x32_bf16 v[36:39], v[72:75], a[112:115], v[36:39]
    v_mov_b32 v137, v136
    v_mfma_f32_16x16x32_bf16 v[40:43], v[76:79], a[40:43], v[40:43]
    ds_read_b128 v[104:107], v178 offset:19456
    v_mfma_f32_16x16x32_bf16 v[44:47], v[76:79], a[112:115], v[44:47]
    s_add_u32 s84, s9, 16384
    buffer_load_dwordx4 a[160:163], v254, s[24:27], s84 offen
    s_waitcnt lgkmcnt(6)
    v_mfma_f32_16x16x32_bf16 v[48:51], v[80:83], a[40:43], v[48:51]
    ds_read_b128 v[108:111], v178 offset:20480
    v_mfma_f32_16x16x32_bf16 v[52:55], v[80:83], a[112:115], v[52:55]
    v_permlane16_swap_b32 v136, v137
    v_mfma_f32_16x16x32_bf16 v[112:115], v[144:147], v[152:155], v[112:115]
    v_mfma_f32_16x16x32_bf16 v[116:119], v[148:151], v[152:155], v[116:119]
    ds_read_b128 v[156:159], v180 offset:14336
    ds_read_b128 v[160:163], v186 offset:14336
    ds_read_b128 v[164:167], v175 offset:11264
    s_waitcnt vmcnt(17) lgkmcnt(8)
    v_mfma_f32_16x16x32_bf16 v[0:3], v[84:87], a[44:47], v[0:3]
    ds_read_b128 v[56:59], v178 offset:21504
    v_mfma_f32_16x16x32_bf16 v[4:7], v[84:87], a[116:119], v[4:7]
    v_mul_f32 v122, 0xbae38e39, v136
    v_mfma_f32_16x16x32_bf16 v[8:11], v[88:91], a[44:47], v[8:11]
    ds_read_b128 v[60:63], v178 offset:22528
    v_mfma_f32_16x16x32_bf16 v[12:15], v[88:91], a[116:119], v[12:15]
    s_waitcnt lgkmcnt(8)
    v_mfma_f32_16x16x32_bf16 v[16:19], v[92:95], a[44:47], v[16:19]
    ds_read_b128 v[64:67], v178 offset:23552
    v_mfma_f32_16x16x32_bf16 v[20:23], v[92:95], a[116:119], v[20:23]
    v_mul_f32 v137, 0x3ae38e39, v137
    v_mfma_f32_16x16x32_bf16 v[24:27], v[96:99], a[44:47], v[24:27]
    ds_read_b128 v[68:71], v178 offset:24576
    v_mfma_f32_16x16x32_bf16 v[28:31], v[96:99], a[116:119], v[28:31]
    s_waitcnt lgkmcnt(8)
    v_mfma_f32_16x16x32_bf16 v[32:35], v[100:103], a[44:47], v[32:35]
    ds_read_b128 v[72:75], v178 offset:25600
    v_mfma_f32_16x16x32_bf16 v[36:39], v[100:103], a[116:119], v[36:39]
    v_fma_f32 v137, -v122, v122, v137
    v_mfma_f32_16x16x32_bf16 v[40:43], v[104:107], a[44:47], v[40:43]
    ds_read_b128 v[76:79], v178 offset:26624
    v_mfma_f32_16x16x32_bf16 v[44:47], v[104:107], a[116:119], v[44:47]
    s_waitcnt lgkmcnt(6)
    v_mfma_f32_16x16x32_bf16 v[48:51], v[108:111], a[44:47], v[48:51]
    ds_read_b128 v[80:83], v178 offset:27648
    v_mfma_f32_16x16x32_bf16 v[52:55], v[108:111], a[116:119], v[52:55]
    v_max_f32 v137, 0, v137
    v_mfma_f32_16x16x32_bf16 v[112:115], v[156:159], v[164:167], v[112:115]
    v_mfma_f32_16x16x32_bf16 v[116:119], v[160:163], v[164:167], v[116:119]
    ds_read_b128 v[144:147], v180 offset:21504
    ds_read_b128 v[148:151], v186 offset:21504
    ds_read_b128 v[152:155], v175 offset:12288
    s_barrier
    s_waitcnt vmcnt(15) lgkmcnt(8)
    v_mfma_f32_16x16x32_bf16 v[0:3], v[56:59], a[48:51], v[0:3]
    ds_read_b128 v[84:87], v178 offset:28672
    v_mfma_f32_16x16x32_bf16 v[4:7], v[56:59], a[120:123], v[4:7]
    v_add_f32 v137, 0x3727c5ac, v137
    v_mfma_f32_16x16x32_bf16 v[8:11], v[60:63], a[48:51], v[8:11]
    ds_read_b128 v[88:91], v178 offset:29696
    v_mfma_f32_16x16x32_bf16 v[12:15], v[60:63], a[120:123], v[12:15]
    s_add_u32 m0, s89, 0
    s_add_u32 s98, s10, 0
    buffer_load_dwordx4 v254, s[24:27], s98 offen lds
    s_waitcnt lgkmcnt(8)
    v_mfma_f32_16x16x32_bf16 v[16:19], v[64:67], a[48:51], v[16:19]
    ds_read_b128 v[92:95], v178 offset:30720
    v_mfma_f32_16x16x32_bf16 v[20:23], v[64:67], a[120:123], v[20:23]
    v_rsq_f32 v128, v137
    v_mfma_f32_16x16x32_bf16 v[24:27], v[68:71], a[48:51], v[24:27]
    ds_read_b128 v[96:99], v178 offset:31744
    v_mfma_f32_16x16x32_bf16 v[28:31], v[68:71], a[120:123], v[28:31]
    s_add_u32 m0, s89, 4096
    s_add_u32 s98, s10, 4096
    buffer_load_dwordx4 v254, s[24:27], s98 offen lds
    s_waitcnt lgkmcnt(8)
    v_mfma_f32_16x16x32_bf16 v[32:35], v[72:75], a[48:51], v[32:35]
    ds_read_b128 v[100:103], v178 offset:32768
    v_mfma_f32_16x16x32_bf16 v[36:39], v[72:75], a[120:123], v[36:39]
    v_add_f32 v140, v140, v142
    v_mfma_f32_16x16x32_bf16 v[40:43], v[76:79], a[48:51], v[40:43]
    ds_read_b128 v[104:107], v178 offset:33792
    v_mfma_f32_16x16x32_bf16 v[44:47], v[76:79], a[120:123], v[44:47]
    s_add_u32 m0, s89, 8192
    s_add_u32 s98, s10, 8192
    buffer_load_dwordx4 v254, s[24:27], s98 offen lds
    s_waitcnt lgkmcnt(6)
    v_mfma_f32_16x16x32_bf16 v[48:51], v[80:83], a[48:51], v[48:51]
    ds_read_b128 v[108:111], v178 offset:34816
    v_mfma_f32_16x16x32_bf16 v[52:55], v[80:83], a[120:123], v[52:55]
    v_add_f32 v141, v141, v143
    v_mfma_f32_16x16x32_bf16 v[112:115], v[144:147], v[152:155], v[112:115]
    v_mfma_f32_16x16x32_bf16 v[116:119], v[148:151], v[152:155], v[116:119]
    ds_read_b128 v[156:159], v180 offset:28672
    ds_read_b128 v[160:163], v186 offset:28672
    ds_read_b128 v[164:167], v175 offset:13312
    s_waitcnt vmcnt(16) lgkmcnt(8)
    v_mfma_f32_16x16x32_bf16 v[0:3], v[84:87], a[52:55], v[0:3]
    ds_read_b128 v[56:59], v178 offset:35840
    v_mfma_f32_16x16x32_bf16 v[4:7], v[84:87], a[124:127], v[4:7]
    v_permlane16_swap_b32 v140, v141
    v_mfma_f32_16x16x32_bf16 v[8:11], v[88:91], a[52:55], v[8:11]
    ds_read_b128 v[60:63], v178 offset:36864
    v_mfma_f32_16x16x32_bf16 v[12:15], v[88:91], a[124:127], v[12:15]
    s_add_u32 m0, s89, 12288
    s_add_u32 s98, s10, 12288
    buffer_load_dwordx4 v254, s[24:27], s98 offen lds
    s_waitcnt lgkmcnt(8)
    v_mfma_f32_16x16x32_bf16 v[16:19], v[92:95], a[52:55], v[16:19]
    ds_read_b128 v[64:67], v178 offset:37888
    v_mfma_f32_16x16x32_bf16 v[20:23], v[92:95], a[124:127], v[20:23]
    v_add_f32 v140, v140, v141
    v_mfma_f32_16x16x32_bf16 v[24:27], v[96:99], a[52:55], v[24:27]
    ds_read_b128 v[68:71], v178 offset:38912
    v_mfma_f32_16x16x32_bf16 v[28:31], v[96:99], a[124:127], v[28:31]
    s_add_u32 m0, s89, 16384
    s_add_u32 s98, s10, 16384
    buffer_load_dwordx4 v254, s[24:27], s98 offen lds
    s_waitcnt lgkmcnt(8)
    v_mfma_f32_16x16x32_bf16 v[32:35], v[100:103], a[52:55], v[32:35]
    ds_read_b128 v[72:75], v178 offset:39936
    v_mfma_f32_16x16x32_bf16 v[36:39], v[100:103], a[124:127], v[36:39]
    v_mov_b32 v142, v140
    v_mfma_f32_16x16x32_bf16 v[40:43], v[104:107], a[52:55], v[40:43]
    ds_read_b128 v[76:79], v178 offset:40960
    v_mfma_f32_16x16x32_bf16 v[44:47], v[104:107], a[124:127], v[44:47]
    s_add_u32 m0, s89, 20480
    s_add_u32 s98, s10, 20480
    buffer_load_dwordx4 v254, s[24:27], s98 offen lds
    s_waitcnt lgkmcnt(6)
    v_mfma_f32_16x16x32_bf16 v[48:51], v[108:111], a[52:55], v[48:51]
    ds_read_b128 v[80:83], v178 offset:41984
    v_mfma_f32_16x16x32_bf16 v[52:55], v[108:111], a[124:127], v[52:55]
    v_permlane32_swap_b32 v140, v142
    v_mfma_f32_16x16x32_bf16 v[112:115], v[156:159], v[164:167], v[112:115]
    v_mfma_f32_16x16x32_bf16 v[116:119], v[160:163], v[164:167], v[116:119]
    ds_read_b128 v[144:147], v180 offset:35840
    ds_read_b128 v[148:151], v186 offset:35840
    ds_read_b128 v[152:155], v175 offset:14336
    s_waitcnt vmcnt(17) lgkmcnt(8)
    v_mfma_f32_16x16x32_bf16 v[0:3], v[56:59], a[56:59], v[0:3]
    ds_read_b128 v[84:87], v178 offset:43008
    v_mfma_f32_16x16x32_bf16 v[4:7], v[56:59], a[128:131], v[4:7]
    v_add_f32 v140, v140, v142
    v_mfma_f32_16x16x32_bf16 v[8:11], v[60:63], a[56:59], v[8:11]
    ds_read_b128 v[88:91], v178 offset:44032
    v_mfma_f32_16x16x32_bf16 v[12:15], v[60:63], a[128:131], v[12:15]
    s_add_u32 m0, s89, 24576
    s_add_u32 s98, s10, 24576
    buffer_load_dwordx4 v254, s[24:27], s98 offen lds
    s_waitcnt lgkmcnt(8)
    v_mfma_f32_16x16x32_bf16 v[16:19], v[64:67], a[56:59], v[16:19]
    ds_read_b128 v[92:95], v178 offset:45056
    v_mfma_f32_16x16x32_bf16 v[20:23], v[64:67], a[128:131], v[20:23]
    v_mov_b32 v141, v140
    v_mfma_f32_16x16x32_bf16 v[24:27], v[68:71], a[56:59], v[24:27]
    ds_read_b128 v[96:99], v178 offset:46080
    v_mfma_f32_16x16x32_bf16 v[28:31], v[68:71], a[128:131], v[28:31]
    s_add_u32 m0, s89, 28672
    s_add_u32 s98, s10, 28672
    buffer_load_dwordx4 v254, s[24:27], s98 offen lds
    s_waitcnt lgkmcnt(8)
    v_mfma_f32_16x16x32_bf16 v[32:35], v[72:75], a[56:59], v[32:35]
    ds_read_b128 v[100:103], v178 offset:47104
    v_mfma_f32_16x16x32_bf16 v[36:39], v[72:75], a[128:131], v[36:39]
    v_permlane16_swap_b32 v140, v141
    v_mfma_f32_16x16x32_bf16 v[40:43], v[76:79], a[56:59], v[40:43]
    ds_read_b128 v[104:107], v178 offset:48128
    v_mfma_f32_16x16x32_bf16 v[44:47], v[76:79], a[128:131], v[44:47]
    s_add_u32 m0, s89, 32768
    s_add_u32 s98, s10, 32768
    buffer_load_dwordx4 v254, s[24:27], s98 offen lds
    s_waitcnt lgkmcnt(6)
    v_mfma_f32_16x16x32_bf16 v[48:51], v[80:83], a[56:59], v[48:51]
    ds_read_b128 v[108:111], v178 offset:49152
    v_mfma_f32_16x16x32_bf16 v[52:55], v[80:83], a[128:131], v[52:55]
    v_mul_f32 v124, 0xbae38e39, v140
    v_mfma_f32_16x16x32_bf16 v[112:115], v[144:147], v[152:155], v[112:115]
    v_mfma_f32_16x16x32_bf16 v[116:119], v[148:151], v[152:155], v[116:119]
    ds_read_b128 v[156:159], v180 offset:43008
    ds_read_b128 v[160:163], v186 offset:43008
    ds_read_b128 v[164:167], v175 offset:15360
    s_waitcnt vmcnt(18) lgkmcnt(8)
    v_mfma_f32_16x16x32_bf16 v[0:3], v[84:87], a[60:63], v[0:3]
    ds_read_b128 v[56:59], v178 offset:50176
    v_mfma_f32_16x16x32_bf16 v[4:7], v[84:87], a[132:135], v[4:7]
    v_mul_f32 v141, 0x3ae38e39, v141
    v_mfma_f32_16x16x32_bf16 v[8:11], v[88:91], a[60:63], v[8:11]
    ds_read_b128 v[60:63], v178 offset:51200
    v_mfma_f32_16x16x32_bf16 v[12:15], v[88:91], a[132:135], v[12:15]
    s_add_u32 m0, s89, 36864
    s_add_u32 s98, s10, 36864
    buffer_load_dwordx4 v254, s[24:27], s98 offen lds
    s_waitcnt lgkmcnt(8)
    v_mfma_f32_16x16x32_bf16 v[16:19], v[92:95], a[60:63], v[16:19]
    ds_read_b128 v[64:67], v178 offset:52224
    v_mfma_f32_16x16x32_bf16 v[20:23], v[92:95], a[132:135], v[20:23]
    v_fma_f32 v141, -v124, v124, v141
    v_mfma_f32_16x16x32_bf16 v[24:27], v[96:99], a[60:63], v[24:27]
    ds_read_b128 v[68:71], v178 offset:53248
    v_mfma_f32_16x16x32_bf16 v[28:31], v[96:99], a[132:135], v[28:31]
    s_add_u32 m0, s89, 40960
    s_add_u32 s98, s10, 40960
    buffer_load_dwordx4 v254, s[24:27], s98 offen lds
    s_waitcnt lgkmcnt(8)
    v_mfma_f32_16x16x32_bf16 v[32:35], v[100:103], a[60:63], v[32:35]
    ds_read_b128 v[72:75], v178 offset:54272
    v_mfma_f32_16x16x32_bf16 v[36:39], v[100:103], a[132:135], v[36:39]
    v_max_f32 v141, 0, v141
    v_mfma_f32_16x16x32_bf16 v[40:43], v[104:107], a[60:63], v[40:43]
    ds_read_b128 v[76:79], v178 offset:55296
    v_mfma_f32_16x16x32_bf16 v[44:47], v[104:107], a[132:135], v[44:47]
    s_add_u32 m0, s89, 45056
    s_add_u32 s98, s10, 45056
    buffer_load_dwordx4 v254, s[24:27], s98 offen lds
    s_waitcnt lgkmcnt(6)
    v_mfma_f32_16x16x32_bf16 v[48:51], v[108:111], a[60:63], v[48:51]
    ds_read_b128 v[80:83], v178 offset:56320
    v_mfma_f32_16x16x32_bf16 v[52:55], v[108:111], a[132:135], v[52:55]
    v_add_f32 v141, 0x3727c5ac, v141
    v_mfma_f32_16x16x32_bf16 v[112:115], v[156:159], v[164:167], v[112:115]
    v_mfma_f32_16x16x32_bf16 v[116:119], v[160:163], v[164:167], v[116:119]
    ds_read_b128 v[144:147], v180 offset:50176
    ds_read_b128 v[148:151], v186 offset:50176
    ds_read_b128 v[152:155], v175 offset:16384
    s_waitcnt vmcnt(19) lgkmcnt(8)
    v_mfma_f32_16x16x32_bf16 v[0:3], v[56:59], a[64:67], v[0:3]
    ds_read_b128 v[84:87], v178 offset:57344
    v_mfma_f32_16x16x32_bf16 v[4:7], v[56:59], a[136:139], v[4:7]
    v_rsq_f32 v130, v141
    v_mfma_f32_16x16x32_bf16 v[8:11], v[60:63], a[64:67], v[8:11]
    ds_read_b128 v[88:91], v178 offset:58368
    v_mfma_f32_16x16x32_bf16 v[12:15], v[60:63], a[136:139], v[12:15]
    s_add_u32 m0, s89, 49152
    s_add_u32 s98, s10, 49152
    buffer_load_dwordx4 v254, s[24:27], s98 offen lds
    s_waitcnt lgkmcnt(8)
    v_mfma_f32_16x16x32_bf16 v[16:19], v[64:67], a[64:67], v[16:19]
    ds_read_b128 v[92:95], v178 offset:59392
    v_mfma_f32_16x16x32_bf16 v[20:23], v[64:67], a[136:139], v[20:23]
    v_mfma_f32_16x16x32_bf16 v[24:27], v[68:71], a[64:67], v[24:27]
    ds_read_b128 v[96:99], v178 offset:60416
    v_mfma_f32_16x16x32_bf16 v[28:31], v[68:71], a[136:139], v[28:31]
    s_add_u32 m0, s89, 53248
    s_add_u32 s98, s10, 53248
    buffer_load_dwordx4 v254, s[24:27], s98 offen lds
    s_waitcnt lgkmcnt(8)
    v_mfma_f32_16x16x32_bf16 v[32:35], v[72:75], a[64:67], v[32:35]
    ds_read_b128 v[100:103], v178 offset:61440
    v_mfma_f32_16x16x32_bf16 v[36:39], v[72:75], a[136:139], v[36:39]
    v_mfma_f32_16x16x32_bf16 v[40:43], v[76:79], a[64:67], v[40:43]
    ds_read_b128 v[104:107], v178 offset:62464
    v_mfma_f32_16x16x32_bf16 v[44:47], v[76:79], a[136:139], v[44:47]
    s_add_u32 m0, s89, 57344
    s_add_u32 s98, s10, 57344
    buffer_load_dwordx4 v254, s[24:27], s98 offen lds
    s_waitcnt lgkmcnt(6)
    v_mfma_f32_16x16x32_bf16 v[48:51], v[80:83], a[64:67], v[48:51]
    ds_read_b128 v[108:111], v178 offset:63488
    v_mfma_f32_16x16x32_bf16 v[52:55], v[80:83], a[136:139], v[52:55]
    v_mfma_f32_16x16x32_bf16 v[112:115], v[144:147], v[152:155], v[112:115]
    v_mfma_f32_16x16x32_bf16 v[116:119], v[148:151], v[152:155], v[116:119]
    ds_read_b128 v[156:159], v180 offset:57344
    ds_read_b128 v[160:163], v186 offset:57344
    ds_read_b128 v[164:167], v175 offset:17408
    s_waitcnt vmcnt(20) lgkmcnt(8)
    v_mfma_f32_16x16x32_bf16 v[0:3], v[84:87], a[68:71], v[0:3]
    v_mfma_f32_16x16x32_bf16 v[4:7], v[84:87], a[140:143], v[4:7]
    v_mfma_f32_16x16x32_bf16 v[8:11], v[88:91], a[68:71], v[8:11]
    v_mfma_f32_16x16x32_bf16 v[12:15], v[88:91], a[140:143], v[12:15]
    s_add_u32 m0, s89, 61440
    s_add_u32 s98, s10, 61440
    buffer_load_dwordx4 v254, s[24:27], s98 offen lds
    s_waitcnt lgkmcnt(6)
    v_mfma_f32_16x16x32_bf16 v[16:19], v[92:95], a[68:71], v[16:19]
    v_mfma_f32_16x16x32_bf16 v[20:23], v[92:95], a[140:143], v[20:23]
    v_mfma_f32_16x16x32_bf16 v[24:27], v[96:99], a[68:71], v[24:27]
    v_mfma_f32_16x16x32_bf16 v[28:31], v[96:99], a[140:143], v[28:31]
    s_add_u32 m0, s89, 65536
    s_add_u32 s98, s10, 65536
    buffer_load_dwordx4 v254, s[24:27], s98 offen lds
    s_waitcnt lgkmcnt(4)
    v_mfma_f32_16x16x32_bf16 v[32:35], v[100:103], a[68:71], v[32:35]
    v_mfma_f32_16x16x32_bf16 v[36:39], v[100:103], a[140:143], v[36:39]
    v_mfma_f32_16x16x32_bf16 v[40:43], v[104:107], a[68:71], v[40:43]
    v_mfma_f32_16x16x32_bf16 v[44:47], v[104:107], a[140:143], v[44:47]
    s_add_u32 m0, s89, 69632
    s_add_u32 s98, s10, 69632
    buffer_load_dwordx4 v254, s[24:27], s98 offen lds
    s_waitcnt lgkmcnt(0)
    v_mfma_f32_16x16x32_bf16 v[48:51], v[108:111], a[68:71], v[48:51]
    v_mfma_f32_16x16x32_bf16 v[52:55], v[108:111], a[140:143], v[52:55]
    v_mfma_f32_16x16x32_bf16 v[112:115], v[156:159], v[164:167], v[112:115]
    v_mfma_f32_16x16x32_bf16 v[116:119], v[160:163], v[164:167], v[116:119]
    s_add_u32 s56, s44, 2
    s_lshl_b32 s56, s56, 6
    s_add_u32 s56, s56, 162432
    s_add_u32 s57, s44, 4
    s_cmp_ge_u32 s44, 2
    s_cselect_b32 s57, s57, s44
    s_lshl_b32 s57, s57, 6
    s_add_u32 s57, s57, 162432
    v_lshlrev_b32 v148, 4, v199
    v_add_u32 v149, s57, v148
    v_add_u32 v148, s56, v148
    s_not_b64 exec, s[66:67]
    ds_write_b128 v148, v[112:115]
    ds_write_b128 v149, v[116:119]
    s_mov_b64 exec, -1
    s_branch L_POST
Lfin_65:
    s_nop 7
    v_cvt_pk_bf16_f32 v200, v0, v1
    v_cvt_pk_bf16_f32 v201, v2, v3
    v_cvt_pk_bf16_f32 v202, v4, v5
    v_cvt_pk_bf16_f32 v203, v6, v7
    v_cvt_pk_bf16_f32 v204, v8, v9
    v_cvt_pk_bf16_f32 v205, v10, v11
    v_cvt_pk_bf16_f32 v206, v12, v13
    v_cvt_pk_bf16_f32 v207, v14, v15
    v_cvt_pk_bf16_f32 v208, v16, v17
    v_cvt_pk_bf16_f32 v209, v18, v19
    v_permlane16_swap_b32 v200, v202
    v_permlane16_swap_b32 v201, v203
    v_permlane16_swap_b32 v204, v206
    v_permlane16_swap_b32 v205, v207
    v_mov_b32 v13, 1073741824
    s_lshl_b32 s3, s45, 7
    s_lshl_b32 s56, s49, 6
    s_add_u32 s56, s56, s3
    s_lshl_b32 s57, s44, 4
    s_add_u32 s56, s56, s57
    v_add_u32 v24, s56, v198
    v_mul_u32_u24 v24, 1152, v24
    s_mul_i32 s57, s50, 144
    v_add_u32 v24, s57, v24
    v_and_b32 v27, 1, v199
    v_lshrrev_b32 v28, 1, v199
    v_lshl_add_u32 v25, v27, 5, v24
    v_lshl_add_u32 v25, v28, 4, v25
    v_lshl_add_u32 v27, v199, 3, v24
    v_add_u32 v27, 128, v27
    v_cmp_gt_u32 vcc, 2, v199
    s_nop 1
    v_cndmask_b32 v26, v13, v27, vcc
    buffer_store_dwordx4 v[200:203], v25, s[28:31], 0 offen
    buffer_store_dwordx4 v[204:207], v25, s[28:31], 0 offen offset:64
    buffer_store_dwordx2 v[208:209], v26, s[28:31], 0 offen
    s_or_b32 s56, s2, s44
    s_cmp_eq_u32 s56, 0
    s_cbranch_scc0 Lep_78
    s_add_u32 s57, s48, 55
    v_mov_b32 v1, s57
    s_mov_b32 s58, 9453568
    s_mov_b64 exec, 1
    buffer_store_dword v1, v255, s[24:27], s58 offen sc1
    s_mov_b64 exec, -1
Lep_78:
L_END:
    s_waitcnt vmcnt(0)
L_EXIT:
    s_endpgm
Lss_26:
    buffer_store_dwordx2 v[120:121], v188, s[24:27], 0 offen sc1
    buffer_store_dwordx2 v[122:123], v189, s[24:27], 0 offen sc1
    buffer_store_dwordx2 v[124:125], v188, s[24:27], s77 offen sc1
    buffer_store_dwordx2 v[126:127], v189, s[24:27], s77 offen sc1
    buffer_store_dwordx2 v[128:129], v190, s[24:27], 0 offen sc1
    buffer_store_dwordx2 v[130:131], v190, s[24:27], s77 offen sc1
    s_branch Lsj_27
Lss_30:
    buffer_store_dwordx2 v[172:173], v255, s[24:27], s52 offen sc1
    s_branch Lsj_31
Lss_34:
    buffer_store_dwordx4 v[200:203], v191, s[24:27], 0 offen sc1
    buffer_store_dwordx4 v[204:207], v191, s[24:27], 0 offen offset:1024 sc1
    buffer_store_dwordx2 v[208:209], v192, s[24:27], 0 offen sc1
    s_branch Lsj_35
Lss_36:
    buffer_store_dword v56, v193, s[24:27], 0 offen sc1
    s_branch Lsj_37
Lss_40:
    buffer_store_dwordx2 v[172:173], v255, s[24:27], s52 offen sc1
    s_branch Lsj_41
Lss_57:
    buffer_store_dwordx2 v[120:121], v188, s[24:27], 0 offen sc1
    buffer_store_dwordx2 v[122:123], v189, s[24:27], 0 offen sc1
    buffer_store_dwordx2 v[124:125], v188, s[24:27], s77 offen sc1
    buffer_store_dwordx2 v[126:127], v189, s[24:27], s77 offen sc1
    buffer_store_dwordx2 v[128:129], v190, s[24:27], 0 offen sc1
    buffer_store_dwordx2 v[130:131], v190, s[24:27], s77 offen sc1
    s_branch Lsj_58
Lss_61:
    buffer_store_dwordx2 v[172:173], v255, s[24:27], s52 offen sc1
    s_branch Lsj_62
Lss_66:
    buffer_store_dwordx4 v[200:203], v191, s[24:27], 0 offen sc1
    buffer_store_dwordx4 v[204:207], v191, s[24:27], 0 offen offset:1024 sc1
    buffer_store_dwordx2 v[208:209], v192, s[24:27], 0 offen sc1
    s_branch Lsj_67
Lss_68:
    buffer_store_dword v56, v193, s[24:27], 0 offen sc1
    s_branch Lsj_69
Lss_73:
    buffer_store_dwordx2 v[172:173], v255, s[24:27], s52 offen sc1
    s_branch Lsj_74
.section .rodata,"a"
.p2align 6
.amdhsa_kernel interleave_layers__sliding_local_dilated__linear_kernel_hedgehog__prompt_kernel
  .amdhsa_next_free_vgpr 512
  .amdhsa_next_free_sgpr 102
  .amdhsa_accum_offset 256
  .amdhsa_group_segment_fixed_size 0
  .amdhsa_kernarg_size 80
  .amdhsa_user_sgpr_count 2
  .amdhsa_user_sgpr_kernarg_segment_ptr 1
  .amdhsa_system_sgpr_workgroup_id_x 1
.end_amdhsa_kernel
```
